```python
import torch

def _softmax(x, axis=-1):
    return torch.softmax(x, dim=axis)
def _gelu(x):
    return torch.nn.functional.gelu(x, approximate="tanh")
def _silu(x):
    return torch.nn.functional.silu(x)
def _sigmoid(x):
    return torch.sigmoid(x)
def _layernorm(x, axis=-1, eps=1e-5):
    m = x.mean(dim=axis, keepdim=True)
    v = x.var(dim=axis, keepdim=True, unbiased=False)
    return (x - m) / torch.sqrt(v + eps)
def _scatter_add(tgt, idx, src, axis=0):
    return tgt.clone().index_add_(axis, idx, src)
def _segment_sum(src, seg, n):
    out = torch.zeros((n,) + src.shape[1:], dtype=src.dtype)
    return out.index_add_(0, seg, src)
def _pad(x, pw):
    flat = tuple(v for pair in reversed(pw) for v in pair)
    return torch.nn.functional.pad(x, flat)

kernel_name = 'gated_mix__ssm_conv_s4__swiglu_ffn__prompt'

def setup_inputs():

    _w = (lambda a: (lambda t: t.to(torch.bfloat16) if t.is_floating_point() else t)(torch.as_tensor(a)))
    def _A_setup():
        B, L, D, N = 1, 2048, 512, 128
        A_re = -(lambda _x: torch.exp(torch.as_tensor(_x)))((lambda *s: torch.randn(*s, dtype=torch.bfloat16) * 3.2)(D, N))
        A_im = torch.pi * (lambda *s: torch.randn(*s, dtype=torch.bfloat16) * 0.05)(D, N)
        B_re = (lambda *s: torch.randn(*s, dtype=torch.bfloat16) * 0.1)(D, N)
        B_im = (lambda *s: torch.randn(*s, dtype=torch.bfloat16) * 0.1)(D, N)
        C_re = (lambda *s: torch.randn(*s, dtype=torch.bfloat16) * 0.1)(D, N)
        C_im = (lambda *s: torch.randn(*s, dtype=torch.bfloat16) * 0.1)(D, N)
        log_dt = (lambda *s: torch.randn(*s, dtype=torch.bfloat16) * 0.05)(D) * 0.5 - 4.0
        Dskip = (lambda *s: torch.randn(*s, dtype=torch.bfloat16) * 0.05)(D)
        return {
            "u": _w((lambda *s: torch.randn(*s, dtype=torch.bfloat16) * 0.05)(B, L, D)),
            "A_re": _w(A_re),
            "A_im": _w(A_im),
            "B_re": _w(B_re),
            "B_im": _w(B_im),
            "C_re": _w(C_re),
            "C_im": _w(C_im),
            "log_dt": _w(log_dt),
            "Dskip": _w(Dskip),
        }
    _A_in = _A_setup()

    def _B_setup():
        B, S, D, F = 1, 2048, 512, 1792
        return {
            "x": _w((lambda *s: torch.randn(*s, dtype=torch.bfloat16) * 0.05)(B, S, D)),
            "w_gate": _w((lambda *s: torch.randn(*s, dtype=torch.bfloat16) * 0.05)(D, F)),
            "w_up": _w((lambda *s: torch.randn(*s, dtype=torch.bfloat16) * 0.05)(D, F)),
            "w_down": _w((lambda *s: torch.randn(*s, dtype=torch.bfloat16) * 0.05)(F, D)),
        }
    _B_in = _B_setup()

    return {
        "A_u": _A_in["u"],
        "A_A_re": _A_in["A_re"],
        "A_A_im": _A_in["A_im"],
        "A_B_re": _A_in["B_re"],
        "A_B_im": _A_in["B_im"],
        "A_C_re": _A_in["C_re"],
        "A_C_im": _A_in["C_im"],
        "A_log_dt": _A_in["log_dt"],
        "A_Dskip": _A_in["Dskip"],
        "B_x": _B_in["x"],
        "B_w_gate": _B_in["w_gate"],
        "B_w_up": _B_in["w_up"],
        "B_w_down": _B_in["w_down"],
        "gate_w": _w((lambda *s: torch.randn(*s, dtype=torch.bfloat16) * 0.05)(512) * 16.0),
    }

def reference(A_u, A_A_re, A_A_im, A_B_re, A_B_im, A_C_re, A_C_im, A_log_dt, A_Dskip, B_x, B_w_gate, B_w_up, B_w_down, gate_w):
    def _A_ref(u, A_re, A_im, B_re, B_im, C_re, C_im, log_dt, Dskip):
        Bsz, L, D = u.shape
        dt = torch.exp(log_dt)[:, None]
        A = A_re + 1j * A_im
        Bc = B_re + 1j * B_im
        Cc = C_re + 1j * C_im
        logdA = dt * A
        dB = dt * Bc
        l = (lambda x, dt: x.to(dt))(torch.arange(L), A_re.dtype)
        P = torch.exp(logdA[:, :, None] * l[None, None, :])
        K = torch.einsum("dn,dnl,dn->dl", Cc, P, dB).real
        L2 = 2 * L
        Kp = _pad(K, ((0, 0), (0, L)))
        up = (lambda x, *d: x.permute(*d))(u, 0, 2, 1)
        up = _pad(up, ((0, 0), (0, 0), (0, L)))
        Kf = (lambda x, axes=(-2,-1): torch.fft.rfft2(x.float(), dim=axes))(Kp[:, None, :], axes=(-2, -1))
        Uf = (lambda x, axes=(-2,-1): torch.fft.rfft2(x.float(), dim=axes))(up[:, :, None, :], axes=(-2, -1))
        Yf = Uf * Kf[None, :, :, :]
        y = (lambda x, s, axes=(-2,-1): torch.fft.irfft2(x, s=s, dim=axes).to(torch.bfloat16))(Yf, (1, L2), axes=(-2, -1))[:, :, 0, :L]
        y = (lambda x, *d: x.permute(*d))(y, 0, 2, 1) + u * Dskip[None, None, :]
        return y

    def _B_ref(x, w_gate, w_up, w_down):
        g = _silu(x @ w_gate)
        u = x @ w_up
        return (g * u) @ w_down

    x = A_u
    g = _sigmoid((x * gate_w).sum(-1, keepdims=True))
    a = _A_ref(x, A_A_re, A_A_im, A_B_re, A_B_im, A_C_re, A_C_im, A_log_dt, A_Dskip)
    b = _B_ref(x, B_w_gate, B_w_up, B_w_down)
    return g * a + (1 - g) * b
```

```asm
; @launch grid=(256,1,1) block=(512,1,1) lds=163840
.amdgcn_target "amdgcn-amd-amdhsa--gfx950"
.text
.globl gated_mix__ssm_conv_s4__swiglu_ffn__prompt_kernel
.p2align 8
.type gated_mix__ssm_conv_s4__swiglu_ffn__prompt_kernel,@function
gated_mix__ssm_conv_s4__swiglu_ffn__prompt_kernel:
    s_cmp_ge_u32 s2, 256
    s_cbranch_scc1 L_END
    s_load_dwordx8 s[24:31], s[0:1], 80
    s_load_dwordx16 s[52:67], s[0:1], 0
    s_load_dwordx2 s[4:5], s[0:1], 0
    s_load_dwordx2 s[36:37], s[0:1], 128
    s_load_dwordx4 s[32:35], s[0:1], 112
    s_load_dwordx2 s[20:21], s[0:1], 64
    v_lshrrev_b32 v1, 6, v0
    v_and_b32 v0, 63, v0
    s_nop 0
    v_readfirstlane_b32 s38, v1
    s_lshl_b32 s69, s2, 1
    v_lshlrev_b32 v2, 2, v0
    s_nop 1
    s_cmp_lt_u32 s38, 6
    s_cbranch_scc1 L_NOTK
    s_sub_u32 s68, s38, 6
    s_add_u32 s69, s69, s68
    s_lshl_b32 s71, s69, 8
    v_add_u32 v2, s71, v2
    s_lshl_b32 s72, s69, 1
    v_mov_b32 v3, s72
    s_waitcnt lgkmcnt(0)
    v_mov_b32 v11, v2
    v_mov_b32 v13, v3
    s_and_b32 s39, s2, 7
    s_lshr_b32 s40, s2, 3
    s_cmp_lt_u32 s2, 224
    s_cbranch_scc1 L_KWAVE
    global_load_dword v6, v11, s[54:55]
    global_load_dword v7, v11, s[56:57]
    global_load_dword v8, v11, s[58:59]
    global_load_dword v9, v11, s[60:61]
    global_load_dword v10, v11, s[62:63]
    global_load_dword v11, v11, s[64:65]
    global_load_ushort v12, v13, s[66:67]
    global_load_ushort v13, v13, s[20:21]
    s_branch L_KWAVE_S
L_NOTK:
    s_cmp_ge_u32 s38, 4
    s_cbranch_scc1 L_ISL
    s_getpc_b64 s[70:71]
L_PC:
    s_sub_u32 s70, s70, L_PC-gated_mix__ssm_conv_s4__swiglu_ffn__prompt_kernel
    s_subb_u32 s71, s71, 0
    s_lshr_b32 s72, s2, 3
    s_lshl_b32 s72, s72, 2
    s_add_u32 s72, s72, s38
    s_lshl_b32 s72, s72, 9
    v_and_b32 v2, 7, v0
    v_lshlrev_b32 v2, 6, v2
    v_add_u32 v2, s72, v2
    v_min_u32 v2, L_END-gated_mix__ssm_conv_s4__swiglu_ffn__prompt_kernel, v2
    global_load_dword v127, v2, s[70:71]
    s_cmp_lt_u32 s2, 224
    s_cbranch_scc1 L_GEMM1
    s_branch L_SPARE
L_ISL:
    s_and_b32 s39, s2, 7
    s_lshr_b32 s40, s2, 3
    s_and_b32 s70, s39, 1
    s_lshl_b32 s70, s70, 2
    s_and_b32 s68, s40, 7
    s_lshr_b32 s69, s40, 3
    s_add_u32 s71, s69, s70
    s_add_u32 s72, s68, s70
    s_cmp_ge_u32 s40, 24
    s_cselect_b32 s71, 3, s71
    s_cselect_b32 s68, s72, s68
    s_lshr_b32 s42, s39, 1
    s_and_b32 s42, s42, 1
    s_mul_i32 s42, s42, 7
    s_add_u32 s42, s42, s71
    s_lshr_b32 s41, s39, 2
    s_lshl_b32 s41, s41, 3
    s_add_u32 s41, s41, s68
    s_lshl_b32 s43, s69, 1
    s_add_u32 s43, s43, s68
    s_and_b32 s43, s43, 7
    s_sub_u32 s6, s38, 4
    s_cmp_ge_u32 s40, 28
    s_cbranch_scc1 L_LWAVE_S
    s_setprio 3
    v_lshrrev_b32 v3, 4, v0
    v_and_b32 v4, 15, v0
    s_mov_b32 s18, s68
    s_mov_b32 s19, s69
    v_lshlrev_b32 v5, 2, v3
    s_lshl_b32 s23, s42, 8
    v_xor_b32 v4, v4, v5
    s_lshl_b32 s16, s6, 14
    v_mul_u32_u24 v3, 3584, v3
    s_add_u32 s16, s16, 16384
    v_lshl_add_u32 v12, v4, 4, v3
    s_mov_b32 s14, 1835008
    s_mov_b32 s15, 0x00020000
    v_xor_b32 v4, 2, v4
    v_add_u32 v13, 13312, v12
    v_lshl_add_u32 v14, v4, 4, v3
    v_add_u32 v15, 39936, v14
    v_add_u32 v14, 26624, v14
    s_add_u32 s17, s18, 0
    s_and_b32 s17, s17, 3
    s_mul_i32 s68, s17, 57344
    s_add_u32 s68, s68, s23
    s_lshl_b32 s72, s17, 12
    s_add_u32 s72, s72, s16
    s_cmp_eq_u32 s6, 0
    s_waitcnt lgkmcnt(0)
    s_cselect_b32 s12, s24, s26
    s_cselect_b32 s13, s25, s27
    s_and_b32 s13, s13, 0xffff
    s_add_u32 m0, s72, 0
    s_add_u32 s22, s68, 0
    buffer_load_dwordx4 v12, s[12:15], s22 offen offset:0 lds
    buffer_load_dwordx4 v13, s[12:15], s22 offen offset:1024 lds
    buffer_load_dwordx4 v14, s[12:15], s22 offen offset:2048 lds
    buffer_load_dwordx4 v15, s[12:15], s22 offen offset:3072 lds
    s_add_u32 s17, s18, 1
    s_and_b32 s17, s17, 3
    s_mul_i32 s69, s17, 57344
    s_add_u32 s69, s69, s23
    s_lshl_b32 s73, s17, 12
    s_add_u32 s73, s73, s16
    s_add_u32 m0, s73, 0
    s_add_u32 s22, s69, 0
    buffer_load_dwordx4 v12, s[12:15], s22 offen offset:0 lds
    buffer_load_dwordx4 v13, s[12:15], s22 offen offset:1024 lds
    buffer_load_dwordx4 v14, s[12:15], s22 offen offset:2048 lds
    buffer_load_dwordx4 v15, s[12:15], s22 offen offset:3072 lds
    s_add_u32 s17, s18, 2
    s_and_b32 s17, s17, 3
    s_mul_i32 s70, s17, 57344
    s_add_u32 s70, s70, s23
    s_lshl_b32 s74, s17, 12
    s_add_u32 s74, s74, s16
    s_add_u32 m0, s74, 0
    s_add_u32 s22, s70, 0
    buffer_load_dwordx4 v12, s[12:15], s22 offen offset:0 lds
    buffer_load_dwordx4 v13, s[12:15], s22 offen offset:1024 lds
    buffer_load_dwordx4 v14, s[12:15], s22 offen offset:2048 lds
    buffer_load_dwordx4 v15, s[12:15], s22 offen offset:3072 lds
    s_add_u32 s17, s18, 3
    s_and_b32 s17, s17, 3
    s_mul_i32 s71, s17, 57344
    s_add_u32 s71, s71, s23
    s_lshl_b32 s75, s17, 12
    s_add_u32 s75, s75, s16
    s_add_u32 m0, s75, 0
    s_add_u32 s22, s71, 0
    buffer_load_dwordx4 v12, s[12:15], s22 offen offset:0 lds
    buffer_load_dwordx4 v13, s[12:15], s22 offen offset:1024 lds
    buffer_load_dwordx4 v14, s[12:15], s22 offen offset:2048 lds
    buffer_load_dwordx4 v15, s[12:15], s22 offen offset:3072 lds
    v_lshrrev_b32 v3, 3, v0
    v_and_b32 v4, 7, v0
    v_lshrrev_b32 v5, 1, v3
    v_xor_b32 v4, v4, v5
    v_lshlrev_b32 v3, 10, v3
    v_xor_b32 v5, 0, v4
    v_lshl_add_u32 v8, v5, 4, v3
    v_add_u32 v8, 0, v8
    v_xor_b32 v5, 4, v4
    v_lshl_add_u32 v9, v5, 4, v3
    v_add_u32 v9, 7168, v9
    v_xor_b32 v5, 0, v4
    v_lshl_add_u32 v10, v5, 4, v3
    v_add_u32 v10, 14336, v10
    v_xor_b32 v5, 4, v4
    v_lshl_add_u32 v11, v5, 4, v3
    v_add_u32 v11, 21504, v11
    s_and_b32 s17, s19, 1
    s_lshl_b32 s17, s17, 1
    s_add_u32 s17, s17, s6
    s_lshl_b32 s16, s41, 17
    s_lshl_b32 s8, s17, 15
    s_add_u32 s8, s8, s16
    s_lshl_b32 s10, s17, 12
    s_xor_b32 s17, s17, 2
    s_lshl_b32 s9, s17, 15
    s_add_u32 s9, s9, s16
    s_lshl_b32 s11, s17, 12
    s_mov_b32 s44, s4
    s_and_b32 s45, s5, 0xffff
    s_mov_b32 s46, 2097152
    s_mov_b32 s47, 0x00020000
    s_add_u32 m0, s10, 0
    s_add_u32 s22, s8, 0
    buffer_load_dwordx4 v8, s[44:47], s22 offen offset:0 lds
    buffer_load_dwordx4 v9, s[44:47], s22 offen offset:1024 lds
    buffer_load_dwordx4 v10, s[44:47], s22 offen offset:2048 lds
    buffer_load_dwordx4 v11, s[44:47], s22 offen offset:3072 lds
    s_add_u32 m0, s11, 0
    s_add_u32 s22, s9, 0
    buffer_load_dwordx4 v8, s[44:47], s22 offen offset:0 lds
    buffer_load_dwordx4 v9, s[44:47], s22 offen offset:1024 lds
    buffer_load_dwordx4 v10, s[44:47], s22 offen offset:2048 lds
    buffer_load_dwordx4 v11, s[44:47], s22 offen offset:3072 lds
    s_lshl_b32 s22, s19, 1
    s_add_u32 s22, s22, s6
    s_and_b32 s22, s22, 7
    s_lshl_b32 s23, s22, 14
    s_add_u32 s23, s23, s16
    s_add_u32 m0, s72, 49152
    s_add_u32 s22, s68, 229376
    buffer_load_dwordx4 v12, s[12:15], s22 offen offset:0 lds
    buffer_load_dwordx4 v13, s[12:15], s22 offen offset:1024 lds
    buffer_load_dwordx4 v14, s[12:15], s22 offen offset:2048 lds
    buffer_load_dwordx4 v15, s[12:15], s22 offen offset:3072 lds
    s_add_u32 m0, s10, 49152
    s_add_u32 s22, s8, 128
    buffer_load_dwordx4 v8, s[44:47], s22 offen offset:0 lds
    buffer_load_dwordx4 v9, s[44:47], s22 offen offset:1024 lds
    buffer_load_dwordx4 v10, s[44:47], s22 offen offset:2048 lds
    buffer_load_dwordx4 v11, s[44:47], s22 offen offset:3072 lds
    s_add_u32 m0, s72, 98304
    s_add_u32 s22, s68, 458752
    buffer_load_dwordx4 v12, s[12:15], s22 offen offset:0 lds
    buffer_load_dwordx4 v13, s[12:15], s22 offen offset:1024 lds
    buffer_load_dwordx4 v14, s[12:15], s22 offen offset:2048 lds
    buffer_load_dwordx4 v15, s[12:15], s22 offen offset:3072 lds
    s_add_u32 m0, s10, 98304
    s_add_u32 s22, s8, 256
    buffer_load_dwordx4 v8, s[44:47], s22 offen offset:0 lds
    buffer_load_dwordx4 v9, s[44:47], s22 offen offset:1024 lds
    buffer_load_dwordx4 v10, s[44:47], s22 offen offset:2048 lds
    buffer_load_dwordx4 v11, s[44:47], s22 offen offset:3072 lds
    s_mov_b32 s56, s36
    s_and_b32 s57, s37, 0xffff
    s_mov_b32 s58, 16777216
    s_mov_b32 s59, 0x00020000
    s_mov_b32 s60, s28
    s_and_b32 s61, s29, 0xffff
    s_mov_b32 s62, 1835008
    s_mov_b32 s63, 0x00020000
    s_lshl_b32 s7, s2, 1
    s_add_u32 s7, s7, s6
    v_lshlrev_b32 v2, 4, v0
    s_mov_b32 s77, 0x100000
    v_mov_b32 v20, 0
    v_mov_b32 v21, 0
    v_mov_b32 v22, 0
    v_mov_b32 v23, 0
    s_lshr_b32 s16, s7, 7
    s_lshl_b32 s16, s16, 7
    s_lshr_b32 s17, s7, 3
    s_and_b32 s17, s17, 8
    s_add_u32 s16, s16, s17
    s_add_u32 s16, s16, 16154624
    v_and_b32 v4, 7, v0
    v_lshlrev_b32 v4, 9, v4
    s_waitcnt vmcnt(16)
    s_barrier
    s_add_u32 m0, s73, 49152
    s_add_u32 s22, s69, 229376
    buffer_load_dwordx4 v12, s[12:15], s22 offen offset:0 lds
    buffer_load_dwordx4 v13, s[12:15], s22 offen offset:1024 lds
    buffer_load_dwordx4 v14, s[12:15], s22 offen offset:2048 lds
    buffer_load_dwordx4 v15, s[12:15], s22 offen offset:3072 lds
    s_add_u32 m0, s11, 49152
    s_add_u32 s22, s9, 128
    buffer_load_dwordx4 v8, s[44:47], s22 offen offset:0 lds
    buffer_load_dwordx4 v9, s[44:47], s22 offen offset:1024 lds
    buffer_load_dwordx4 v10, s[44:47], s22 offen offset:2048 lds
    buffer_load_dwordx4 v11, s[44:47], s22 offen offset:3072 lds
    s_add_u32 m0, s74, 49152
    s_add_u32 s22, s70, 229376
    buffer_load_dwordx4 v12, s[12:15], s22 offen offset:0 lds
    buffer_load_dwordx4 v13, s[12:15], s22 offen offset:1024 lds
    buffer_load_dwordx4 v14, s[12:15], s22 offen offset:2048 lds
    buffer_load_dwordx4 v15, s[12:15], s22 offen offset:3072 lds
    s_add_u32 m0, s75, 49152
    s_add_u32 s22, s71, 229376
    buffer_load_dwordx4 v12, s[12:15], s22 offen offset:0 lds
    buffer_load_dwordx4 v13, s[12:15], s22 offen offset:1024 lds
    buffer_load_dwordx4 v14, s[12:15], s22 offen offset:2048 lds
    buffer_load_dwordx4 v15, s[12:15], s22 offen offset:3072 lds
    s_add_u32 m0, s73, 98304
    s_add_u32 s22, s69, 458752
    buffer_load_dwordx4 v12, s[12:15], s22 offen offset:0 lds
    buffer_load_dwordx4 v13, s[12:15], s22 offen offset:1024 lds
    buffer_load_dwordx4 v14, s[12:15], s22 offen offset:2048 lds
    buffer_load_dwordx4 v15, s[12:15], s22 offen offset:3072 lds
    s_add_u32 m0, s11, 98304
    s_add_u32 s22, s9, 256
    buffer_load_dwordx4 v8, s[44:47], s22 offen offset:0 lds
    buffer_load_dwordx4 v9, s[44:47], s22 offen offset:1024 lds
    buffer_load_dwordx4 v10, s[44:47], s22 offen offset:2048 lds
    buffer_load_dwordx4 v11, s[44:47], s22 offen offset:3072 lds
    s_add_u32 m0, s74, 98304
    s_add_u32 s22, s70, 458752
    buffer_load_dwordx4 v12, s[12:15], s22 offen offset:0 lds
    buffer_load_dwordx4 v13, s[12:15], s22 offen offset:1024 lds
    buffer_load_dwordx4 v14, s[12:15], s22 offen offset:2048 lds
    buffer_load_dwordx4 v15, s[12:15], s22 offen offset:3072 lds
    s_add_u32 m0, s75, 98304
    s_add_u32 s22, s71, 458752
    buffer_load_dwordx4 v12, s[12:15], s22 offen offset:0 lds
    buffer_load_dwordx4 v13, s[12:15], s22 offen offset:1024 lds
    buffer_load_dwordx4 v14, s[12:15], s22 offen offset:2048 lds
    buffer_load_dwordx4 v15, s[12:15], s22 offen offset:3072 lds
    s_mul_i32 s22, s39, 28
    s_add_u32 s22, s22, s40
    s_mul_i32 s22, s22, 5120
    s_add_u32 s22, s22, 688128
    v_lshlrev_b32 v2, 4, v0
    s_add_u32 s17, s22, 4096
    buffer_load_dwordx4 v[40:43], v2, s[12:15], s22 offen offset:0
    buffer_load_dwordx4 v[44:47], v2, s[12:15], s22 offen offset:1024
    buffer_load_dwordx4 v[48:51], v2, s[12:15], s22 offen offset:2048
    buffer_load_dwordx4 v[52:55], v2, s[12:15], s22 offen offset:3072
    buffer_load_dwordx4 v[56:59], v2, s[12:15], s17 offen
    s_waitcnt vmcnt(21)
    s_barrier
    s_add_u32 m0, s72, 0
    s_add_u32 s22, s68, 688128
    buffer_load_dwordx4 v12, s[12:15], s22 offen offset:0 lds
    buffer_load_dwordx4 v13, s[12:15], s22 offen offset:1024 lds
    buffer_load_dwordx4 v14, s[12:15], s22 offen offset:2048 lds
    buffer_load_dwordx4 v15, s[12:15], s22 offen offset:3072 lds
    s_add_u32 m0, s10, 0
    s_add_u32 s22, s8, 384
    buffer_load_dwordx4 v8, s[44:47], s22 offen offset:0 lds
    buffer_load_dwordx4 v9, s[44:47], s22 offen offset:1024 lds
    buffer_load_dwordx4 v10, s[44:47], s22 offen offset:2048 lds
    buffer_load_dwordx4 v11, s[44:47], s22 offen offset:3072 lds
    s_add_u32 m0, s73, 0
    s_add_u32 s22, s69, 688128
    buffer_load_dwordx4 v12, s[12:15], s22 offen offset:0 lds
    buffer_load_dwordx4 v13, s[12:15], s22 offen offset:1024 lds
    buffer_load_dwordx4 v14, s[12:15], s22 offen offset:2048 lds
    buffer_load_dwordx4 v15, s[12:15], s22 offen offset:3072 lds
    s_add_u32 m0, s11, 0
    s_add_u32 s22, s9, 384
    buffer_load_dwordx4 v8, s[44:47], s22 offen offset:0 lds
    buffer_load_dwordx4 v9, s[44:47], s22 offen offset:1024 lds
    buffer_load_dwordx4 v10, s[44:47], s22 offen offset:2048 lds
    buffer_load_dwordx4 v11, s[44:47], s22 offen offset:3072 lds
    s_add_u32 m0, s74, 0
    s_add_u32 s22, s70, 688128
    buffer_load_dwordx4 v12, s[12:15], s22 offen offset:0 lds
    buffer_load_dwordx4 v13, s[12:15], s22 offen offset:1024 lds
    buffer_load_dwordx4 v14, s[12:15], s22 offen offset:2048 lds
    buffer_load_dwordx4 v15, s[12:15], s22 offen offset:3072 lds
    s_add_u32 m0, s75, 0
    s_add_u32 s22, s71, 688128
    buffer_load_dwordx4 v12, s[12:15], s22 offen offset:0 lds
    buffer_load_dwordx4 v13, s[12:15], s22 offen offset:1024 lds
    buffer_load_dwordx4 v14, s[12:15], s22 offen offset:2048 lds
    buffer_load_dwordx4 v15, s[12:15], s22 offen offset:3072 lds
    s_mul_i32 s22, s39, 28
    s_add_u32 s22, s22, s40
    s_lshl_b32 s22, s22, 1
    s_add_u32 s22, s22, s6
    s_lshl_b32 s22, s22, 12
    buffer_load_dwordx4 v[24:27], v2, s[60:63], s22 offen offset:0
    buffer_load_dwordx4 v[28:31], v2, s[60:63], s22 offen offset:1024
    buffer_load_dwordx4 v[32:35], v2, s[60:63], s22 offen offset:2048
    buffer_load_dwordx4 v[36:39], v2, s[60:63], s22 offen offset:3072
    s_waitcnt vmcnt(33)
    s_barrier
    s_add_u32 m0, s72, 49152
    s_add_u32 s22, s68, 917504
    buffer_load_dwordx4 v12, s[12:15], s22 offen offset:0 lds
    buffer_load_dwordx4 v13, s[12:15], s22 offen offset:1024 lds
    buffer_load_dwordx4 v14, s[12:15], s22 offen offset:2048 lds
    buffer_load_dwordx4 v15, s[12:15], s22 offen offset:3072 lds
    s_add_u32 m0, s10, 49152
    s_add_u32 s22, s8, 512
    buffer_load_dwordx4 v8, s[44:47], s22 offen offset:0 lds
    buffer_load_dwordx4 v9, s[44:47], s22 offen offset:1024 lds
    buffer_load_dwordx4 v10, s[44:47], s22 offen offset:2048 lds
    buffer_load_dwordx4 v11, s[44:47], s22 offen offset:3072 lds
    s_add_u32 m0, s73, 49152
    s_add_u32 s22, s69, 917504
    buffer_load_dwordx4 v12, s[12:15], s22 offen offset:0 lds
    buffer_load_dwordx4 v13, s[12:15], s22 offen offset:1024 lds
    buffer_load_dwordx4 v14, s[12:15], s22 offen offset:2048 lds
    buffer_load_dwordx4 v15, s[12:15], s22 offen offset:3072 lds
    s_add_u32 m0, s11, 49152
    s_add_u32 s22, s9, 512
    buffer_load_dwordx4 v8, s[44:47], s22 offen offset:0 lds
    buffer_load_dwordx4 v9, s[44:47], s22 offen offset:1024 lds
    buffer_load_dwordx4 v10, s[44:47], s22 offen offset:2048 lds
    buffer_load_dwordx4 v11, s[44:47], s22 offen offset:3072 lds
    s_add_u32 m0, s74, 49152
    s_add_u32 s22, s70, 917504
    buffer_load_dwordx4 v12, s[12:15], s22 offen offset:0 lds
    buffer_load_dwordx4 v13, s[12:15], s22 offen offset:1024 lds
    buffer_load_dwordx4 v14, s[12:15], s22 offen offset:2048 lds
    buffer_load_dwordx4 v15, s[12:15], s22 offen offset:3072 lds
    s_add_u32 m0, s75, 49152
    s_add_u32 s22, s71, 917504
    buffer_load_dwordx4 v12, s[12:15], s22 offen offset:0 lds
    buffer_load_dwordx4 v13, s[12:15], s22 offen offset:1024 lds
    buffer_load_dwordx4 v14, s[12:15], s22 offen offset:2048 lds
    buffer_load_dwordx4 v15, s[12:15], s22 offen offset:3072 lds
    v_lshrrev_b32 v20, 3, v0
    v_and_b32 v21, 7, v0
    v_lshrrev_b32 v22, 1, v20
    v_and_b32 v22, 1, v22
    v_lshlrev_b32 v22, 2, v22
    v_xor_b32 v21, v21, v22
    v_lshlrev_b32 v18, 10, v20
    v_lshl_add_u32 v18, v21, 4, v18
    v_add_u32 v19, 16384, v18
    s_lshr_b32 s17, s40, 2
    s_lshr_b32 s3, s28, 7
    s_sub_u32 s17, s17, s3
    s_add_u32 s17, s17, 4
    s_and_b32 s17, s17, 7
    s_lshl_b32 s17, s17, 7
    s_mul_i32 s3, s6, 1376256
    s_add_u32 s3, s3, s17
    s_sub_u32 s48, 2, s6
    s_lshl_b32 s49, s48, 15
    v_add_u32 v1, s49, v2
    s_mul_i32 s48, s48, 458752
    s_add_u32 s48, s48, s17
    s_mul_i32 s17, s6, 98304
    v_add_u32 v7, s17, v2
    s_lshr_b32 s76, s40, 1
    s_and_b32 s76, s76, 2
    s_add_u32 s76, s76, s40
    s_and_b32 s76, s76, 3
    s_mul_i32 s76, s76, 7
    s_mov_b32 s49, s76
    s_waitcnt vmcnt(28)
    s_barrier
    s_add_u32 m0, s72, 98304
    s_add_u32 s22, s68, 1146880
    buffer_load_dwordx4 v12, s[12:15], s22 offen offset:0 lds
    buffer_load_dwordx4 v13, s[12:15], s22 offen offset:1024 lds
    buffer_load_dwordx4 v14, s[12:15], s22 offen offset:2048 lds
    buffer_load_dwordx4 v15, s[12:15], s22 offen offset:3072 lds
    s_add_u32 m0, s10, 98304
    s_add_u32 s22, s8, 640
    buffer_load_dwordx4 v8, s[44:47], s22 offen offset:0 lds
    buffer_load_dwordx4 v9, s[44:47], s22 offen offset:1024 lds
    buffer_load_dwordx4 v10, s[44:47], s22 offen offset:2048 lds
    buffer_load_dwordx4 v11, s[44:47], s22 offen offset:3072 lds
    s_add_u32 m0, s73, 98304
    s_add_u32 s22, s69, 1146880
    buffer_load_dwordx4 v12, s[12:15], s22 offen offset:0 lds
    buffer_load_dwordx4 v13, s[12:15], s22 offen offset:1024 lds
    buffer_load_dwordx4 v14, s[12:15], s22 offen offset:2048 lds
    buffer_load_dwordx4 v15, s[12:15], s22 offen offset:3072 lds
    s_add_u32 m0, s11, 98304
    s_add_u32 s22, s9, 640
    buffer_load_dwordx4 v8, s[44:47], s22 offen offset:0 lds
    buffer_load_dwordx4 v9, s[44:47], s22 offen offset:1024 lds
    buffer_load_dwordx4 v10, s[44:47], s22 offen offset:2048 lds
    buffer_load_dwordx4 v11, s[44:47], s22 offen offset:3072 lds
    s_add_u32 m0, s74, 98304
    s_add_u32 s22, s70, 1146880
    buffer_load_dwordx4 v12, s[12:15], s22 offen offset:0 lds
    buffer_load_dwordx4 v13, s[12:15], s22 offen offset:1024 lds
    buffer_load_dwordx4 v14, s[12:15], s22 offen offset:2048 lds
    buffer_load_dwordx4 v15, s[12:15], s22 offen offset:3072 lds
    s_add_u32 m0, s75, 98304
    s_add_u32 s22, s71, 1146880
    buffer_load_dwordx4 v12, s[12:15], s22 offen offset:0 lds
    buffer_load_dwordx4 v13, s[12:15], s22 offen offset:1024 lds
    buffer_load_dwordx4 v14, s[12:15], s22 offen offset:2048 lds
    buffer_load_dwordx4 v15, s[12:15], s22 offen offset:3072 lds
    s_waitcnt vmcnt(24)
    s_barrier
    s_add_u32 m0, s72, 0
    s_add_u32 s22, s68, 1376256
    buffer_load_dwordx4 v12, s[12:15], s22 offen offset:0 lds
    buffer_load_dwordx4 v13, s[12:15], s22 offen offset:1024 lds
    buffer_load_dwordx4 v14, s[12:15], s22 offen offset:2048 lds
    buffer_load_dwordx4 v15, s[12:15], s22 offen offset:3072 lds
    s_add_u32 m0, s10, 0
    s_add_u32 s22, s8, 768
    buffer_load_dwordx4 v8, s[44:47], s22 offen offset:0 lds
    buffer_load_dwordx4 v9, s[44:47], s22 offen offset:1024 lds
    buffer_load_dwordx4 v10, s[44:47], s22 offen offset:2048 lds
    buffer_load_dwordx4 v11, s[44:47], s22 offen offset:3072 lds
    s_add_u32 m0, s73, 0
    s_add_u32 s22, s69, 1376256
    buffer_load_dwordx4 v12, s[12:15], s22 offen offset:0 lds
    buffer_load_dwordx4 v13, s[12:15], s22 offen offset:1024 lds
    buffer_load_dwordx4 v14, s[12:15], s22 offen offset:2048 lds
    buffer_load_dwordx4 v15, s[12:15], s22 offen offset:3072 lds
    s_add_u32 m0, s11, 0
    s_add_u32 s22, s9, 768
    buffer_load_dwordx4 v8, s[44:47], s22 offen offset:0 lds
    buffer_load_dwordx4 v9, s[44:47], s22 offen offset:1024 lds
    buffer_load_dwordx4 v10, s[44:47], s22 offen offset:2048 lds
    buffer_load_dwordx4 v11, s[44:47], s22 offen offset:3072 lds
    s_add_u32 m0, s74, 0
    s_add_u32 s22, s70, 1376256
    buffer_load_dwordx4 v12, s[12:15], s22 offen offset:0 lds
    buffer_load_dwordx4 v13, s[12:15], s22 offen offset:1024 lds
    buffer_load_dwordx4 v14, s[12:15], s22 offen offset:2048 lds
    buffer_load_dwordx4 v15, s[12:15], s22 offen offset:3072 lds
    s_add_u32 m0, s75, 0
    s_add_u32 s22, s71, 1376256
    buffer_load_dwordx4 v12, s[12:15], s22 offen offset:0 lds
    buffer_load_dwordx4 v13, s[12:15], s22 offen offset:1024 lds
    buffer_load_dwordx4 v14, s[12:15], s22 offen offset:2048 lds
    buffer_load_dwordx4 v15, s[12:15], s22 offen offset:3072 lds
    s_waitcnt vmcnt(24)
    s_barrier
    s_add_u32 m0, s72, 49152
    s_add_u32 s22, s68, 1605632
    buffer_load_dwordx4 v12, s[12:15], s22 offen offset:0 lds
    buffer_load_dwordx4 v13, s[12:15], s22 offen offset:1024 lds
    buffer_load_dwordx4 v14, s[12:15], s22 offen offset:2048 lds
    buffer_load_dwordx4 v15, s[12:15], s22 offen offset:3072 lds
    s_add_u32 m0, s10, 49152
    s_add_u32 s22, s8, 896
    buffer_load_dwordx4 v8, s[44:47], s22 offen offset:0 lds
    buffer_load_dwordx4 v9, s[44:47], s22 offen offset:1024 lds
    buffer_load_dwordx4 v10, s[44:47], s22 offen offset:2048 lds
    buffer_load_dwordx4 v11, s[44:47], s22 offen offset:3072 lds
    s_add_u32 m0, s73, 49152
    s_add_u32 s22, s69, 1605632
    buffer_load_dwordx4 v12, s[12:15], s22 offen offset:0 lds
    buffer_load_dwordx4 v13, s[12:15], s22 offen offset:1024 lds
    buffer_load_dwordx4 v14, s[12:15], s22 offen offset:2048 lds
    buffer_load_dwordx4 v15, s[12:15], s22 offen offset:3072 lds
    s_add_u32 m0, s11, 49152
    s_add_u32 s22, s9, 896
    buffer_load_dwordx4 v8, s[44:47], s22 offen offset:0 lds
    buffer_load_dwordx4 v9, s[44:47], s22 offen offset:1024 lds
    buffer_load_dwordx4 v10, s[44:47], s22 offen offset:2048 lds
    buffer_load_dwordx4 v11, s[44:47], s22 offen offset:3072 lds
    s_add_u32 m0, s74, 49152
    s_add_u32 s22, s70, 1605632
    buffer_load_dwordx4 v12, s[12:15], s22 offen offset:0 lds
    buffer_load_dwordx4 v13, s[12:15], s22 offen offset:1024 lds
    buffer_load_dwordx4 v14, s[12:15], s22 offen offset:2048 lds
    buffer_load_dwordx4 v15, s[12:15], s22 offen offset:3072 lds
    s_add_u32 m0, s75, 49152
    s_add_u32 s22, s71, 1605632
    buffer_load_dwordx4 v12, s[12:15], s22 offen offset:0 lds
    buffer_load_dwordx4 v13, s[12:15], s22 offen offset:1024 lds
    buffer_load_dwordx4 v14, s[12:15], s22 offen offset:2048 lds
    buffer_load_dwordx4 v15, s[12:15], s22 offen offset:3072 lds
    s_and_b32 s17, s76, 1
    s_lshl_b32 s22, s76, 14
    s_lshl_b32 s17, s17, 13
    s_sub_u32 s22, s22, s17
    s_add_u32 s22, s22, s3
    buffer_load_dwordx4 v[24:27], v18, s[60:63], s22 offen
    s_add_u32 s76, s76, 1
    s_cmp_ge_u32 s76, 28
    s_cselect_b32 s76, 0, s76
    buffer_load_dwordx4 v[28:31], v19, s[60:63], s22 offen
    s_and_b32 s17, s76, 1
    s_lshl_b32 s22, s76, 14
    s_lshl_b32 s17, s17, 13
    s_sub_u32 s22, s22, s17
    s_add_u32 s22, s22, s3
    buffer_load_dwordx4 v[32:35], v18, s[60:63], s22 offen
    s_add_u32 s76, s76, 1
    s_cmp_ge_u32 s76, 28
    s_cselect_b32 s76, 0, s76
    buffer_load_dwordx4 v[36:39], v19, s[60:63], s22 offen
    s_and_b32 s17, s76, 1
    s_lshl_b32 s22, s76, 14
    s_lshl_b32 s17, s17, 13
    s_sub_u32 s22, s22, s17
    s_add_u32 s22, s22, s3
    buffer_load_dwordx4 v[40:43], v18, s[60:63], s22 offen
    s_add_u32 s76, s76, 1
    s_cmp_ge_u32 s76, 28
    s_cselect_b32 s76, 0, s76
    buffer_load_dwordx4 v[44:47], v19, s[60:63], s22 offen
    s_and_b32 s17, s76, 1
    s_lshl_b32 s22, s76, 14
    s_lshl_b32 s17, s17, 13
    s_sub_u32 s22, s22, s17
    s_add_u32 s22, s22, s3
    buffer_load_dwordx4 v[48:51], v18, s[60:63], s22 offen
    s_add_u32 s76, s76, 1
    s_cmp_ge_u32 s76, 28
    s_cselect_b32 s76, 0, s76
    buffer_load_dwordx4 v[52:55], v19, s[60:63], s22 offen
    s_and_b32 s17, s76, 1
    s_lshl_b32 s22, s76, 14
    s_lshl_b32 s17, s17, 13
    s_sub_u32 s22, s22, s17
    s_add_u32 s22, s22, s3
    buffer_load_dwordx4 v[56:59], v18, s[60:63], s22 offen
    s_add_u32 s76, s76, 1
    s_cmp_ge_u32 s76, 28
    s_cselect_b32 s76, 0, s76
    buffer_load_dwordx4 v[60:63], v19, s[60:63], s22 offen
    s_and_b32 s17, s76, 1
    s_lshl_b32 s22, s76, 14
    s_lshl_b32 s17, s17, 13
    s_sub_u32 s22, s22, s17
    s_add_u32 s22, s22, s3
    buffer_load_dwordx4 v[64:67], v18, s[60:63], s22 offen
    s_add_u32 s76, s76, 1
    s_cmp_ge_u32 s76, 28
    s_cselect_b32 s76, 0, s76
    buffer_load_dwordx4 v[68:71], v19, s[60:63], s22 offen
    s_waitcnt vmcnt(36)
    s_barrier
    s_setprio 1
    s_and_b32 s17, s76, 1
    s_lshl_b32 s22, s76, 14
    s_lshl_b32 s17, s17, 13
    s_sub_u32 s22, s22, s17
    s_add_u32 s22, s22, s3
    buffer_load_dwordx4 v[72:75], v18, s[60:63], s22 offen
    s_add_u32 s76, s76, 1
    s_cmp_ge_u32 s76, 28
    s_cselect_b32 s76, 0, s76
    buffer_load_dwordx4 v[76:79], v19, s[60:63], s22 offen
    s_and_b32 s17, s76, 1
    s_lshl_b32 s22, s76, 14
    s_lshl_b32 s17, s17, 13
    s_sub_u32 s22, s22, s17
    s_add_u32 s22, s22, s3
    buffer_load_dwordx4 v[80:83], v18, s[60:63], s22 offen
    s_add_u32 s76, s76, 1
    s_cmp_ge_u32 s76, 28
    s_cselect_b32 s76, 0, s76
    buffer_load_dwordx4 v[84:87], v19, s[60:63], s22 offen
    s_and_b32 s17, s76, 1
    s_lshl_b32 s22, s76, 14
    s_lshl_b32 s17, s17, 13
    s_sub_u32 s22, s22, s17
    s_add_u32 s22, s22, s3
    buffer_load_dwordx4 v[88:91], v18, s[60:63], s22 offen
    s_add_u32 s76, s76, 1
    s_cmp_ge_u32 s76, 28
    s_cselect_b32 s76, 0, s76
    buffer_load_dwordx4 v[92:95], v19, s[60:63], s22 offen
    s_and_b32 s17, s76, 1
    s_lshl_b32 s22, s76, 14
    s_lshl_b32 s17, s17, 13
    s_sub_u32 s22, s22, s17
    s_add_u32 s22, s22, s3
    buffer_load_dwordx4 v[96:99], v18, s[60:63], s22 offen
    s_add_u32 s76, s76, 1
    s_cmp_ge_u32 s76, 28
    s_cselect_b32 s76, 0, s76
    buffer_load_dwordx4 v[100:103], v19, s[60:63], s22 offen
    s_and_b32 s17, s76, 1
    s_lshl_b32 s22, s76, 14
    s_lshl_b32 s17, s17, 13
    s_sub_u32 s22, s22, s17
    s_add_u32 s22, s22, s3
    buffer_load_dwordx4 v[104:107], v18, s[60:63], s22 offen
    s_add_u32 s76, s76, 1
    s_cmp_ge_u32 s76, 28
    s_cselect_b32 s76, 0, s76
    buffer_load_dwordx4 v[108:111], v19, s[60:63], s22 offen
    s_and_b32 s17, s76, 1
    s_lshl_b32 s22, s76, 14
    s_lshl_b32 s17, s17, 13
    s_sub_u32 s22, s22, s17
    s_add_u32 s22, s22, s3
    buffer_load_dwordx4 v[112:115], v18, s[60:63], s22 offen
    s_add_u32 s76, s76, 1
    s_cmp_ge_u32 s76, 28
    s_cselect_b32 s76, 0, s76
    buffer_load_dwordx4 v[116:119], v19, s[60:63], s22 offen
    s_and_b32 s17, s76, 1
    s_lshl_b32 s22, s76, 14
    s_lshl_b32 s17, s17, 13
    s_sub_u32 s22, s22, s17
    s_add_u32 s22, s22, s3
    buffer_load_dwordx4 v[120:123], v18, s[60:63], s22 offen
    s_add_u32 s76, s76, 1
    s_cmp_ge_u32 s76, 28
    s_cselect_b32 s76, 0, s76
    buffer_load_dwordx4 v[124:127], v19, s[60:63], s22 offen
    s_and_b32 s17, s76, 1
    s_lshl_b32 s22, s76, 14
    s_lshl_b32 s17, s17, 13
    s_sub_u32 s22, s22, s17
    s_add_u32 s22, s22, s3
    buffer_load_dwordx4 v[128:131], v18, s[60:63], s22 offen
    s_add_u32 s76, s76, 1
    s_cmp_ge_u32 s76, 28
    s_cselect_b32 s76, 0, s76
    buffer_load_dwordx4 v[132:135], v19, s[60:63], s22 offen
    s_and_b32 s17, s49, 1
    s_lshl_b32 s22, s49, 14
    s_lshl_b32 s17, s17, 13
    s_sub_u32 s22, s22, s17
    s_add_u32 s22, s22, s48
    buffer_load_dwordx4 v[136:139], v18, s[60:63], s22 offen
    s_add_u32 s49, s49, 1
    s_cmp_ge_u32 s49, 28
    s_cselect_b32 s49, 0, s49
    buffer_load_dwordx4 v[140:143], v19, s[60:63], s22 offen
    s_and_b32 s17, s49, 1
    s_lshl_b32 s22, s49, 14
    s_lshl_b32 s17, s17, 13
    s_sub_u32 s22, s22, s17
    s_add_u32 s22, s22, s48
    buffer_load_dwordx4 v[144:147], v18, s[60:63], s22 offen
    s_add_u32 s49, s49, 1
    s_cmp_ge_u32 s49, 28
    s_cselect_b32 s49, 0, s49
    buffer_load_dwordx4 v[148:151], v19, s[60:63], s22 offen
    s_and_b32 s17, s49, 1
    s_lshl_b32 s22, s49, 14
    s_lshl_b32 s17, s17, 13
    s_sub_u32 s22, s22, s17
    s_add_u32 s22, s22, s48
    buffer_load_dwordx4 v[152:155], v18, s[60:63], s22 offen
    s_add_u32 s49, s49, 1
    s_cmp_ge_u32 s49, 28
    s_cselect_b32 s49, 0, s49
    buffer_load_dwordx4 v[156:159], v19, s[60:63], s22 offen
    s_waitcnt vmcnt(34)
    s_barrier
    s_and_b32 s17, s49, 1
    s_lshl_b32 s22, s49, 14
    s_lshl_b32 s17, s17, 13
    s_sub_u32 s22, s22, s17
    s_add_u32 s22, s22, s48
    buffer_load_dwordx4 v[160:163], v18, s[60:63], s22 offen
    s_add_u32 s49, s49, 1
    s_cmp_ge_u32 s49, 28
    s_cselect_b32 s49, 0, s49
    buffer_load_dwordx4 v[164:167], v19, s[60:63], s22 offen
    s_and_b32 s17, s49, 1
    s_lshl_b32 s22, s49, 14
    s_lshl_b32 s17, s17, 13
    s_sub_u32 s22, s22, s17
    s_add_u32 s22, s22, s48
    buffer_load_dwordx4 v[168:171], v18, s[60:63], s22 offen
    s_add_u32 s49, s49, 1
    s_cmp_ge_u32 s49, 28
    s_cselect_b32 s49, 0, s49
    buffer_load_dwordx4 v[172:175], v19, s[60:63], s22 offen
    s_and_b32 s17, s49, 1
    s_lshl_b32 s22, s49, 14
    s_lshl_b32 s17, s17, 13
    s_sub_u32 s22, s22, s17
    s_add_u32 s22, s22, s48
    buffer_load_dwordx4 v[176:179], v18, s[60:63], s22 offen
    s_add_u32 s49, s49, 1
    s_cmp_ge_u32 s49, 28
    s_cselect_b32 s49, 0, s49
    buffer_load_dwordx4 v[180:183], v19, s[60:63], s22 offen
    s_and_b32 s17, s49, 1
    s_lshl_b32 s22, s49, 14
    s_lshl_b32 s17, s17, 13
    s_sub_u32 s22, s22, s17
    s_add_u32 s22, s22, s48
    buffer_load_dwordx4 v[184:187], v18, s[60:63], s22 offen
    s_add_u32 s49, s49, 1
    s_cmp_ge_u32 s49, 28
    s_cselect_b32 s49, 0, s49
    buffer_load_dwordx4 v[188:191], v19, s[60:63], s22 offen
    s_and_b32 s17, s49, 1
    s_lshl_b32 s22, s49, 14
    s_lshl_b32 s17, s17, 13
    s_sub_u32 s22, s22, s17
    s_add_u32 s22, s22, s48
    buffer_load_dwordx4 v[192:195], v18, s[60:63], s22 offen
    s_add_u32 s49, s49, 1
    s_cmp_ge_u32 s49, 28
    s_cselect_b32 s49, 0, s49
    buffer_load_dwordx4 v[196:199], v19, s[60:63], s22 offen
    s_and_b32 s17, s49, 1
    s_lshl_b32 s22, s49, 14
    s_lshl_b32 s17, s17, 13
    s_sub_u32 s22, s22, s17
    s_add_u32 s22, s22, s48
    buffer_load_dwordx4 v[200:203], v18, s[60:63], s22 offen
    s_add_u32 s49, s49, 1
    s_cmp_ge_u32 s49, 28
    s_cselect_b32 s49, 0, s49
    buffer_load_dwordx4 v[204:207], v19, s[60:63], s22 offen
    s_and_b32 s17, s49, 1
    s_lshl_b32 s22, s49, 14
    s_lshl_b32 s17, s17, 13
    s_sub_u32 s22, s22, s17
    s_add_u32 s22, s22, s48
    buffer_load_dwordx4 v[208:211], v18, s[60:63], s22 offen
    s_add_u32 s49, s49, 1
    s_cmp_ge_u32 s49, 28
    s_cselect_b32 s49, 0, s49
    buffer_load_dwordx4 v[212:215], v19, s[60:63], s22 offen
    s_and_b32 s17, s49, 1
    s_lshl_b32 s22, s49, 14
    s_lshl_b32 s17, s17, 13
    s_sub_u32 s22, s22, s17
    s_add_u32 s22, s22, s48
    buffer_load_dwordx4 v[216:219], v18, s[60:63], s22 offen
    s_add_u32 s49, s49, 1
    s_cmp_ge_u32 s49, 28
    s_cselect_b32 s49, 0, s49
    buffer_load_dwordx4 v[220:223], v19, s[60:63], s22 offen
    s_and_b32 s17, s49, 1
    s_lshl_b32 s22, s49, 14
    s_lshl_b32 s17, s17, 13
    s_sub_u32 s22, s22, s17
    s_add_u32 s22, s22, s48
    buffer_load_dwordx4 v[224:227], v18, s[60:63], s22 offen
    s_add_u32 s49, s49, 1
    s_cmp_ge_u32 s49, 28
    s_cselect_b32 s49, 0, s49
    buffer_load_dwordx4 v[228:231], v19, s[60:63], s22 offen
    s_and_b32 s17, s49, 1
    s_lshl_b32 s22, s49, 14
    s_lshl_b32 s17, s17, 13
    s_sub_u32 s22, s22, s17
    s_add_u32 s22, s22, s48
    buffer_load_dwordx4 v[232:235], v18, s[60:63], s22 offen
    s_add_u32 s49, s49, 1
    s_cmp_ge_u32 s49, 28
    s_cselect_b32 s49, 0, s49
    buffer_load_dwordx4 v[236:239], v19, s[60:63], s22 offen
    s_and_b32 s17, s49, 1
    s_lshl_b32 s22, s49, 14
    s_lshl_b32 s17, s17, 13
    s_sub_u32 s22, s22, s17
    s_add_u32 s22, s22, s48
    buffer_load_dwordx4 v[240:243], v18, s[60:63], s22 offen
    s_add_u32 s49, s49, 1
    s_cmp_ge_u32 s49, 28
    s_cselect_b32 s49, 0, s49
    buffer_load_dwordx4 v[244:247], v19, s[60:63], s22 offen
    buffer_load_dwordx2 v[16:17], v4, s[56:59], s16 offen sc1
    s_barrier
    v_mov_b32 v6, 142080
    ds_read_b32 v6, v6
    s_waitcnt vmcnt(55)
    ds_write_b128 v7, v[24:27] offset:0
    ds_write_b128 v7, v[28:31] offset:1024
    s_waitcnt vmcnt(53)
    ds_write_b128 v7, v[32:35] offset:2048
    ds_write_b128 v7, v[36:39] offset:3072
    s_waitcnt vmcnt(51)
    ds_write_b128 v7, v[40:43] offset:4096
    ds_write_b128 v7, v[44:47] offset:5120
    s_waitcnt vmcnt(49)
    ds_write_b128 v7, v[48:51] offset:6144
    ds_write_b128 v7, v[52:55] offset:7168
    s_waitcnt vmcnt(47)
    ds_write_b128 v7, v[56:59] offset:8192
    ds_write_b128 v7, v[60:63] offset:9216
    s_waitcnt vmcnt(45)
    ds_write_b128 v7, v[64:67] offset:10240
    ds_write_b128 v7, v[68:71] offset:11264
    s_waitcnt vmcnt(0)
    s_waitcnt lgkmcnt(0)
    v_readfirstlane_b32 s23, v6
    s_nop 3
    v_cmp_eq_u32 vcc, s23, v16
    v_cmp_eq_u32 s[50:51], s23, v17
    s_nop 3
    s_and_b64 vcc, vcc, s[50:51]
    s_cmp_eq_u64 vcc, exec
    s_cselect_b32 s19, 1, 0
    s_mul_i32 s18, s6, 5376
    s_add_u32 s18, s18, 131072
    v_mov_b32 v20, 0
    v_mov_b32 v21, 0
    v_mov_b32 v22, 0
    v_mov_b32 v23, 0
    v_and_b32 v5, 7, v0
    v_lshrrev_b32 v6, 3, v0
    v_and_b32 v6, 3, v6
    v_min_u32 v5, 6, v5
    v_mul_u32_u24 v6, 1344, v6
    v_lshl_add_u32 v5, v5, 4, v6
    v_add_u32 v5, s18, v5
    ds_write_b128 v5, v[20:23]
    s_lshl_b32 s18, s6, 2
    s_add_u32 s18, s18, 142096
    v_mov_b32 v5, s18
    v_mov_b32 v6, s19
    ds_write_b32 v5, v6
    s_cmp_eq_u32 s19, 0
    s_cbranch_scc1 NOUG
    s_mul_i32 s52, s6, 5376
    s_mul_i32 s53, s7, 4224
    s_add_u32 s53, s53, 8388608
    s_add_u32 m0, s52, 131184
    s_nop 0
    buffer_load_dwordx4 v2, s[56:59], s53 offen sc1 lds
    s_add_u32 s53, s53, 1024
    s_add_u32 m0, s52, 132528
    s_nop 0
    buffer_load_dwordx4 v2, s[56:59], s53 offen sc1 lds
    s_add_u32 s53, s53, 1024
    s_add_u32 m0, s52, 133872
    s_nop 0
    buffer_load_dwordx4 v2, s[56:59], s53 offen sc1 lds
    s_add_u32 s53, s53, 1024
    s_add_u32 m0, s52, 135216
    s_nop 0
    buffer_load_dwordx4 v2, s[56:59], s53 offen sc1 lds
    s_add_u32 s53, s53, 1024
NOUG:
    ds_write_b128 v7, v[72:75] offset:12288
    ds_write_b128 v7, v[76:79] offset:13312
    ds_write_b128 v7, v[80:83] offset:14336
    ds_write_b128 v7, v[84:87] offset:15360
    ds_write_b128 v7, v[88:91] offset:16384
    ds_write_b128 v7, v[92:95] offset:17408
    ds_write_b128 v7, v[96:99] offset:18432
    ds_write_b128 v7, v[100:103] offset:19456
    ds_write_b128 v7, v[104:107] offset:20480
    ds_write_b128 v7, v[108:111] offset:21504
    ds_write_b128 v7, v[112:115] offset:22528
    ds_write_b128 v7, v[116:119] offset:23552
    ds_write_b128 v7, v[120:123] offset:24576
    ds_write_b128 v7, v[124:127] offset:25600
    ds_write_b128 v7, v[128:131] offset:26624
    ds_write_b128 v7, v[132:135] offset:27648
    ds_write_b128 v1, v[136:139] offset:0
    ds_write_b128 v1, v[140:143] offset:1024
    ds_write_b128 v1, v[144:147] offset:2048
    ds_write_b128 v1, v[148:151] offset:3072
    ds_write_b128 v1, v[152:155] offset:4096
    ds_write_b128 v1, v[156:159] offset:5120
    ds_write_b128 v1, v[160:163] offset:6144
    ds_write_b128 v1, v[164:167] offset:7168
    ds_write_b128 v1, v[168:171] offset:8192
    ds_write_b128 v1, v[172:175] offset:9216
    ds_write_b128 v1, v[176:179] offset:10240
    ds_write_b128 v1, v[180:183] offset:11264
    ds_write_b128 v1, v[184:187] offset:12288
    ds_write_b128 v1, v[188:191] offset:13312
    ds_write_b128 v1, v[192:195] offset:14336
    ds_write_b128 v1, v[196:199] offset:15360
    ds_write_b128 v1, v[200:203] offset:16384
    ds_write_b128 v1, v[204:207] offset:17408
    ds_write_b128 v1, v[208:211] offset:18432
    ds_write_b128 v1, v[212:215] offset:19456
    ds_write_b128 v1, v[216:219] offset:20480
    ds_write_b128 v1, v[220:223] offset:21504
    ds_write_b128 v1, v[224:227] offset:22528
    ds_write_b128 v1, v[228:231] offset:23552
    ds_write_b128 v1, v[232:235] offset:24576
    ds_write_b128 v1, v[236:239] offset:25600
    ds_write_b128 v1, v[240:243] offset:26624
    ds_write_b128 v1, v[244:247] offset:27648
    s_waitcnt vmcnt(0) lgkmcnt(0)
    s_branch L_CONVA
L_SPARE:
    s_and_b32 s39, s2, 7
    s_lshr_b32 s40, s2, 3
    s_waitcnt lgkmcnt(0)
    s_mov_b32 s44, s4
    s_and_b32 s45, s5, 0xffff
    s_mov_b32 s46, 2097152
    s_mov_b32 s47, 0x00020000
    s_mov_b32 s56, s36
    s_and_b32 s57, s37, 0xffff
    s_mov_b32 s58, 16777216
    s_mov_b32 s59, 0x00020000
    s_mov_b32 s60, s28
    s_and_b32 s61, s29, 0xffff
    s_mov_b32 s62, 1835008
    s_mov_b32 s63, 0x00020000
    s_mov_b32 s64, s32
    s_and_b32 s65, s33, 0xffff
    s_mov_b32 s66, 2097152
    s_mov_b32 s67, 0x00020000
    s_sub_u32 s68, s40, 28
    s_lshl_b32 s3, s39, 2
    s_add_u32 s3, s3, s68
    s_lshl_b32 s3, s3, 5
    s_add_u32 s3, s3, s38
    s_lshl_b32 s3, s3, 2
    s_add_u32 s3, s3, 16154624
    s_lshl_b32 s68, s68, 2
    s_add_u32 s68, s68, s38
    s_lshr_b32 s69, s68, 1
    s_mov_b32 s74, s39
    v_and_b32 v1, 7, v0
    v_lshrrev_b32 v2, 3, v0
    v_lshlrev_b32 v3, 15, v2
    v_lshl_add_u32 v3, v1, 4, v3
    v_mul_u32_u24 v4, 33792, v1
    v_lshl_add_u32 v4, v2, 4, v4
    v_lshlrev_b32 v5, 4, v1
    v_lshlrev_b32 v6, 2, v0
    s_mov_b32 s70, 0x05040100
    s_mov_b32 s71, 0x07060302
    s_lshl_b32 s72, s69, 7
    v_add_u32 v7, s72, v5
    global_load_dwordx4 v[112:115], v7, s[30:31]
    s_lshl_b32 s73, s68, 1
    s_add_u32 s73, s73, 0
    s_and_b32 s73, s73, 3
    s_lshl_b32 s6, s74, 18
    s_lshl_b32 s75, s73, 10
    s_add_u32 s6, s6, s75
    s_add_u32 s6, s6, s72
    s_mul_i32 s7, s69, 270336
    s_add_u32 s7, s7, s75
    s_lshl_b32 s75, s74, 7
    s_add_u32 s7, s7, s75
    s_add_u32 s7, s7, 8388608
    s_lshl_b32 s8, s74, 8
    s_lshl_b32 s75, s73, 11
    s_add_u32 s8, s8, s75
    s_lshl_b32 s75, s69, 13
    s_add_u32 s8, s8, s75
    s_add_u32 s8, s8, 15728640
    buffer_load_dwordx4 v[16:19], v3, s[44:47], s6 offen
    s_add_u32 s6, s6, 4096
    buffer_load_dwordx4 v[20:23], v3, s[44:47], s6 offen
    s_add_u32 s6, s6, 4096
    buffer_load_dwordx4 v[24:27], v3, s[44:47], s6 offen
    s_add_u32 s6, s6, 4096
    buffer_load_dwordx4 v[28:31], v3, s[44:47], s6 offen
    s_add_u32 s6, s6, 4096
    buffer_load_dwordx4 v[32:35], v3, s[44:47], s6 offen
    s_add_u32 s6, s6, 4096
    buffer_load_dwordx4 v[36:39], v3, s[44:47], s6 offen
    s_add_u32 s6, s6, 4096
    buffer_load_dwordx4 v[40:43], v3, s[44:47], s6 offen
    s_add_u32 s6, s6, 4096
    buffer_load_dwordx4 v[44:47], v3, s[44:47], s6 offen
    s_lshl_b32 s73, s68, 1
    s_add_u32 s73, s73, 1
    s_and_b32 s73, s73, 3
    s_lshl_b32 s10, s74, 18
    s_lshl_b32 s75, s73, 10
    s_add_u32 s10, s10, s75
    s_add_u32 s10, s10, s72
    s_mul_i32 s11, s69, 270336
    s_add_u32 s11, s11, s75
    s_lshl_b32 s75, s74, 7
    s_add_u32 s11, s11, s75
    s_add_u32 s11, s11, 8388608
    s_lshl_b32 s12, s74, 8
    s_lshl_b32 s75, s73, 11
    s_add_u32 s12, s12, s75
    s_lshl_b32 s75, s69, 13
    s_add_u32 s12, s12, s75
    s_add_u32 s12, s12, 15728640
    buffer_load_dwordx4 v[48:51], v3, s[44:47], s10 offen
    s_add_u32 s10, s10, 4096
    buffer_load_dwordx4 v[52:55], v3, s[44:47], s10 offen
    s_add_u32 s10, s10, 4096
    buffer_load_dwordx4 v[56:59], v3, s[44:47], s10 offen
    s_add_u32 s10, s10, 4096
    buffer_load_dwordx4 v[60:63], v3, s[44:47], s10 offen
    s_add_u32 s10, s10, 4096
    buffer_load_dwordx4 v[64:67], v3, s[44:47], s10 offen
    s_add_u32 s10, s10, 4096
    buffer_load_dwordx4 v[68:71], v3, s[44:47], s10 offen
    s_add_u32 s10, s10, 4096
    buffer_load_dwordx4 v[72:75], v3, s[44:47], s10 offen
    s_add_u32 s10, s10, 4096
    buffer_load_dwordx4 v[76:79], v3, s[44:47], s10 offen
    v_mov_b32 v2, 0
    s_waitcnt vmcnt(8)
    v_perm_b32 v80, v20, v16, s70
    v_perm_b32 v81, v28, v24, s70
    v_perm_b32 v82, v36, v32, s70
    v_perm_b32 v83, v44, v40, s70
    buffer_store_dwordx4 v[80:83], v4, s[56:59], s7 offen sc1
    s_add_u32 s7, s7, 4224
    v_perm_b32 v84, v20, v16, s71
    v_perm_b32 v85, v28, v24, s71
    v_perm_b32 v86, v36, v32, s71
    v_perm_b32 v87, v44, v40, s71
    buffer_store_dwordx4 v[84:87], v4, s[56:59], s7 offen sc1
    s_add_u32 s7, s7, 4224
    v_perm_b32 v88, v21, v17, s70
    v_perm_b32 v89, v29, v25, s70
    v_perm_b32 v90, v37, v33, s70
    v_perm_b32 v91, v45, v41, s70
    buffer_store_dwordx4 v[88:91], v4, s[56:59], s7 offen sc1
    s_add_u32 s7, s7, 4224
    v_perm_b32 v92, v21, v17, s71
    v_perm_b32 v93, v29, v25, s71
    v_perm_b32 v94, v37, v33, s71
    v_perm_b32 v95, v45, v41, s71
    buffer_store_dwordx4 v[92:95], v4, s[56:59], s7 offen sc1
    s_add_u32 s7, s7, 4224
    v_perm_b32 v96, v22, v18, s70
    v_perm_b32 v97, v30, v26, s70
    v_perm_b32 v98, v38, v34, s70
    v_perm_b32 v99, v46, v42, s70
    buffer_store_dwordx4 v[96:99], v4, s[56:59], s7 offen sc1
    s_add_u32 s7, s7, 4224
    v_perm_b32 v100, v22, v18, s71
    v_perm_b32 v101, v30, v26, s71
    v_perm_b32 v102, v38, v34, s71
    v_perm_b32 v103, v46, v42, s71
    buffer_store_dwordx4 v[100:103], v4, s[56:59], s7 offen sc1
    s_add_u32 s7, s7, 4224
    v_perm_b32 v104, v23, v19, s70
    v_perm_b32 v105, v31, v27, s70
    v_perm_b32 v106, v39, v35, s70
    v_perm_b32 v107, v47, v43, s70
    buffer_store_dwordx4 v[104:107], v4, s[56:59], s7 offen sc1
    s_add_u32 s7, s7, 4224
    v_perm_b32 v108, v23, v19, s71
    v_perm_b32 v109, v31, v27, s71
    v_perm_b32 v110, v39, v35, s71
    v_perm_b32 v111, v47, v43, s71
    buffer_store_dwordx4 v[108:111], v4, s[56:59], s7 offen sc1
    s_waitcnt vmcnt(8)
    v_perm_b32 v80, v52, v48, s70
    v_perm_b32 v81, v60, v56, s70
    v_perm_b32 v82, v68, v64, s70
    v_perm_b32 v83, v76, v72, s70
    buffer_store_dwordx4 v[80:83], v4, s[56:59], s11 offen sc1
    s_add_u32 s11, s11, 4224
    v_perm_b32 v84, v52, v48, s71
    v_perm_b32 v85, v60, v56, s71
    v_perm_b32 v86, v68, v64, s71
    v_perm_b32 v87, v76, v72, s71
    buffer_store_dwordx4 v[84:87], v4, s[56:59], s11 offen sc1
    s_add_u32 s11, s11, 4224
    v_perm_b32 v88, v53, v49, s70
    v_perm_b32 v89, v61, v57, s70
    v_perm_b32 v90, v69, v65, s70
    v_perm_b32 v91, v77, v73, s70
    buffer_store_dwordx4 v[88:91], v4, s[56:59], s11 offen sc1
    s_add_u32 s11, s11, 4224
    v_perm_b32 v92, v53, v49, s71
    v_perm_b32 v93, v61, v57, s71
    v_perm_b32 v94, v69, v65, s71
    v_perm_b32 v95, v77, v73, s71
    buffer_store_dwordx4 v[92:95], v4, s[56:59], s11 offen sc1
    s_add_u32 s11, s11, 4224
    v_perm_b32 v96, v54, v50, s70
    v_perm_b32 v97, v62, v58, s70
    v_perm_b32 v98, v70, v66, s70
    v_perm_b32 v99, v78, v74, s70
    buffer_store_dwordx4 v[96:99], v4, s[56:59], s11 offen sc1
    s_add_u32 s11, s11, 4224
    v_perm_b32 v100, v54, v50, s71
    v_perm_b32 v101, v62, v58, s71
    v_perm_b32 v102, v70, v66, s71
    v_perm_b32 v103, v78, v74, s71
    buffer_store_dwordx4 v[100:103], v4, s[56:59], s11 offen sc1
    s_add_u32 s11, s11, 4224
    v_perm_b32 v104, v55, v51, s70
    v_perm_b32 v105, v63, v59, s70
    v_perm_b32 v106, v71, v67, s70
    v_perm_b32 v107, v79, v75, s70
    buffer_store_dwordx4 v[104:107], v4, s[56:59], s11 offen sc1
    s_add_u32 s11, s11, 4224
    v_perm_b32 v108, v55, v51, s71
    v_perm_b32 v109, v63, v59, s71
    v_perm_b32 v110, v71, v67, s71
    v_perm_b32 v111, v79, v75, s71
    buffer_store_dwordx4 v[108:111], v4, s[56:59], s11 offen sc1
    global_load_dword v3, v2, s[34:35] sc1
    s_barrier
    v_mov_b32 v120, 0
    v_mov_b32 v121, 0
    v_mov_b32 v122, 0
    v_mov_b32 v123, 0
    v_mov_b32 v124, 0
    v_mov_b32 v125, 0
    v_mov_b32 v126, 0
    v_mov_b32 v127, 0
    v_dot2c_f32_bf16 v120, v16, v112
    v_dot2c_f32_bf16 v121, v20, v112
    v_dot2c_f32_bf16 v122, v24, v112
    v_dot2c_f32_bf16 v123, v28, v112
    v_dot2c_f32_bf16 v124, v32, v112
    v_dot2c_f32_bf16 v125, v36, v112
    v_dot2c_f32_bf16 v126, v40, v112
    v_dot2c_f32_bf16 v127, v44, v112
    v_dot2c_f32_bf16 v120, v17, v113
    v_dot2c_f32_bf16 v121, v21, v113
    v_dot2c_f32_bf16 v122, v25, v113
    v_dot2c_f32_bf16 v123, v29, v113
    v_dot2c_f32_bf16 v124, v33, v113
    v_dot2c_f32_bf16 v125, v37, v113
    v_dot2c_f32_bf16 v126, v41, v113
    v_dot2c_f32_bf16 v127, v45, v113
    v_dot2c_f32_bf16 v120, v18, v114
    v_dot2c_f32_bf16 v121, v22, v114
    v_dot2c_f32_bf16 v122, v26, v114
    v_dot2c_f32_bf16 v123, v30, v114
    v_dot2c_f32_bf16 v124, v34, v114
    v_dot2c_f32_bf16 v125, v38, v114
    v_dot2c_f32_bf16 v126, v42, v114
    v_dot2c_f32_bf16 v127, v46, v114
    v_dot2c_f32_bf16 v120, v19, v115
    v_dot2c_f32_bf16 v121, v23, v115
    v_dot2c_f32_bf16 v122, v27, v115
    v_dot2c_f32_bf16 v123, v31, v115
    v_dot2c_f32_bf16 v124, v35, v115
    v_dot2c_f32_bf16 v125, v39, v115
    v_dot2c_f32_bf16 v126, v43, v115
    v_dot2c_f32_bf16 v127, v47, v115
    s_nop 3
    v_add_f32_dpp v120, v120, v120 quad_perm:[1,0,3,2] row_mask:0xf bank_mask:0xf
    v_add_f32_dpp v121, v121, v121 quad_perm:[1,0,3,2] row_mask:0xf bank_mask:0xf
    v_add_f32_dpp v122, v122, v122 quad_perm:[1,0,3,2] row_mask:0xf bank_mask:0xf
    v_add_f32_dpp v123, v123, v123 quad_perm:[1,0,3,2] row_mask:0xf bank_mask:0xf
    v_add_f32_dpp v124, v124, v124 quad_perm:[1,0,3,2] row_mask:0xf bank_mask:0xf
    v_add_f32_dpp v125, v125, v125 quad_perm:[1,0,3,2] row_mask:0xf bank_mask:0xf
    v_add_f32_dpp v126, v126, v126 quad_perm:[1,0,3,2] row_mask:0xf bank_mask:0xf
    v_add_f32_dpp v127, v127, v127 quad_perm:[1,0,3,2] row_mask:0xf bank_mask:0xf
    v_add_f32_dpp v120, v120, v120 quad_perm:[2,3,0,1] row_mask:0xf bank_mask:0xf
    v_add_f32_dpp v121, v121, v121 quad_perm:[2,3,0,1] row_mask:0xf bank_mask:0xf
    v_add_f32_dpp v122, v122, v122 quad_perm:[2,3,0,1] row_mask:0xf bank_mask:0xf
    v_add_f32_dpp v123, v123, v123 quad_perm:[2,3,0,1] row_mask:0xf bank_mask:0xf
    v_add_f32_dpp v124, v124, v124 quad_perm:[2,3,0,1] row_mask:0xf bank_mask:0xf
    v_add_f32_dpp v125, v125, v125 quad_perm:[2,3,0,1] row_mask:0xf bank_mask:0xf
    v_add_f32_dpp v126, v126, v126 quad_perm:[2,3,0,1] row_mask:0xf bank_mask:0xf
    v_add_f32_dpp v127, v127, v127 quad_perm:[2,3,0,1] row_mask:0xf bank_mask:0xf
    v_add_f32_dpp v120, v120, v120 row_half_mirror row_mask:0xf bank_mask:0xf
    v_add_f32_dpp v121, v121, v121 row_half_mirror row_mask:0xf bank_mask:0xf
    v_add_f32_dpp v122, v122, v122 row_half_mirror row_mask:0xf bank_mask:0xf
    v_add_f32_dpp v123, v123, v123 row_half_mirror row_mask:0xf bank_mask:0xf
    v_add_f32_dpp v124, v124, v124 row_half_mirror row_mask:0xf bank_mask:0xf
    v_add_f32_dpp v125, v125, v125 row_half_mirror row_mask:0xf bank_mask:0xf
    v_add_f32_dpp v126, v126, v126 row_half_mirror row_mask:0xf bank_mask:0xf
    v_add_f32_dpp v127, v127, v127 row_half_mirror row_mask:0xf bank_mask:0xf
    v_cmp_eq_u32 vcc, 1, v1
    s_nop 1
    v_cndmask_b32 v120, v120, v121, vcc
    v_cmp_eq_u32 vcc, 2, v1
    s_nop 1
    v_cndmask_b32 v120, v120, v122, vcc
    v_cmp_eq_u32 vcc, 3, v1
    s_nop 1
    v_cndmask_b32 v120, v120, v123, vcc
    v_cmp_eq_u32 vcc, 4, v1
    s_nop 1
    v_cndmask_b32 v120, v120, v124, vcc
    v_cmp_eq_u32 vcc, 5, v1
    s_nop 1
    v_cndmask_b32 v120, v120, v125, vcc
    v_cmp_eq_u32 vcc, 6, v1
    s_nop 1
    v_cndmask_b32 v120, v120, v126, vcc
    v_cmp_eq_u32 vcc, 7, v1
    s_nop 1
    v_cndmask_b32 v120, v120, v127, vcc
    s_waitcnt vmcnt(0)
    s_mov_b32 s77, 0x100000
    s_branch NS_CHK
NS_SPIN:
    s_sleep 8
    global_load_dword v3, v2, s[34:35] sc1
    s_waitcnt vmcnt(0)
    s_sub_u32 s77, s77, 1
    s_cmp_eq_u32 s77, 0
    s_cbranch_scc1 NS_OK
NS_CHK:
    v_cmp_ne_u32 vcc, 0, v3
    s_nop 3
    s_cmp_eq_u64 vcc, exec
    s_cbranch_scc0 NS_SPIN
NS_OK:
    v_readfirstlane_b32 s23, v3
    s_nop 3
    s_mov_b32 s76, s23
    s_mov_b64 exec, 1
    buffer_store_dword v3, v2, s[56:59], s3 offen sc1
    s_mov_b64 exec, -1
    v_mov_b32 v80, 0
    v_mov_b32 v81, 0
    v_mov_b32 v82, 0
    v_mov_b32 v83, 0
    v_mov_b32 v84, 0
    v_mov_b32 v85, 0
    v_mov_b32 v86, 0
    v_mov_b32 v87, 0
    v_dot2c_f32_bf16 v80, v48, v112
    v_dot2c_f32_bf16 v81, v52, v112
    v_dot2c_f32_bf16 v82, v56, v112
    v_dot2c_f32_bf16 v83, v60, v112
    v_dot2c_f32_bf16 v84, v64, v112
    v_dot2c_f32_bf16 v85, v68, v112
    v_dot2c_f32_bf16 v86, v72, v112
    v_dot2c_f32_bf16 v87, v76, v112
    v_dot2c_f32_bf16 v80, v49, v113
    v_dot2c_f32_bf16 v81, v53, v113
    v_dot2c_f32_bf16 v82, v57, v113
    v_dot2c_f32_bf16 v83, v61, v113
    v_dot2c_f32_bf16 v84, v65, v113
    v_dot2c_f32_bf16 v85, v69, v113
    v_dot2c_f32_bf16 v86, v73, v113
    v_dot2c_f32_bf16 v87, v77, v113
    v_dot2c_f32_bf16 v80, v50, v114
    v_dot2c_f32_bf16 v81, v54, v114
    v_dot2c_f32_bf16 v82, v58, v114
    v_dot2c_f32_bf16 v83, v62, v114
    v_dot2c_f32_bf16 v84, v66, v114
    v_dot2c_f32_bf16 v85, v70, v114
    v_dot2c_f32_bf16 v86, v74, v114
    v_dot2c_f32_bf16 v87, v78, v114
    v_dot2c_f32_bf16 v80, v51, v115
    v_dot2c_f32_bf16 v81, v55, v115
    v_dot2c_f32_bf16 v82, v59, v115
    v_dot2c_f32_bf16 v83, v63, v115
    v_dot2c_f32_bf16 v84, v67, v115
    v_dot2c_f32_bf16 v85, v71, v115
    v_dot2c_f32_bf16 v86, v75, v115
    v_dot2c_f32_bf16 v87, v79, v115
    s_nop 3
    v_add_f32_dpp v80, v80, v80 quad_perm:[1,0,3,2] row_mask:0xf bank_mask:0xf
    v_add_f32_dpp v81, v81, v81 quad_perm:[1,0,3,2] row_mask:0xf bank_mask:0xf
    v_add_f32_dpp v82, v82, v82 quad_perm:[1,0,3,2] row_mask:0xf bank_mask:0xf
    v_add_f32_dpp v83, v83, v83 quad_perm:[1,0,3,2] row_mask:0xf bank_mask:0xf
    v_add_f32_dpp v84, v84, v84 quad_perm:[1,0,3,2] row_mask:0xf bank_mask:0xf
    v_add_f32_dpp v85, v85, v85 quad_perm:[1,0,3,2] row_mask:0xf bank_mask:0xf
    v_add_f32_dpp v86, v86, v86 quad_perm:[1,0,3,2] row_mask:0xf bank_mask:0xf
    v_add_f32_dpp v87, v87, v87 quad_perm:[1,0,3,2] row_mask:0xf bank_mask:0xf
    v_add_f32_dpp v80, v80, v80 quad_perm:[2,3,0,1] row_mask:0xf bank_mask:0xf
    v_add_f32_dpp v81, v81, v81 quad_perm:[2,3,0,1] row_mask:0xf bank_mask:0xf
    v_add_f32_dpp v82, v82, v82 quad_perm:[2,3,0,1] row_mask:0xf bank_mask:0xf
    v_add_f32_dpp v83, v83, v83 quad_perm:[2,3,0,1] row_mask:0xf bank_mask:0xf
    v_add_f32_dpp v84, v84, v84 quad_perm:[2,3,0,1] row_mask:0xf bank_mask:0xf
    v_add_f32_dpp v85, v85, v85 quad_perm:[2,3,0,1] row_mask:0xf bank_mask:0xf
    v_add_f32_dpp v86, v86, v86 quad_perm:[2,3,0,1] row_mask:0xf bank_mask:0xf
    v_add_f32_dpp v87, v87, v87 quad_perm:[2,3,0,1] row_mask:0xf bank_mask:0xf
    v_add_f32_dpp v80, v80, v80 row_half_mirror row_mask:0xf bank_mask:0xf
    v_add_f32_dpp v81, v81, v81 row_half_mirror row_mask:0xf bank_mask:0xf
    v_add_f32_dpp v82, v82, v82 row_half_mirror row_mask:0xf bank_mask:0xf
    v_add_f32_dpp v83, v83, v83 row_half_mirror row_mask:0xf bank_mask:0xf
    v_add_f32_dpp v84, v84, v84 row_half_mirror row_mask:0xf bank_mask:0xf
    v_add_f32_dpp v85, v85, v85 row_half_mirror row_mask:0xf bank_mask:0xf
    v_add_f32_dpp v86, v86, v86 row_half_mirror row_mask:0xf bank_mask:0xf
    v_add_f32_dpp v87, v87, v87 row_half_mirror row_mask:0xf bank_mask:0xf
    v_cmp_eq_u32 vcc, 1, v1
    s_nop 1
    v_cndmask_b32 v80, v80, v81, vcc
    v_cmp_eq_u32 vcc, 2, v1
    s_nop 1
    v_cndmask_b32 v80, v80, v82, vcc
    v_cmp_eq_u32 vcc, 3, v1
    s_nop 1
    v_cndmask_b32 v80, v80, v83, vcc
    v_cmp_eq_u32 vcc, 4, v1
    s_nop 1
    v_cndmask_b32 v80, v80, v84, vcc
    v_cmp_eq_u32 vcc, 5, v1
    s_nop 1
    v_cndmask_b32 v80, v80, v85, vcc
    v_cmp_eq_u32 vcc, 6, v1
    s_nop 1
    v_cndmask_b32 v80, v80, v86, vcc
    v_cmp_eq_u32 vcc, 7, v1
    s_nop 1
    v_cndmask_b32 v80, v80, v87, vcc
    buffer_store_dword v120, v6, s[56:59], s8 offen sc1
    buffer_store_dword v80, v6, s[56:59], s12 offen sc1
    s_add_u32 s3, s3, 8192
    s_waitcnt vmcnt(0)
    s_mov_b64 exec, 1
    buffer_store_dword v3, v2, s[56:59], s3 offen sc1
    s_mov_b64 exec, -1
    s_sub_u32 s3, s3, 16162816
    s_lshl_b32 s3, s3, 5
    s_add_u32 s3, s3, 16252928
    s_lshl_b32 s6, s39, 2
    s_and_b32 s13, s40, 3
    s_add_u32 s6, s6, s13
    s_lshr_b32 s7, s40, 2
    s_lshr_b32 s13, s28, 7
    s_sub_u32 s7, s7, s13
    s_add_u32 s7, s7, 4
    s_and_b32 s7, s7, 7
    s_lshl_b32 s17, s6, 6
    s_lshr_b32 s23, s38, 1
    s_lshl_b32 s13, s23, 5
    s_add_u32 s17, s17, s13
    s_lshl_b32 s18, s7, 6
    s_and_b32 s14, s38, 1
    s_lshl_b32 s13, s14, 5
    s_add_u32 s18, s18, s13
    v_lshrrev_b32 v5, 5, v0
    v_and_b32 v6, 31, v0
    v_add_u32 v6, s17, v6
    v_lshlrev_b32 v7, 4, v5
    v_add_u32 v7, s18, v7
    v_lshlrev_b32 v7, 1, v7
    v_lshl_add_u32 v116, v6, 10, v7
    s_lshl_b32 s8, s38, 15
    s_lshl_b32 s9, s6, 1
    s_add_u32 s9, s9, s23
    s_mul_i32 s9, s9, 112
    s_mul_i32 s13, s38, 28
    s_add_u32 s9, s9, s13
    s_lshl_b32 s9, s9, 10
    s_mul_i32 s22, s23, 229376
    s_sub_u32 s22, 114688, s22
    s_lshl_b32 s10, s13, 14
    s_lshl_b32 s13, s7, 7
    s_add_u32 s10, s10, s13
    s_lshr_b32 s12, s40, 1
    s_and_b32 s12, s12, 2
    s_add_u32 s12, s12, s40
    s_and_b32 s12, s12, 3
    s_mul_i32 s12, s12, 7
    s_add_u32 s11, s12, 14
    s_cmp_ge_u32 s11, 28
    s_cselect_b32 s13, 28, 0
    s_sub_u32 s11, s11, s13
    s_lshl_b32 s15, s6, 5
    s_mul_i32 s13, s38, 7
    s_add_u32 s15, s15, s13
    s_lshl_b32 s15, s15, 7
    s_add_u32 s15, s15, 15990784
    s_lshl_b32 s13, s7, 2
    s_add_u32 s13, s13, s38
    s_lshl_b32 s16, s13, 10
    s_add_u32 s16, s16, 16121856
    s_mul_i32 s19, s13, 67584
    s_lshl_b32 s13, s6, 7
    s_add_u32 s19, s19, s13
    s_add_u32 s19, s19, 11010048
    v_lshlrev_b32 v1, 4, v0
    v_lshrrev_b32 v2, 3, v0
    v_and_b32 v3, 7, v0
    v_mul_u32_u24 v120, 4224, v2
    v_lshl_add_u32 v120, v3, 4, v120
    v_lshrrev_b32 v4, 1, v2
    v_and_b32 v4, 1, v4
    v_lshlrev_b32 v4, 2, v4
    v_xor_b32 v3, v3, v4
    v_lshlrev_b32 v112, 10, v2
    v_lshl_add_u32 v112, v3, 4, v112
    v_add_u32 v113, 15360, v112
    v_lshlrev_b32 v121, 7, v2
    v_lshl_add_u32 v121, v3, 4, v121
    v_add_u32 v121, s8, v121
    v_lshrrev_b32 v2, 2, v0
    v_and_b32 v2, 3, v2
    v_and_b32 v3, 3, v0
    v_lshrrev_b32 v4, 4, v0
    v_and_b32 v4, 1, v4
    v_lshl_add_u32 v6, v5, 2, v2
    v_lshlrev_b32 v6, 7, v6
    v_and_b32 v7, 1, v3
    v_lshl_add_u32 v6, v7, 5, v6
    v_lshl_add_u32 v6, v4, 4, v6
    v_lshrrev_b32 v7, 1, v3
    v_lshl_add_u32 v6, v7, 3, v6
    v_add_u32 v6, s8, v6
    v_lshrrev_b32 v7, 1, v2
    v_xor_b32 v7, s14, v7
    v_lshl_add_u32 v114, v7, 6, v6
    v_xor_b32 v7, 1, v7
    v_lshl_add_u32 v115, v7, 6, v6
    s_lshl_b32 s13, s14, 1
    v_add_u32 v6, s13, v5
    v_lshlrev_b32 v122, 15, v6
    v_lshl_add_u32 v122, v2, 7, v122
    v_lshrrev_b32 v7, 1, v2
    v_xor_b32 v7, s23, v7
    v_lshl_add_u32 v122, v7, 6, v122
    v_lshl_add_u32 v122, v4, 5, v122
    v_lshl_add_u32 v122, v3, 3, v122
    v_min_u32 v117, 6, v0
    v_lshlrev_b32 v117, 7, v117
    v_lshrrev_b32 v2, 2, v0
    v_and_b32 v2, 7, v2
    v_lshlrev_b32 v118, 7, v2
    v_lshl_add_u32 v118, v3, 2, v118
    v_and_b32 v119, 31, v0
    s_lshl_b32 s13, s23, 5
    v_add_u32 v119, s13, v119
    v_lshlrev_b32 v119, 2, v119
    v_add_u32 v119, 141824, v119
    v_add_u32 v123, s8, v1
    s_xor_b32 s13, s38, 1
    s_lshl_b32 s13, s13, 15
    v_add_u32 v126, s13, v1
    s_xor_b32 s13, s38, 2
    s_lshl_b32 s13, s13, 15
    v_add_u32 v124, s13, v1
    s_xor_b32 s13, s38, 3
    s_lshl_b32 s13, s13, 15
    v_add_u32 v125, s13, v1
    s_mov_b32 s23, s76
    s_waitcnt vmcnt(0)
    s_branch L_GEMM2
L_GEMM1:
    s_lshr_b32 s68, s38, 1
    s_and_b32 s69, s38, 1
    v_and_b32 v7, 15, v0
    v_lshrrev_b32 v2, 4, v0
    v_lshrrev_b32 v3, 1, v7
    s_lshl_b32 s70, s68, 13
    v_lshlrev_b32 v4, 7, v7
    v_add_u32 v4, s70, v4
    v_lshlrev_b32 v34, 9, v2
    v_lshl_add_u32 v34, v7, 4, v34
    v_add_u32 v5, 0, v2
    v_xor_b32 v5, v5, v3
    v_lshl_add_u32 v16, v5, 4, v4
    v_add_u32 v5, 4, v2
    v_xor_b32 v5, v5, v3
    v_lshl_add_u32 v17, v5, 4, v4
    v_lshrrev_b32 v7, 2, v0
    v_and_b32 v7, 3, v7
    v_and_b32 v3, 3, v0
    v_lshl_add_u32 v5, v2, 3, v7
    v_lshlrev_b32 v5, 8, v5
    v_lshl_add_u32 v5, v3, 3, v5
    v_and_b32 v4, 1, v2
    v_lshl_add_u32 v4, v7, 1, v4
    s_lshl_b32 s70, s69, 2
    s_add_u32 s71, s70, 0
    v_xor_b32 v6, s71, v4
    v_lshl_add_u32 v22, v6, 5, v5
    s_add_u32 s71, s70, 1
    v_xor_b32 v6, s71, v4
    v_lshl_add_u32 v23, v6, 5, v5
    s_add_u32 s71, s70, 2
    v_xor_b32 v6, s71, v4
    v_lshl_add_u32 v24, v6, 5, v5
    s_add_u32 s71, s70, 3
    v_xor_b32 v6, s71, v4
    v_lshl_add_u32 v25, v6, 5, v5
    v_add_u32 v18, 49152, v16
    v_add_u32 v19, 49152, v17
    v_add_u32 v26, 49152, v22
    v_add_u32 v27, 49152, v23
    v_add_u32 v28, 49152, v24
    v_add_u32 v29, 49152, v25
    v_add_u32 v20, 98304, v16
    v_add_u32 v21, 98304, v17
    v_add_u32 v30, 98304, v22
    v_add_u32 v31, 98304, v23
    v_add_u32 v32, 98304, v24
    v_add_u32 v33, 98304, v25
    s_waitcnt lgkmcnt(0)
    s_barrier
    ds_read_b128 v[40:43], v16 offset:0
    ds_read_b64_tr_b16 v[72:73], v22 offset:16384
    ds_read_b64_tr_b16 v[74:75], v22 offset:17408
    ds_read_b128 v[44:47], v16 offset:2048
    ds_read_b128 v[48:51], v16 offset:4096
    ds_read_b128 v[52:55], v16 offset:6144
    ds_read_b64_tr_b16 v[76:77], v22 offset:32768
    ds_read_b64_tr_b16 v[78:79], v22 offset:33792
    ds_read_b64_tr_b16 v[80:81], v23 offset:16384
    ds_read_b64_tr_b16 v[82:83], v23 offset:17408
    ds_read_b64_tr_b16 v[84:85], v23 offset:32768
    ds_read_b64_tr_b16 v[86:87], v23 offset:33792
    ds_read_b64_tr_b16 v[88:89], v24 offset:16384
    ds_read_b64_tr_b16 v[90:91], v24 offset:17408
    ds_read_b64_tr_b16 v[92:93], v24 offset:32768
    ds_read_b64_tr_b16 v[94:95], v24 offset:33792
    ds_read_b64_tr_b16 v[96:97], v25 offset:16384
    ds_read_b64_tr_b16 v[98:99], v25 offset:17408
    ds_read_b64_tr_b16 v[100:101], v25 offset:32768
    ds_read_b64_tr_b16 v[102:103], v25 offset:33792
    s_waitcnt lgkmcnt(14)
    v_mfma_f32_16x16x32_bf16 v[128:131], v[72:75], v[40:43], 0
    ds_read_b64_tr_b16 v[104:105], v22 offset:24576
    v_mfma_f32_16x16x32_bf16 v[132:135], v[72:75], v[44:47], 0
    ds_read_b64_tr_b16 v[106:107], v22 offset:25600
    v_mfma_f32_16x16x32_bf16 v[136:139], v[72:75], v[48:51], 0
    ds_read_b128 v[56:59], v17 offset:0
    v_mfma_f32_16x16x32_bf16 v[140:143], v[72:75], v[52:55], 0
    s_waitcnt lgkmcnt(14)
    v_mfma_f32_16x16x32_bf16 v[192:195], v[76:79], v[40:43], 0
    ds_read_b64_tr_b16 v[108:109], v22 offset:40960
    v_mfma_f32_16x16x32_bf16 v[196:199], v[76:79], v[44:47], 0
    ds_read_b64_tr_b16 v[110:111], v22 offset:41984
    v_mfma_f32_16x16x32_bf16 v[200:203], v[76:79], v[48:51], 0
    ds_read_b128 v[60:63], v17 offset:2048
    v_mfma_f32_16x16x32_bf16 v[204:207], v[76:79], v[52:55], 0
    s_waitcnt lgkmcnt(14)
    v_mfma_f32_16x16x32_bf16 v[144:147], v[80:83], v[40:43], 0
    ds_read_b64_tr_b16 v[72:73], v23 offset:24576
    v_mfma_f32_16x16x32_bf16 v[148:151], v[80:83], v[44:47], 0
    ds_read_b64_tr_b16 v[74:75], v23 offset:25600
    v_mfma_f32_16x16x32_bf16 v[152:155], v[80:83], v[48:51], 0
    ds_read_b128 v[64:67], v17 offset:4096
    v_mfma_f32_16x16x32_bf16 v[156:159], v[80:83], v[52:55], 0
    v_mfma_f32_16x16x32_bf16 v[208:211], v[84:87], v[40:43], 0
    ds_read_b64_tr_b16 v[76:77], v23 offset:40960
    v_mfma_f32_16x16x32_bf16 v[212:215], v[84:87], v[44:47], 0
    ds_read_b64_tr_b16 v[78:79], v23 offset:41984
    v_mfma_f32_16x16x32_bf16 v[216:219], v[84:87], v[48:51], 0
    ds_read_b128 v[68:71], v17 offset:6144
    v_mfma_f32_16x16x32_bf16 v[220:223], v[84:87], v[52:55], 0
    s_waitcnt lgkmcnt(14)
    v_mfma_f32_16x16x32_bf16 v[160:163], v[88:91], v[40:43], 0
    ds_read_b64_tr_b16 v[80:81], v24 offset:24576
    v_mfma_f32_16x16x32_bf16 v[164:167], v[88:91], v[44:47], 0
    ds_read_b64_tr_b16 v[82:83], v24 offset:25600
    v_mfma_f32_16x16x32_bf16 v[168:171], v[88:91], v[48:51], 0
    v_mfma_f32_16x16x32_bf16 v[172:175], v[88:91], v[52:55], 0
    v_mfma_f32_16x16x32_bf16 v[224:227], v[92:95], v[40:43], 0
    ds_read_b64_tr_b16 v[84:85], v24 offset:40960
    v_mfma_f32_16x16x32_bf16 v[228:231], v[92:95], v[44:47], 0
    ds_read_b64_tr_b16 v[86:87], v24 offset:41984
    v_mfma_f32_16x16x32_bf16 v[232:235], v[92:95], v[48:51], 0
    v_mfma_f32_16x16x32_bf16 v[236:239], v[92:95], v[52:55], 0
    v_mfma_f32_16x16x32_bf16 v[176:179], v[96:99], v[40:43], 0
    ds_read_b64_tr_b16 v[88:89], v25 offset:24576
    v_mfma_f32_16x16x32_bf16 v[180:183], v[96:99], v[44:47], 0
    ds_read_b64_tr_b16 v[90:91], v25 offset:25600
    v_mfma_f32_16x16x32_bf16 v[184:187], v[96:99], v[48:51], 0
    v_mfma_f32_16x16x32_bf16 v[188:191], v[96:99], v[52:55], 0
    s_waitcnt lgkmcnt(14)
    v_mfma_f32_16x16x32_bf16 v[240:243], v[100:103], v[40:43], 0
    ds_read_b64_tr_b16 v[92:93], v25 offset:40960
    v_mfma_f32_16x16x32_bf16 v[244:247], v[100:103], v[44:47], 0
    ds_read_b64_tr_b16 v[94:95], v25 offset:41984
    v_mfma_f32_16x16x32_bf16 v[248:251], v[100:103], v[48:51], 0
    v_mfma_f32_16x16x32_bf16 v[252:255], v[100:103], v[52:55], 0
    v_mfma_f32_16x16x32_bf16 v[128:131], v[104:107], v[56:59], v[128:131]
    s_waitcnt lgkmcnt(14)
    v_mfma_f32_16x16x32_bf16 v[132:135], v[104:107], v[60:63], v[132:135]
    s_waitcnt lgkmcnt(11)
    v_mfma_f32_16x16x32_bf16 v[136:139], v[104:107], v[64:67], v[136:139]
    s_waitcnt lgkmcnt(8)
    v_mfma_f32_16x16x32_bf16 v[140:143], v[104:107], v[68:71], v[140:143]
    v_mfma_f32_16x16x32_bf16 v[192:195], v[108:111], v[56:59], v[192:195]
    v_mfma_f32_16x16x32_bf16 v[196:199], v[108:111], v[60:63], v[196:199]
    v_mfma_f32_16x16x32_bf16 v[200:203], v[108:111], v[64:67], v[200:203]
    v_mfma_f32_16x16x32_bf16 v[204:207], v[108:111], v[68:71], v[204:207]
    s_waitcnt lgkmcnt(0)
    s_barrier
    v_mfma_f32_16x16x32_bf16 v[144:147], v[72:75], v[56:59], v[144:147]
    ds_read_b64_tr_b16 v[96:97], v26 offset:16384
    v_mfma_f32_16x16x32_bf16 v[148:151], v[72:75], v[60:63], v[148:151]
    ds_read_b64_tr_b16 v[98:99], v26 offset:17408
    v_mfma_f32_16x16x32_bf16 v[152:155], v[72:75], v[64:67], v[152:155]
    ds_read_b128 v[40:43], v18 offset:0
    v_mfma_f32_16x16x32_bf16 v[156:159], v[72:75], v[68:71], v[156:159]
    ds_read_b128 v[44:47], v18 offset:2048
    v_mfma_f32_16x16x32_bf16 v[208:211], v[76:79], v[56:59], v[208:211]
    ds_read_b64_tr_b16 v[100:101], v26 offset:32768
    v_mfma_f32_16x16x32_bf16 v[212:215], v[76:79], v[60:63], v[212:215]
    ds_read_b64_tr_b16 v[102:103], v26 offset:33792
    v_mfma_f32_16x16x32_bf16 v[216:219], v[76:79], v[64:67], v[216:219]
    ds_read_b128 v[48:51], v18 offset:4096
    v_mfma_f32_16x16x32_bf16 v[220:223], v[76:79], v[68:71], v[220:223]
    ds_read_b128 v[52:55], v18 offset:6144
    v_mfma_f32_16x16x32_bf16 v[160:163], v[80:83], v[56:59], v[160:163]
    ds_read_b64_tr_b16 v[104:105], v27 offset:16384
    v_mfma_f32_16x16x32_bf16 v[164:167], v[80:83], v[60:63], v[164:167]
    ds_read_b64_tr_b16 v[106:107], v27 offset:17408
    v_mfma_f32_16x16x32_bf16 v[168:171], v[80:83], v[64:67], v[168:171]
    ds_read_b64_tr_b16 v[108:109], v27 offset:32768
    v_mfma_f32_16x16x32_bf16 v[172:175], v[80:83], v[68:71], v[172:175]
    ds_read_b64_tr_b16 v[110:111], v27 offset:33792
    v_mfma_f32_16x16x32_bf16 v[224:227], v[84:87], v[56:59], v[224:227]
    ds_read_b64_tr_b16 v[72:73], v28 offset:16384
    v_mfma_f32_16x16x32_bf16 v[228:231], v[84:87], v[60:63], v[228:231]
    ds_read_b64_tr_b16 v[74:75], v28 offset:17408
    v_mfma_f32_16x16x32_bf16 v[232:235], v[84:87], v[64:67], v[232:235]
    ds_read_b64_tr_b16 v[76:77], v28 offset:32768
    v_mfma_f32_16x16x32_bf16 v[236:239], v[84:87], v[68:71], v[236:239]
    ds_read_b64_tr_b16 v[78:79], v28 offset:33792
    v_mfma_f32_16x16x32_bf16 v[176:179], v[88:91], v[56:59], v[176:179]
    ds_read_b64_tr_b16 v[80:81], v29 offset:16384
    v_mfma_f32_16x16x32_bf16 v[180:183], v[88:91], v[60:63], v[180:183]
    ds_read_b64_tr_b16 v[82:83], v29 offset:17408
    v_mfma_f32_16x16x32_bf16 v[184:187], v[88:91], v[64:67], v[184:187]
    v_mfma_f32_16x16x32_bf16 v[188:191], v[88:91], v[68:71], v[188:191]
    v_mfma_f32_16x16x32_bf16 v[240:243], v[92:95], v[56:59], v[240:243]
    ds_read_b64_tr_b16 v[84:85], v29 offset:32768
    v_mfma_f32_16x16x32_bf16 v[244:247], v[92:95], v[60:63], v[244:247]
    ds_read_b64_tr_b16 v[86:87], v29 offset:33792
    v_mfma_f32_16x16x32_bf16 v[248:251], v[92:95], v[64:67], v[248:251]
    v_mfma_f32_16x16x32_bf16 v[252:255], v[92:95], v[68:71], v[252:255]
    s_waitcnt lgkmcnt(14)
    v_mfma_f32_16x16x32_bf16 v[128:131], v[96:99], v[40:43], v[128:131]
    ds_read_b64_tr_b16 v[88:89], v26 offset:24576
    v_mfma_f32_16x16x32_bf16 v[132:135], v[96:99], v[44:47], v[132:135]
    ds_read_b64_tr_b16 v[90:91], v26 offset:25600
    s_waitcnt lgkmcnt(14)
    v_mfma_f32_16x16x32_bf16 v[136:139], v[96:99], v[48:51], v[136:139]
    ds_read_b128 v[56:59], v19 offset:0
    v_mfma_f32_16x16x32_bf16 v[140:143], v[96:99], v[52:55], v[140:143]
    v_mfma_f32_16x16x32_bf16 v[192:195], v[100:103], v[40:43], v[192:195]
    ds_read_b64_tr_b16 v[92:93], v26 offset:40960
    v_mfma_f32_16x16x32_bf16 v[196:199], v[100:103], v[44:47], v[196:199]
    ds_read_b64_tr_b16 v[94:95], v26 offset:41984
    v_mfma_f32_16x16x32_bf16 v[200:203], v[100:103], v[48:51], v[200:203]
    ds_read_b128 v[60:63], v19 offset:2048
    v_mfma_f32_16x16x32_bf16 v[204:207], v[100:103], v[52:55], v[204:207]
    s_waitcnt lgkmcnt(14)
    v_mfma_f32_16x16x32_bf16 v[144:147], v[104:107], v[40:43], v[144:147]
    ds_read_b64_tr_b16 v[96:97], v27 offset:24576
    v_mfma_f32_16x16x32_bf16 v[148:151], v[104:107], v[44:47], v[148:151]
    ds_read_b64_tr_b16 v[98:99], v27 offset:25600
    v_mfma_f32_16x16x32_bf16 v[152:155], v[104:107], v[48:51], v[152:155]
    ds_read_b128 v[64:67], v19 offset:4096
    v_mfma_f32_16x16x32_bf16 v[156:159], v[104:107], v[52:55], v[156:159]
    v_mfma_f32_16x16x32_bf16 v[208:211], v[108:111], v[40:43], v[208:211]
    ds_read_b64_tr_b16 v[100:101], v27 offset:40960
    v_mfma_f32_16x16x32_bf16 v[212:215], v[108:111], v[44:47], v[212:215]
    ds_read_b64_tr_b16 v[102:103], v27 offset:41984
    v_mfma_f32_16x16x32_bf16 v[216:219], v[108:111], v[48:51], v[216:219]
    ds_read_b128 v[68:71], v19 offset:6144
    v_mfma_f32_16x16x32_bf16 v[220:223], v[108:111], v[52:55], v[220:223]
    s_waitcnt lgkmcnt(14)
    v_mfma_f32_16x16x32_bf16 v[160:163], v[72:75], v[40:43], v[160:163]
    ds_read_b64_tr_b16 v[104:105], v28 offset:24576
    v_mfma_f32_16x16x32_bf16 v[164:167], v[72:75], v[44:47], v[164:167]
    ds_read_b64_tr_b16 v[106:107], v28 offset:25600
    v_mfma_f32_16x16x32_bf16 v[168:171], v[72:75], v[48:51], v[168:171]
    v_mfma_f32_16x16x32_bf16 v[172:175], v[72:75], v[52:55], v[172:175]
    v_mfma_f32_16x16x32_bf16 v[224:227], v[76:79], v[40:43], v[224:227]
    ds_read_b64_tr_b16 v[108:109], v28 offset:40960
    v_mfma_f32_16x16x32_bf16 v[228:231], v[76:79], v[44:47], v[228:231]
    ds_read_b64_tr_b16 v[110:111], v28 offset:41984
    v_mfma_f32_16x16x32_bf16 v[232:235], v[76:79], v[48:51], v[232:235]
    v_mfma_f32_16x16x32_bf16 v[236:239], v[76:79], v[52:55], v[236:239]
    v_mfma_f32_16x16x32_bf16 v[176:179], v[80:83], v[40:43], v[176:179]
    ds_read_b64_tr_b16 v[72:73], v29 offset:24576
    v_mfma_f32_16x16x32_bf16 v[180:183], v[80:83], v[44:47], v[180:183]
    ds_read_b64_tr_b16 v[74:75], v29 offset:25600
    v_mfma_f32_16x16x32_bf16 v[184:187], v[80:83], v[48:51], v[184:187]
    v_mfma_f32_16x16x32_bf16 v[188:191], v[80:83], v[52:55], v[188:191]
    s_waitcnt lgkmcnt(14)
    v_mfma_f32_16x16x32_bf16 v[240:243], v[84:87], v[40:43], v[240:243]
    ds_read_b64_tr_b16 v[76:77], v29 offset:40960
    v_mfma_f32_16x16x32_bf16 v[244:247], v[84:87], v[44:47], v[244:247]
    ds_read_b64_tr_b16 v[78:79], v29 offset:41984
    v_mfma_f32_16x16x32_bf16 v[248:251], v[84:87], v[48:51], v[248:251]
    v_mfma_f32_16x16x32_bf16 v[252:255], v[84:87], v[52:55], v[252:255]
    v_mfma_f32_16x16x32_bf16 v[128:131], v[88:91], v[56:59], v[128:131]
    s_waitcnt lgkmcnt(14)
    v_mfma_f32_16x16x32_bf16 v[132:135], v[88:91], v[60:63], v[132:135]
    s_waitcnt lgkmcnt(11)
    v_mfma_f32_16x16x32_bf16 v[136:139], v[88:91], v[64:67], v[136:139]
    s_waitcnt lgkmcnt(8)
    v_mfma_f32_16x16x32_bf16 v[140:143], v[88:91], v[68:71], v[140:143]
    v_mfma_f32_16x16x32_bf16 v[192:195], v[92:95], v[56:59], v[192:195]
    v_mfma_f32_16x16x32_bf16 v[196:199], v[92:95], v[60:63], v[196:199]
    v_mfma_f32_16x16x32_bf16 v[200:203], v[92:95], v[64:67], v[200:203]
    v_mfma_f32_16x16x32_bf16 v[204:207], v[92:95], v[68:71], v[204:207]
    s_waitcnt lgkmcnt(0)
    s_barrier
    v_mfma_f32_16x16x32_bf16 v[144:147], v[96:99], v[56:59], v[144:147]
    ds_read_b64_tr_b16 v[80:81], v30 offset:16384
    v_mfma_f32_16x16x32_bf16 v[148:151], v[96:99], v[60:63], v[148:151]
    ds_read_b64_tr_b16 v[82:83], v30 offset:17408
    v_mfma_f32_16x16x32_bf16 v[152:155], v[96:99], v[64:67], v[152:155]
    ds_read_b128 v[40:43], v20 offset:0
    v_mfma_f32_16x16x32_bf16 v[156:159], v[96:99], v[68:71], v[156:159]
    ds_read_b128 v[44:47], v20 offset:2048
    v_mfma_f32_16x16x32_bf16 v[208:211], v[100:103], v[56:59], v[208:211]
    ds_read_b64_tr_b16 v[84:85], v30 offset:32768
    v_mfma_f32_16x16x32_bf16 v[212:215], v[100:103], v[60:63], v[212:215]
    ds_read_b64_tr_b16 v[86:87], v30 offset:33792
    v_mfma_f32_16x16x32_bf16 v[216:219], v[100:103], v[64:67], v[216:219]
    ds_read_b128 v[48:51], v20 offset:4096
    v_mfma_f32_16x16x32_bf16 v[220:223], v[100:103], v[68:71], v[220:223]
    ds_read_b128 v[52:55], v20 offset:6144
    v_mfma_f32_16x16x32_bf16 v[160:163], v[104:107], v[56:59], v[160:163]
    ds_read_b64_tr_b16 v[88:89], v31 offset:16384
    v_mfma_f32_16x16x32_bf16 v[164:167], v[104:107], v[60:63], v[164:167]
    ds_read_b64_tr_b16 v[90:91], v31 offset:17408
    v_mfma_f32_16x16x32_bf16 v[168:171], v[104:107], v[64:67], v[168:171]
    ds_read_b64_tr_b16 v[92:93], v31 offset:32768
    v_mfma_f32_16x16x32_bf16 v[172:175], v[104:107], v[68:71], v[172:175]
    ds_read_b64_tr_b16 v[94:95], v31 offset:33792
    v_mfma_f32_16x16x32_bf16 v[224:227], v[108:111], v[56:59], v[224:227]
    ds_read_b64_tr_b16 v[96:97], v32 offset:16384
    v_mfma_f32_16x16x32_bf16 v[228:231], v[108:111], v[60:63], v[228:231]
    ds_read_b64_tr_b16 v[98:99], v32 offset:17408
    v_mfma_f32_16x16x32_bf16 v[232:235], v[108:111], v[64:67], v[232:235]
    ds_read_b64_tr_b16 v[100:101], v32 offset:32768
    v_mfma_f32_16x16x32_bf16 v[236:239], v[108:111], v[68:71], v[236:239]
    ds_read_b64_tr_b16 v[102:103], v32 offset:33792
    v_mfma_f32_16x16x32_bf16 v[176:179], v[72:75], v[56:59], v[176:179]
    ds_read_b64_tr_b16 v[104:105], v33 offset:16384
    v_mfma_f32_16x16x32_bf16 v[180:183], v[72:75], v[60:63], v[180:183]
    ds_read_b64_tr_b16 v[106:107], v33 offset:17408
    v_mfma_f32_16x16x32_bf16 v[184:187], v[72:75], v[64:67], v[184:187]
    v_mfma_f32_16x16x32_bf16 v[188:191], v[72:75], v[68:71], v[188:191]
    v_mfma_f32_16x16x32_bf16 v[240:243], v[76:79], v[56:59], v[240:243]
    ds_read_b64_tr_b16 v[108:109], v33 offset:32768
    v_mfma_f32_16x16x32_bf16 v[244:247], v[76:79], v[60:63], v[244:247]
    ds_read_b64_tr_b16 v[110:111], v33 offset:33792
    v_mfma_f32_16x16x32_bf16 v[248:251], v[76:79], v[64:67], v[248:251]
    v_mfma_f32_16x16x32_bf16 v[252:255], v[76:79], v[68:71], v[252:255]
    s_and_b32 s39, s2, 7
    s_lshr_b32 s40, s2, 3
    s_and_b32 s70, s39, 1
    s_lshl_b32 s70, s70, 2
    s_and_b32 s68, s40, 7
    s_lshr_b32 s69, s40, 3
    s_add_u32 s71, s69, s70
    s_add_u32 s72, s68, s70
    s_cmp_ge_u32 s40, 24
    s_cselect_b32 s71, 3, s71
    s_cselect_b32 s68, s72, s68
    s_lshr_b32 s42, s39, 1
    s_and_b32 s42, s42, 1
    s_mul_i32 s42, s42, 7
    s_add_u32 s42, s42, s71
    s_lshr_b32 s41, s39, 2
    s_lshl_b32 s41, s41, 3
    s_add_u32 s41, s41, s68
    s_lshl_b32 s43, s69, 1
    s_add_u32 s43, s43, s68
    s_and_b32 s43, s43, 7
    s_mov_b32 s56, s36
    s_and_b32 s57, s37, 0xffff
    s_mov_b32 s58, 16777216
    s_mov_b32 s59, 0x00020000
    s_mov_b32 s60, s28
    s_and_b32 s61, s29, 0xffff
    s_mov_b32 s62, 1835008
    s_mov_b32 s63, 0x00020000
    s_mov_b32 s64, s32
    s_and_b32 s65, s33, 0xffff
    s_mov_b32 s66, 2097152
    s_mov_b32 s67, 0x00020000
    s_lshl_b32 s6, s39, 2
    s_and_b32 s13, s40, 3
    s_add_u32 s6, s6, s13
    s_lshr_b32 s7, s40, 2
    s_lshr_b32 s13, s28, 7
    s_sub_u32 s7, s7, s13
    s_add_u32 s7, s7, 4
    s_and_b32 s7, s7, 7
    s_lshl_b32 s17, s6, 6
    s_lshr_b32 s23, s38, 1
    s_lshl_b32 s13, s23, 5
    s_add_u32 s17, s17, s13
    s_lshl_b32 s18, s7, 6
    s_and_b32 s14, s38, 1
    s_lshl_b32 s13, s14, 5
    s_add_u32 s18, s18, s13
    v_lshrrev_b32 v5, 5, v0
    v_and_b32 v6, 31, v0
    v_add_u32 v6, s17, v6
    v_lshlrev_b32 v7, 4, v5
    v_add_u32 v7, s18, v7
    v_lshlrev_b32 v7, 1, v7
    v_lshl_add_u32 v116, v6, 10, v7
    s_lshl_b32 s8, s38, 15
    s_lshl_b32 s9, s6, 1
    s_add_u32 s9, s9, s23
    s_mul_i32 s9, s9, 112
    s_mul_i32 s13, s38, 28
    s_add_u32 s9, s9, s13
    s_lshl_b32 s9, s9, 10
    s_mul_i32 s22, s23, 229376
    s_sub_u32 s22, 114688, s22
    s_lshl_b32 s10, s13, 14
    s_lshl_b32 s13, s7, 7
    s_add_u32 s10, s10, s13
    s_lshr_b32 s12, s40, 1
    s_and_b32 s12, s12, 2
    s_add_u32 s12, s12, s40
    s_and_b32 s12, s12, 3
    s_mul_i32 s12, s12, 7
    s_add_u32 s11, s12, 14
    s_cmp_ge_u32 s11, 28
    s_cselect_b32 s13, 28, 0
    s_sub_u32 s11, s11, s13
    s_lshl_b32 s15, s6, 5
    s_mul_i32 s13, s38, 7
    s_add_u32 s15, s15, s13
    s_lshl_b32 s15, s15, 7
    s_add_u32 s15, s15, 15990784
    s_lshl_b32 s13, s7, 2
    s_add_u32 s13, s13, s38
    s_lshl_b32 s16, s13, 10
    s_add_u32 s16, s16, 16121856
    s_mul_i32 s19, s13, 67584
    s_lshl_b32 s13, s6, 7
    s_add_u32 s19, s19, s13
    s_add_u32 s19, s19, 11010048
    v_lshlrev_b32 v1, 4, v0
    s_waitcnt lgkmcnt(14)
    v_mfma_f32_16x16x32_bf16 v[128:131], v[80:83], v[40:43], v[128:131]
    ds_read_b64_tr_b16 v[72:73], v30 offset:24576
    v_mfma_f32_16x16x32_bf16 v[132:135], v[80:83], v[44:47], v[132:135]
    ds_read_b64_tr_b16 v[74:75], v30 offset:25600
    s_waitcnt lgkmcnt(14)
    v_mfma_f32_16x16x32_bf16 v[136:139], v[80:83], v[48:51], v[136:139]
    ds_read_b128 v[56:59], v21 offset:0
    v_mfma_f32_16x16x32_bf16 v[140:143], v[80:83], v[52:55], v[140:143]
    v_mfma_f32_16x16x32_bf16 v[192:195], v[84:87], v[40:43], v[192:195]
    ds_read_b64_tr_b16 v[76:77], v30 offset:40960
    v_mfma_f32_16x16x32_bf16 v[196:199], v[84:87], v[44:47], v[196:199]
    ds_read_b64_tr_b16 v[78:79], v30 offset:41984
    v_mfma_f32_16x16x32_bf16 v[200:203], v[84:87], v[48:51], v[200:203]
    ds_read_b128 v[60:63], v21 offset:2048
    v_mfma_f32_16x16x32_bf16 v[204:207], v[84:87], v[52:55], v[204:207]
    s_waitcnt lgkmcnt(14)
    v_mfma_f32_16x16x32_bf16 v[144:147], v[88:91], v[40:43], v[144:147]
    ds_read_b64_tr_b16 v[80:81], v31 offset:24576
    v_mfma_f32_16x16x32_bf16 v[148:151], v[88:91], v[44:47], v[148:151]
    ds_read_b64_tr_b16 v[82:83], v31 offset:25600
    v_mfma_f32_16x16x32_bf16 v[152:155], v[88:91], v[48:51], v[152:155]
    ds_read_b128 v[64:67], v21 offset:4096
    v_mfma_f32_16x16x32_bf16 v[156:159], v[88:91], v[52:55], v[156:159]
    v_mfma_f32_16x16x32_bf16 v[208:211], v[92:95], v[40:43], v[208:211]
    ds_read_b64_tr_b16 v[84:85], v31 offset:40960
    v_mfma_f32_16x16x32_bf16 v[212:215], v[92:95], v[44:47], v[212:215]
    ds_read_b64_tr_b16 v[86:87], v31 offset:41984
    v_mfma_f32_16x16x32_bf16 v[216:219], v[92:95], v[48:51], v[216:219]
    ds_read_b128 v[68:71], v21 offset:6144
    v_mfma_f32_16x16x32_bf16 v[220:223], v[92:95], v[52:55], v[220:223]
    s_waitcnt lgkmcnt(14)
    v_mfma_f32_16x16x32_bf16 v[160:163], v[96:99], v[40:43], v[160:163]
    ds_read_b64_tr_b16 v[88:89], v32 offset:24576
    v_mfma_f32_16x16x32_bf16 v[164:167], v[96:99], v[44:47], v[164:167]
    ds_read_b64_tr_b16 v[90:91], v32 offset:25600
    v_mfma_f32_16x16x32_bf16 v[168:171], v[96:99], v[48:51], v[168:171]
    v_mfma_f32_16x16x32_bf16 v[172:175], v[96:99], v[52:55], v[172:175]
    v_mfma_f32_16x16x32_bf16 v[224:227], v[100:103], v[40:43], v[224:227]
    ds_read_b64_tr_b16 v[92:93], v32 offset:40960
    v_mfma_f32_16x16x32_bf16 v[228:231], v[100:103], v[44:47], v[228:231]
    ds_read_b64_tr_b16 v[94:95], v32 offset:41984
    v_mfma_f32_16x16x32_bf16 v[232:235], v[100:103], v[48:51], v[232:235]
    v_mfma_f32_16x16x32_bf16 v[236:239], v[100:103], v[52:55], v[236:239]
    v_mfma_f32_16x16x32_bf16 v[176:179], v[104:107], v[40:43], v[176:179]
    ds_read_b64_tr_b16 v[96:97], v33 offset:24576
    v_mfma_f32_16x16x32_bf16 v[180:183], v[104:107], v[44:47], v[180:183]
    ds_read_b64_tr_b16 v[98:99], v33 offset:25600
    v_mfma_f32_16x16x32_bf16 v[184:187], v[104:107], v[48:51], v[184:187]
    v_mfma_f32_16x16x32_bf16 v[188:191], v[104:107], v[52:55], v[188:191]
    s_waitcnt lgkmcnt(14)
    v_mfma_f32_16x16x32_bf16 v[240:243], v[108:111], v[40:43], v[240:243]
    ds_read_b64_tr_b16 v[100:101], v33 offset:40960
    v_mfma_f32_16x16x32_bf16 v[244:247], v[108:111], v[44:47], v[244:247]
    ds_read_b64_tr_b16 v[102:103], v33 offset:41984
    v_mfma_f32_16x16x32_bf16 v[248:251], v[108:111], v[48:51], v[248:251]
    v_mfma_f32_16x16x32_bf16 v[252:255], v[108:111], v[52:55], v[252:255]
    v_mfma_f32_16x16x32_bf16 v[128:131], v[72:75], v[56:59], v[128:131]
    s_waitcnt lgkmcnt(14)
    v_mfma_f32_16x16x32_bf16 v[132:135], v[72:75], v[60:63], v[132:135]
    s_waitcnt lgkmcnt(11)
    v_mfma_f32_16x16x32_bf16 v[136:139], v[72:75], v[64:67], v[136:139]
    s_waitcnt lgkmcnt(8)
    v_mfma_f32_16x16x32_bf16 v[140:143], v[72:75], v[68:71], v[140:143]
    v_mfma_f32_16x16x32_bf16 v[192:195], v[76:79], v[56:59], v[192:195]
    v_mfma_f32_16x16x32_bf16 v[196:199], v[76:79], v[60:63], v[196:199]
    v_mfma_f32_16x16x32_bf16 v[200:203], v[76:79], v[64:67], v[200:203]
    v_mfma_f32_16x16x32_bf16 v[204:207], v[76:79], v[68:71], v[204:207]
    s_waitcnt lgkmcnt(0)
    s_barrier
    v_mfma_f32_16x16x32_bf16 v[144:147], v[80:83], v[56:59], v[144:147]
    ds_read_b64_tr_b16 v[104:105], v22 offset:16384
    v_mfma_f32_16x16x32_bf16 v[148:151], v[80:83], v[60:63], v[148:151]
    ds_read_b64_tr_b16 v[106:107], v22 offset:17408
    v_mfma_f32_16x16x32_bf16 v[152:155], v[80:83], v[64:67], v[152:155]
    ds_read_b128 v[40:43], v16 offset:0
    v_mfma_f32_16x16x32_bf16 v[156:159], v[80:83], v[68:71], v[156:159]
    ds_read_b128 v[44:47], v16 offset:2048
    v_mfma_f32_16x16x32_bf16 v[208:211], v[84:87], v[56:59], v[208:211]
    ds_read_b64_tr_b16 v[108:109], v22 offset:32768
    v_mfma_f32_16x16x32_bf16 v[212:215], v[84:87], v[60:63], v[212:215]
    ds_read_b64_tr_b16 v[110:111], v22 offset:33792
    v_mfma_f32_16x16x32_bf16 v[216:219], v[84:87], v[64:67], v[216:219]
    ds_read_b128 v[48:51], v16 offset:4096
    v_mfma_f32_16x16x32_bf16 v[220:223], v[84:87], v[68:71], v[220:223]
    ds_read_b128 v[52:55], v16 offset:6144
    v_mfma_f32_16x16x32_bf16 v[160:163], v[88:91], v[56:59], v[160:163]
    ds_read_b64_tr_b16 v[72:73], v23 offset:16384
    v_mfma_f32_16x16x32_bf16 v[164:167], v[88:91], v[60:63], v[164:167]
    ds_read_b64_tr_b16 v[74:75], v23 offset:17408
    v_mfma_f32_16x16x32_bf16 v[168:171], v[88:91], v[64:67], v[168:171]
    ds_read_b64_tr_b16 v[76:77], v23 offset:32768
    v_mfma_f32_16x16x32_bf16 v[172:175], v[88:91], v[68:71], v[172:175]
    ds_read_b64_tr_b16 v[78:79], v23 offset:33792
    v_mfma_f32_16x16x32_bf16 v[224:227], v[92:95], v[56:59], v[224:227]
    ds_read_b64_tr_b16 v[80:81], v24 offset:16384
    v_mfma_f32_16x16x32_bf16 v[228:231], v[92:95], v[60:63], v[228:231]
    ds_read_b64_tr_b16 v[82:83], v24 offset:17408
    v_mfma_f32_16x16x32_bf16 v[232:235], v[92:95], v[64:67], v[232:235]
    ds_read_b64_tr_b16 v[84:85], v24 offset:32768
    v_mfma_f32_16x16x32_bf16 v[236:239], v[92:95], v[68:71], v[236:239]
    ds_read_b64_tr_b16 v[86:87], v24 offset:33792
    v_mfma_f32_16x16x32_bf16 v[176:179], v[96:99], v[56:59], v[176:179]
    ds_read_b64_tr_b16 v[88:89], v25 offset:16384
    v_mfma_f32_16x16x32_bf16 v[180:183], v[96:99], v[60:63], v[180:183]
    ds_read_b64_tr_b16 v[90:91], v25 offset:17408
    v_mfma_f32_16x16x32_bf16 v[184:187], v[96:99], v[64:67], v[184:187]
    v_mfma_f32_16x16x32_bf16 v[188:191], v[96:99], v[68:71], v[188:191]
    v_mfma_f32_16x16x32_bf16 v[240:243], v[100:103], v[56:59], v[240:243]
    ds_read_b64_tr_b16 v[92:93], v25 offset:32768
    v_mfma_f32_16x16x32_bf16 v[244:247], v[100:103], v[60:63], v[244:247]
    ds_read_b64_tr_b16 v[94:95], v25 offset:33792
    v_mfma_f32_16x16x32_bf16 v[248:251], v[100:103], v[64:67], v[248:251]
    v_mfma_f32_16x16x32_bf16 v[252:255], v[100:103], v[68:71], v[252:255]
    s_waitcnt lgkmcnt(14)
    v_mfma_f32_16x16x32_bf16 v[128:131], v[104:107], v[40:43], v[128:131]
    ds_read_b64_tr_b16 v[96:97], v22 offset:24576
    v_mfma_f32_16x16x32_bf16 v[132:135], v[104:107], v[44:47], v[132:135]
    ds_read_b64_tr_b16 v[98:99], v22 offset:25600
    s_waitcnt lgkmcnt(14)
    v_mfma_f32_16x16x32_bf16 v[136:139], v[104:107], v[48:51], v[136:139]
    ds_read_b128 v[56:59], v17 offset:0
    v_mfma_f32_16x16x32_bf16 v[140:143], v[104:107], v[52:55], v[140:143]
    v_mfma_f32_16x16x32_bf16 v[192:195], v[108:111], v[40:43], v[192:195]
    ds_read_b64_tr_b16 v[100:101], v22 offset:40960
    v_mfma_f32_16x16x32_bf16 v[196:199], v[108:111], v[44:47], v[196:199]
    ds_read_b64_tr_b16 v[102:103], v22 offset:41984
    v_mfma_f32_16x16x32_bf16 v[200:203], v[108:111], v[48:51], v[200:203]
    ds_read_b128 v[60:63], v17 offset:2048
    v_mfma_f32_16x16x32_bf16 v[204:207], v[108:111], v[52:55], v[204:207]
    s_waitcnt lgkmcnt(14)
    v_mfma_f32_16x16x32_bf16 v[144:147], v[72:75], v[40:43], v[144:147]
    ds_read_b64_tr_b16 v[104:105], v23 offset:24576
    v_mfma_f32_16x16x32_bf16 v[148:151], v[72:75], v[44:47], v[148:151]
    ds_read_b64_tr_b16 v[106:107], v23 offset:25600
    v_mfma_f32_16x16x32_bf16 v[152:155], v[72:75], v[48:51], v[152:155]
    ds_read_b128 v[64:67], v17 offset:4096
    v_mfma_f32_16x16x32_bf16 v[156:159], v[72:75], v[52:55], v[156:159]
    v_mfma_f32_16x16x32_bf16 v[208:211], v[76:79], v[40:43], v[208:211]
    ds_read_b64_tr_b16 v[108:109], v23 offset:40960
    v_mfma_f32_16x16x32_bf16 v[212:215], v[76:79], v[44:47], v[212:215]
    ds_read_b64_tr_b16 v[110:111], v23 offset:41984
    v_mfma_f32_16x16x32_bf16 v[216:219], v[76:79], v[48:51], v[216:219]
    ds_read_b128 v[68:71], v17 offset:6144
    v_mfma_f32_16x16x32_bf16 v[220:223], v[76:79], v[52:55], v[220:223]
    s_waitcnt lgkmcnt(14)
    v_mfma_f32_16x16x32_bf16 v[160:163], v[80:83], v[40:43], v[160:163]
    ds_read_b64_tr_b16 v[72:73], v24 offset:24576
    v_mfma_f32_16x16x32_bf16 v[164:167], v[80:83], v[44:47], v[164:167]
    ds_read_b64_tr_b16 v[74:75], v24 offset:25600
    v_mfma_f32_16x16x32_bf16 v[168:171], v[80:83], v[48:51], v[168:171]
    v_mfma_f32_16x16x32_bf16 v[172:175], v[80:83], v[52:55], v[172:175]
    v_mfma_f32_16x16x32_bf16 v[224:227], v[84:87], v[40:43], v[224:227]
    ds_read_b64_tr_b16 v[76:77], v24 offset:40960
    v_mfma_f32_16x16x32_bf16 v[228:231], v[84:87], v[44:47], v[228:231]
    ds_read_b64_tr_b16 v[78:79], v24 offset:41984
    v_mfma_f32_16x16x32_bf16 v[232:235], v[84:87], v[48:51], v[232:235]
    v_mfma_f32_16x16x32_bf16 v[236:239], v[84:87], v[52:55], v[236:239]
    v_mfma_f32_16x16x32_bf16 v[176:179], v[88:91], v[40:43], v[176:179]
    ds_read_b64_tr_b16 v[80:81], v25 offset:24576
    v_mfma_f32_16x16x32_bf16 v[180:183], v[88:91], v[44:47], v[180:183]
    ds_read_b64_tr_b16 v[82:83], v25 offset:25600
    v_mfma_f32_16x16x32_bf16 v[184:187], v[88:91], v[48:51], v[184:187]
    v_mfma_f32_16x16x32_bf16 v[188:191], v[88:91], v[52:55], v[188:191]
    s_waitcnt lgkmcnt(14)
    v_mfma_f32_16x16x32_bf16 v[240:243], v[92:95], v[40:43], v[240:243]
    ds_read_b64_tr_b16 v[84:85], v25 offset:40960
    v_mfma_f32_16x16x32_bf16 v[244:247], v[92:95], v[44:47], v[244:247]
    ds_read_b64_tr_b16 v[86:87], v25 offset:41984
    v_mfma_f32_16x16x32_bf16 v[248:251], v[92:95], v[48:51], v[248:251]
    v_mfma_f32_16x16x32_bf16 v[252:255], v[92:95], v[52:55], v[252:255]
    v_lshrrev_b32 v2, 3, v0
    v_and_b32 v3, 7, v0
    v_mul_u32_u24 v120, 4224, v2
    v_lshl_add_u32 v120, v3, 4, v120
    v_lshrrev_b32 v4, 1, v2
    v_and_b32 v4, 1, v4
    v_lshlrev_b32 v4, 2, v4
    v_xor_b32 v3, v3, v4
    v_lshlrev_b32 v112, 10, v2
    v_lshl_add_u32 v112, v3, 4, v112
    v_add_u32 v113, 15360, v112
    v_lshlrev_b32 v121, 7, v2
    v_lshl_add_u32 v121, v3, 4, v121
    v_add_u32 v121, s8, v121
    v_lshrrev_b32 v2, 2, v0
    v_and_b32 v2, 3, v2
    v_and_b32 v3, 3, v0
    v_lshrrev_b32 v4, 4, v0
    v_and_b32 v4, 1, v4
    v_lshl_add_u32 v6, v5, 2, v2
    v_lshlrev_b32 v6, 7, v6
    v_and_b32 v7, 1, v3
    v_lshl_add_u32 v6, v7, 5, v6
    v_lshl_add_u32 v6, v4, 4, v6
    v_lshrrev_b32 v7, 1, v3
    v_lshl_add_u32 v6, v7, 3, v6
    v_add_u32 v6, s8, v6
    v_lshrrev_b32 v7, 1, v2
    v_xor_b32 v7, s14, v7
    v_lshl_add_u32 v114, v7, 6, v6
    v_xor_b32 v7, 1, v7
    v_lshl_add_u32 v115, v7, 6, v6
    s_lshl_b32 s13, s14, 1
    v_add_u32 v6, s13, v5
    v_lshlrev_b32 v122, 15, v6
    v_lshl_add_u32 v122, v2, 7, v122
    v_lshrrev_b32 v7, 1, v2
    v_xor_b32 v7, s23, v7
    v_lshl_add_u32 v122, v7, 6, v122
    v_lshl_add_u32 v122, v4, 5, v122
    v_lshl_add_u32 v122, v3, 3, v122
    v_min_u32 v117, 6, v0
    v_lshlrev_b32 v117, 7, v117
    v_lshrrev_b32 v2, 2, v0
    v_and_b32 v2, 7, v2
    v_lshlrev_b32 v118, 7, v2
    v_lshl_add_u32 v118, v3, 2, v118
    v_and_b32 v119, 31, v0
    s_lshl_b32 s13, s23, 5
    v_add_u32 v119, s13, v119
    v_lshlrev_b32 v119, 2, v119
    v_add_u32 v119, 141824, v119
    v_add_u32 v123, s8, v1
    s_xor_b32 s13, s38, 1
    s_lshl_b32 s13, s13, 15
    v_add_u32 v126, s13, v1
    s_xor_b32 s13, s38, 2
    s_lshl_b32 s13, s13, 15
    v_add_u32 v124, s13, v1
    s_xor_b32 s13, s38, 3
    s_lshl_b32 s13, s13, 15
    v_add_u32 v125, s13, v1
    s_lshr_b32 s68, s38, 1
    s_and_b32 s69, s38, 1
    s_lshl_b32 s70, s41, 2
    s_lshl_b32 s71, s68, 1
    s_add_u32 s70, s70, s71
    s_mul_i32 s70, s70, 112
    s_lshl_b32 s71, s42, 3
    s_add_u32 s70, s70, s71
    s_lshl_b32 s71, s69, 2
    s_add_u32 s70, s70, s71
    s_lshl_b32 s70, s70, 10
    s_add_u32 s71, s70, 114688
    s_lshl_b32 s3, s41, 1
    s_add_u32 s3, s3, s68
    s_lshl_b32 s3, s3, 5
    s_lshl_b32 s72, s42, 1
    s_add_u32 s3, s3, s72
    s_add_u32 s3, s3, s69
    s_lshl_b32 s3, s3, 7
    s_add_u32 s3, s3, 15990784
    s_mov_b32 s72, 0xbfb8aa3b
    s_mov_b32 s73, 0xbfb8aa3b
    v_mfma_f32_16x16x32_bf16 v[128:131], v[96:99], v[56:59], v[128:131]
    s_waitcnt lgkmcnt(14)
    v_mfma_f32_16x16x32_bf16 v[132:135], v[96:99], v[60:63], v[132:135]
    s_waitcnt lgkmcnt(11)
    v_mfma_f32_16x16x32_bf16 v[136:139], v[96:99], v[64:67], v[136:139]
    s_waitcnt lgkmcnt(8)
    v_mfma_f32_16x16x32_bf16 v[140:143], v[96:99], v[68:71], v[140:143]
    v_mfma_f32_16x16x32_bf16 v[192:195], v[100:103], v[56:59], v[192:195]
    v_mfma_f32_16x16x32_bf16 v[196:199], v[100:103], v[60:63], v[196:199]
    v_mfma_f32_16x16x32_bf16 v[200:203], v[100:103], v[64:67], v[200:203]
    v_mfma_f32_16x16x32_bf16 v[204:207], v[100:103], v[68:71], v[204:207]
    s_waitcnt lgkmcnt(0)
    s_barrier
    v_mfma_f32_16x16x32_bf16 v[144:147], v[104:107], v[56:59], v[144:147]
    ds_read_b64_tr_b16 v[88:89], v26 offset:16384
    v_mfma_f32_16x16x32_bf16 v[148:151], v[104:107], v[60:63], v[148:151]
    ds_read_b64_tr_b16 v[90:91], v26 offset:17408
    v_mfma_f32_16x16x32_bf16 v[152:155], v[104:107], v[64:67], v[152:155]
    ds_read_b128 v[40:43], v18 offset:0
    v_mfma_f32_16x16x32_bf16 v[156:159], v[104:107], v[68:71], v[156:159]
    ds_read_b128 v[44:47], v18 offset:2048
    v_mfma_f32_16x16x32_bf16 v[208:211], v[108:111], v[56:59], v[208:211]
    ds_read_b64_tr_b16 v[92:93], v26 offset:32768
    v_mfma_f32_16x16x32_bf16 v[212:215], v[108:111], v[60:63], v[212:215]
    ds_read_b64_tr_b16 v[94:95], v26 offset:33792
    v_mfma_f32_16x16x32_bf16 v[216:219], v[108:111], v[64:67], v[216:219]
    ds_read_b128 v[48:51], v18 offset:4096
    v_mfma_f32_16x16x32_bf16 v[220:223], v[108:111], v[68:71], v[220:223]
    ds_read_b128 v[52:55], v18 offset:6144
    v_mfma_f32_16x16x32_bf16 v[160:163], v[72:75], v[56:59], v[160:163]
    ds_read_b64_tr_b16 v[96:97], v27 offset:16384
    v_mfma_f32_16x16x32_bf16 v[164:167], v[72:75], v[60:63], v[164:167]
    ds_read_b64_tr_b16 v[98:99], v27 offset:17408
    v_mfma_f32_16x16x32_bf16 v[168:171], v[72:75], v[64:67], v[168:171]
    ds_read_b64_tr_b16 v[100:101], v27 offset:32768
    v_mfma_f32_16x16x32_bf16 v[172:175], v[72:75], v[68:71], v[172:175]
    ds_read_b64_tr_b16 v[102:103], v27 offset:33792
    v_mfma_f32_16x16x32_bf16 v[224:227], v[76:79], v[56:59], v[224:227]
    ds_read_b64_tr_b16 v[104:105], v28 offset:16384
    v_mfma_f32_16x16x32_bf16 v[228:231], v[76:79], v[60:63], v[228:231]
    ds_read_b64_tr_b16 v[106:107], v28 offset:17408
    v_mfma_f32_16x16x32_bf16 v[232:235], v[76:79], v[64:67], v[232:235]
    ds_read_b64_tr_b16 v[108:109], v28 offset:32768
    v_mfma_f32_16x16x32_bf16 v[236:239], v[76:79], v[68:71], v[236:239]
    ds_read_b64_tr_b16 v[110:111], v28 offset:33792
    v_mfma_f32_16x16x32_bf16 v[176:179], v[80:83], v[56:59], v[176:179]
    ds_read_b64_tr_b16 v[72:73], v29 offset:16384
    v_mfma_f32_16x16x32_bf16 v[180:183], v[80:83], v[60:63], v[180:183]
    ds_read_b64_tr_b16 v[74:75], v29 offset:17408
    v_mfma_f32_16x16x32_bf16 v[184:187], v[80:83], v[64:67], v[184:187]
    v_mfma_f32_16x16x32_bf16 v[188:191], v[80:83], v[68:71], v[188:191]
    v_mfma_f32_16x16x32_bf16 v[240:243], v[84:87], v[56:59], v[240:243]
    ds_read_b64_tr_b16 v[76:77], v29 offset:32768
    v_mfma_f32_16x16x32_bf16 v[244:247], v[84:87], v[60:63], v[244:247]
    ds_read_b64_tr_b16 v[78:79], v29 offset:33792
    v_mfma_f32_16x16x32_bf16 v[248:251], v[84:87], v[64:67], v[248:251]
    v_mfma_f32_16x16x32_bf16 v[252:255], v[84:87], v[68:71], v[252:255]
    s_waitcnt lgkmcnt(14)
    v_mfma_f32_16x16x32_bf16 v[128:131], v[88:91], v[40:43], v[128:131]
    ds_read_b64_tr_b16 v[80:81], v26 offset:24576
    v_mfma_f32_16x16x32_bf16 v[132:135], v[88:91], v[44:47], v[132:135]
    ds_read_b64_tr_b16 v[82:83], v26 offset:25600
    s_waitcnt lgkmcnt(14)
    v_mfma_f32_16x16x32_bf16 v[136:139], v[88:91], v[48:51], v[136:139]
    ds_read_b128 v[56:59], v19 offset:0
    v_mfma_f32_16x16x32_bf16 v[140:143], v[88:91], v[52:55], v[140:143]
    v_mfma_f32_16x16x32_bf16 v[192:195], v[92:95], v[40:43], v[192:195]
    ds_read_b64_tr_b16 v[84:85], v26 offset:40960
    v_mfma_f32_16x16x32_bf16 v[196:199], v[92:95], v[44:47], v[196:199]
    ds_read_b64_tr_b16 v[86:87], v26 offset:41984
    v_mfma_f32_16x16x32_bf16 v[200:203], v[92:95], v[48:51], v[200:203]
    ds_read_b128 v[60:63], v19 offset:2048
    v_mfma_f32_16x16x32_bf16 v[204:207], v[92:95], v[52:55], v[204:207]
    s_waitcnt lgkmcnt(14)
    v_mfma_f32_16x16x32_bf16 v[144:147], v[96:99], v[40:43], v[144:147]
    ds_read_b64_tr_b16 v[88:89], v27 offset:24576
    v_mfma_f32_16x16x32_bf16 v[148:151], v[96:99], v[44:47], v[148:151]
    ds_read_b64_tr_b16 v[90:91], v27 offset:25600
    v_mfma_f32_16x16x32_bf16 v[152:155], v[96:99], v[48:51], v[152:155]
    ds_read_b128 v[64:67], v19 offset:4096
    v_mfma_f32_16x16x32_bf16 v[156:159], v[96:99], v[52:55], v[156:159]
    v_mfma_f32_16x16x32_bf16 v[208:211], v[100:103], v[40:43], v[208:211]
    ds_read_b64_tr_b16 v[92:93], v27 offset:40960
    v_mfma_f32_16x16x32_bf16 v[212:215], v[100:103], v[44:47], v[212:215]
    ds_read_b64_tr_b16 v[94:95], v27 offset:41984
    v_mfma_f32_16x16x32_bf16 v[216:219], v[100:103], v[48:51], v[216:219]
    ds_read_b128 v[68:71], v19 offset:6144
    v_mfma_f32_16x16x32_bf16 v[220:223], v[100:103], v[52:55], v[220:223]
    s_waitcnt lgkmcnt(14)
    v_mfma_f32_16x16x32_bf16 v[160:163], v[104:107], v[40:43], v[160:163]
    ds_read_b64_tr_b16 v[96:97], v28 offset:24576
    v_mfma_f32_16x16x32_bf16 v[164:167], v[104:107], v[44:47], v[164:167]
    ds_read_b64_tr_b16 v[98:99], v28 offset:25600
    v_mfma_f32_16x16x32_bf16 v[168:171], v[104:107], v[48:51], v[168:171]
    v_mfma_f32_16x16x32_bf16 v[172:175], v[104:107], v[52:55], v[172:175]
    v_mfma_f32_16x16x32_bf16 v[224:227], v[108:111], v[40:43], v[224:227]
    ds_read_b64_tr_b16 v[100:101], v28 offset:40960
    v_mfma_f32_16x16x32_bf16 v[228:231], v[108:111], v[44:47], v[228:231]
    ds_read_b64_tr_b16 v[102:103], v28 offset:41984
    v_mfma_f32_16x16x32_bf16 v[232:235], v[108:111], v[48:51], v[232:235]
    v_mfma_f32_16x16x32_bf16 v[236:239], v[108:111], v[52:55], v[236:239]
    v_mfma_f32_16x16x32_bf16 v[176:179], v[72:75], v[40:43], v[176:179]
    ds_read_b64_tr_b16 v[104:105], v29 offset:24576
    v_mfma_f32_16x16x32_bf16 v[180:183], v[72:75], v[44:47], v[180:183]
    ds_read_b64_tr_b16 v[106:107], v29 offset:25600
    v_mfma_f32_16x16x32_bf16 v[184:187], v[72:75], v[48:51], v[184:187]
    v_mfma_f32_16x16x32_bf16 v[188:191], v[72:75], v[52:55], v[188:191]
    s_waitcnt lgkmcnt(14)
    v_mfma_f32_16x16x32_bf16 v[240:243], v[76:79], v[40:43], v[240:243]
    ds_read_b64_tr_b16 v[108:109], v29 offset:40960
    v_mfma_f32_16x16x32_bf16 v[244:247], v[76:79], v[44:47], v[244:247]
    ds_read_b64_tr_b16 v[110:111], v29 offset:41984
    v_mfma_f32_16x16x32_bf16 v[248:251], v[76:79], v[48:51], v[248:251]
    v_mfma_f32_16x16x32_bf16 v[252:255], v[76:79], v[52:55], v[252:255]
    v_mfma_f32_16x16x32_bf16 v[128:131], v[80:83], v[56:59], v[128:131]
    s_waitcnt lgkmcnt(14)
    v_mfma_f32_16x16x32_bf16 v[132:135], v[80:83], v[60:63], v[132:135]
    s_waitcnt lgkmcnt(11)
    v_mfma_f32_16x16x32_bf16 v[136:139], v[80:83], v[64:67], v[136:139]
    s_waitcnt lgkmcnt(8)
    v_mfma_f32_16x16x32_bf16 v[140:143], v[80:83], v[68:71], v[140:143]
    v_mfma_f32_16x16x32_bf16 v[192:195], v[84:87], v[56:59], v[192:195]
    v_mfma_f32_16x16x32_bf16 v[196:199], v[84:87], v[60:63], v[196:199]
    v_mfma_f32_16x16x32_bf16 v[200:203], v[84:87], v[64:67], v[200:203]
    v_mfma_f32_16x16x32_bf16 v[204:207], v[84:87], v[68:71], v[204:207]
    s_waitcnt lgkmcnt(0)
    s_barrier
    v_mfma_f32_16x16x32_bf16 v[144:147], v[88:91], v[56:59], v[144:147]
    ds_read_b64_tr_b16 v[72:73], v30 offset:16384
    v_mfma_f32_16x16x32_bf16 v[148:151], v[88:91], v[60:63], v[148:151]
    ds_read_b64_tr_b16 v[74:75], v30 offset:17408
    v_mfma_f32_16x16x32_bf16 v[152:155], v[88:91], v[64:67], v[152:155]
    ds_read_b128 v[40:43], v20 offset:0
    v_mfma_f32_16x16x32_bf16 v[156:159], v[88:91], v[68:71], v[156:159]
    ds_read_b128 v[44:47], v20 offset:2048
    v_mfma_f32_16x16x32_bf16 v[208:211], v[92:95], v[56:59], v[208:211]
    ds_read_b64_tr_b16 v[76:77], v30 offset:32768
    v_mfma_f32_16x16x32_bf16 v[212:215], v[92:95], v[60:63], v[212:215]
    ds_read_b64_tr_b16 v[78:79], v30 offset:33792
    v_mfma_f32_16x16x32_bf16 v[216:219], v[92:95], v[64:67], v[216:219]
    ds_read_b128 v[48:51], v20 offset:4096
    v_mfma_f32_16x16x32_bf16 v[220:223], v[92:95], v[68:71], v[220:223]
    ds_read_b128 v[52:55], v20 offset:6144
    v_mfma_f32_16x16x32_bf16 v[160:163], v[96:99], v[56:59], v[160:163]
    ds_read_b64_tr_b16 v[80:81], v31 offset:16384
    v_mfma_f32_16x16x32_bf16 v[164:167], v[96:99], v[60:63], v[164:167]
    ds_read_b64_tr_b16 v[82:83], v31 offset:17408
    v_mfma_f32_16x16x32_bf16 v[168:171], v[96:99], v[64:67], v[168:171]
    ds_read_b64_tr_b16 v[84:85], v31 offset:32768
    v_mfma_f32_16x16x32_bf16 v[172:175], v[96:99], v[68:71], v[172:175]
    ds_read_b64_tr_b16 v[86:87], v31 offset:33792
    v_mfma_f32_16x16x32_bf16 v[224:227], v[100:103], v[56:59], v[224:227]
    ds_read_b64_tr_b16 v[88:89], v32 offset:16384
    v_mfma_f32_16x16x32_bf16 v[228:231], v[100:103], v[60:63], v[228:231]
    ds_read_b64_tr_b16 v[90:91], v32 offset:17408
    v_mfma_f32_16x16x32_bf16 v[232:235], v[100:103], v[64:67], v[232:235]
    ds_read_b64_tr_b16 v[92:93], v32 offset:32768
    v_mfma_f32_16x16x32_bf16 v[236:239], v[100:103], v[68:71], v[236:239]
    ds_read_b64_tr_b16 v[94:95], v32 offset:33792
    v_mfma_f32_16x16x32_bf16 v[176:179], v[104:107], v[56:59], v[176:179]
    ds_read_b64_tr_b16 v[96:97], v33 offset:16384
    v_mfma_f32_16x16x32_bf16 v[180:183], v[104:107], v[60:63], v[180:183]
    ds_read_b64_tr_b16 v[98:99], v33 offset:17408
    v_mfma_f32_16x16x32_bf16 v[184:187], v[104:107], v[64:67], v[184:187]
    v_mfma_f32_16x16x32_bf16 v[188:191], v[104:107], v[68:71], v[188:191]
    v_mfma_f32_16x16x32_bf16 v[240:243], v[108:111], v[56:59], v[240:243]
    ds_read_b64_tr_b16 v[100:101], v33 offset:32768
    v_mfma_f32_16x16x32_bf16 v[244:247], v[108:111], v[60:63], v[244:247]
    ds_read_b64_tr_b16 v[102:103], v33 offset:33792
    v_mfma_f32_16x16x32_bf16 v[248:251], v[108:111], v[64:67], v[248:251]
    v_mfma_f32_16x16x32_bf16 v[252:255], v[108:111], v[68:71], v[252:255]
    s_waitcnt lgkmcnt(14)
    v_mfma_f32_16x16x32_bf16 v[128:131], v[72:75], v[40:43], v[128:131]
    ds_read_b64_tr_b16 v[104:105], v30 offset:24576
    v_mfma_f32_16x16x32_bf16 v[132:135], v[72:75], v[44:47], v[132:135]
    ds_read_b64_tr_b16 v[106:107], v30 offset:25600
    s_waitcnt lgkmcnt(14)
    v_mfma_f32_16x16x32_bf16 v[136:139], v[72:75], v[48:51], v[136:139]
    ds_read_b128 v[56:59], v21 offset:0
    v_mfma_f32_16x16x32_bf16 v[140:143], v[72:75], v[52:55], v[140:143]
    v_mfma_f32_16x16x32_bf16 v[192:195], v[76:79], v[40:43], v[192:195]
    ds_read_b64_tr_b16 v[108:109], v30 offset:40960
    v_mfma_f32_16x16x32_bf16 v[196:199], v[76:79], v[44:47], v[196:199]
    ds_read_b64_tr_b16 v[110:111], v30 offset:41984
    v_mfma_f32_16x16x32_bf16 v[200:203], v[76:79], v[48:51], v[200:203]
    ds_read_b128 v[60:63], v21 offset:2048
    v_mfma_f32_16x16x32_bf16 v[204:207], v[76:79], v[52:55], v[204:207]
    s_waitcnt lgkmcnt(14)
    v_mfma_f32_16x16x32_bf16 v[144:147], v[80:83], v[40:43], v[144:147]
    ds_read_b64_tr_b16 v[72:73], v31 offset:24576
    v_mfma_f32_16x16x32_bf16 v[148:151], v[80:83], v[44:47], v[148:151]
    ds_read_b64_tr_b16 v[74:75], v31 offset:25600
    v_mfma_f32_16x16x32_bf16 v[152:155], v[80:83], v[48:51], v[152:155]
    ds_read_b128 v[64:67], v21 offset:4096
    v_mfma_f32_16x16x32_bf16 v[156:159], v[80:83], v[52:55], v[156:159]
    v_mfma_f32_16x16x32_bf16 v[208:211], v[84:87], v[40:43], v[208:211]
    ds_read_b64_tr_b16 v[76:77], v31 offset:40960
    v_mfma_f32_16x16x32_bf16 v[212:215], v[84:87], v[44:47], v[212:215]
    ds_read_b64_tr_b16 v[78:79], v31 offset:41984
    v_mfma_f32_16x16x32_bf16 v[216:219], v[84:87], v[48:51], v[216:219]
    ds_read_b128 v[68:71], v21 offset:6144
    v_mfma_f32_16x16x32_bf16 v[220:223], v[84:87], v[52:55], v[220:223]
    s_waitcnt lgkmcnt(14)
    v_mfma_f32_16x16x32_bf16 v[160:163], v[88:91], v[40:43], v[160:163]
    ds_read_b64_tr_b16 v[80:81], v32 offset:24576
    v_mfma_f32_16x16x32_bf16 v[164:167], v[88:91], v[44:47], v[164:167]
    ds_read_b64_tr_b16 v[82:83], v32 offset:25600
    v_mfma_f32_16x16x32_bf16 v[168:171], v[88:91], v[48:51], v[168:171]
    v_mfma_f32_16x16x32_bf16 v[172:175], v[88:91], v[52:55], v[172:175]
    v_mfma_f32_16x16x32_bf16 v[224:227], v[92:95], v[40:43], v[224:227]
    ds_read_b64_tr_b16 v[84:85], v32 offset:40960
    v_mfma_f32_16x16x32_bf16 v[228:231], v[92:95], v[44:47], v[228:231]
    ds_read_b64_tr_b16 v[86:87], v32 offset:41984
    v_mfma_f32_16x16x32_bf16 v[232:235], v[92:95], v[48:51], v[232:235]
    v_mfma_f32_16x16x32_bf16 v[236:239], v[92:95], v[52:55], v[236:239]
    v_mfma_f32_16x16x32_bf16 v[176:179], v[96:99], v[40:43], v[176:179]
    ds_read_b64_tr_b16 v[88:89], v33 offset:24576
    v_mfma_f32_16x16x32_bf16 v[180:183], v[96:99], v[44:47], v[180:183]
    ds_read_b64_tr_b16 v[90:91], v33 offset:25600
    v_mfma_f32_16x16x32_bf16 v[184:187], v[96:99], v[48:51], v[184:187]
    v_mfma_f32_16x16x32_bf16 v[188:191], v[96:99], v[52:55], v[188:191]
    s_waitcnt lgkmcnt(14)
    v_mfma_f32_16x16x32_bf16 v[240:243], v[100:103], v[40:43], v[240:243]
    ds_read_b64_tr_b16 v[92:93], v33 offset:40960
    v_mfma_f32_16x16x32_bf16 v[244:247], v[100:103], v[44:47], v[244:247]
    ds_read_b64_tr_b16 v[94:95], v33 offset:41984
    v_mfma_f32_16x16x32_bf16 v[248:251], v[100:103], v[48:51], v[248:251]
    v_mfma_f32_16x16x32_bf16 v[252:255], v[100:103], v[52:55], v[252:255]
    v_mfma_f32_16x16x32_bf16 v[128:131], v[104:107], v[56:59], v[128:131]
    s_waitcnt lgkmcnt(14)
    v_mfma_f32_16x16x32_bf16 v[132:135], v[104:107], v[60:63], v[132:135]
    s_waitcnt lgkmcnt(11)
    v_mfma_f32_16x16x32_bf16 v[136:139], v[104:107], v[64:67], v[136:139]
    s_waitcnt lgkmcnt(8)
    v_mfma_f32_16x16x32_bf16 v[140:143], v[104:107], v[68:71], v[140:143]
    v_mfma_f32_16x16x32_bf16 v[192:195], v[108:111], v[56:59], v[192:195]
    v_mfma_f32_16x16x32_bf16 v[196:199], v[108:111], v[60:63], v[196:199]
    v_mfma_f32_16x16x32_bf16 v[200:203], v[108:111], v[64:67], v[200:203]
    v_mfma_f32_16x16x32_bf16 v[204:207], v[108:111], v[68:71], v[204:207]
    s_waitcnt lgkmcnt(0)
    s_barrier
    v_mfma_f32_16x16x32_bf16 v[144:147], v[72:75], v[56:59], v[144:147]
    ds_read_b64_tr_b16 v[96:97], v22 offset:16384
    v_mfma_f32_16x16x32_bf16 v[148:151], v[72:75], v[60:63], v[148:151]
    ds_read_b64_tr_b16 v[98:99], v22 offset:17408
    v_mfma_f32_16x16x32_bf16 v[152:155], v[72:75], v[64:67], v[152:155]
    ds_read_b128 v[40:43], v16 offset:0
    v_mfma_f32_16x16x32_bf16 v[156:159], v[72:75], v[68:71], v[156:159]
    ds_read_b128 v[44:47], v16 offset:2048
    v_mfma_f32_16x16x32_bf16 v[208:211], v[76:79], v[56:59], v[208:211]
    ds_read_b64_tr_b16 v[100:101], v22 offset:32768
    v_mfma_f32_16x16x32_bf16 v[212:215], v[76:79], v[60:63], v[212:215]
    ds_read_b64_tr_b16 v[102:103], v22 offset:33792
    v_mfma_f32_16x16x32_bf16 v[216:219], v[76:79], v[64:67], v[216:219]
    ds_read_b128 v[48:51], v16 offset:4096
    v_mfma_f32_16x16x32_bf16 v[220:223], v[76:79], v[68:71], v[220:223]
    ds_read_b128 v[52:55], v16 offset:6144
    v_mfma_f32_16x16x32_bf16 v[160:163], v[80:83], v[56:59], v[160:163]
    ds_read_b64_tr_b16 v[104:105], v23 offset:16384
    v_mfma_f32_16x16x32_bf16 v[164:167], v[80:83], v[60:63], v[164:167]
    ds_read_b64_tr_b16 v[106:107], v23 offset:17408
    v_mfma_f32_16x16x32_bf16 v[168:171], v[80:83], v[64:67], v[168:171]
    ds_read_b64_tr_b16 v[108:109], v23 offset:32768
    v_mfma_f32_16x16x32_bf16 v[172:175], v[80:83], v[68:71], v[172:175]
    ds_read_b64_tr_b16 v[110:111], v23 offset:33792
    v_mfma_f32_16x16x32_bf16 v[224:227], v[84:87], v[56:59], v[224:227]
    ds_read_b64_tr_b16 v[72:73], v24 offset:16384
    v_mfma_f32_16x16x32_bf16 v[228:231], v[84:87], v[60:63], v[228:231]
    ds_read_b64_tr_b16 v[74:75], v24 offset:17408
    v_mfma_f32_16x16x32_bf16 v[232:235], v[84:87], v[64:67], v[232:235]
    ds_read_b64_tr_b16 v[76:77], v24 offset:32768
    v_mfma_f32_16x16x32_bf16 v[236:239], v[84:87], v[68:71], v[236:239]
    ds_read_b64_tr_b16 v[78:79], v24 offset:33792
    v_mfma_f32_16x16x32_bf16 v[176:179], v[88:91], v[56:59], v[176:179]
    ds_read_b64_tr_b16 v[80:81], v25 offset:16384
    v_mfma_f32_16x16x32_bf16 v[180:183], v[88:91], v[60:63], v[180:183]
    ds_read_b64_tr_b16 v[82:83], v25 offset:17408
    v_mfma_f32_16x16x32_bf16 v[184:187], v[88:91], v[64:67], v[184:187]
    v_mfma_f32_16x16x32_bf16 v[188:191], v[88:91], v[68:71], v[188:191]
    v_mfma_f32_16x16x32_bf16 v[240:243], v[92:95], v[56:59], v[240:243]
    ds_read_b64_tr_b16 v[84:85], v25 offset:32768
    v_mfma_f32_16x16x32_bf16 v[244:247], v[92:95], v[60:63], v[244:247]
    ds_read_b64_tr_b16 v[86:87], v25 offset:33792
    v_mfma_f32_16x16x32_bf16 v[248:251], v[92:95], v[64:67], v[248:251]
    v_mfma_f32_16x16x32_bf16 v[252:255], v[92:95], v[68:71], v[252:255]
    s_waitcnt lgkmcnt(14)
    v_mfma_f32_16x16x32_bf16 v[128:131], v[96:99], v[40:43], v[128:131]
    ds_read_b64_tr_b16 v[88:89], v22 offset:24576
    v_mfma_f32_16x16x32_bf16 v[132:135], v[96:99], v[44:47], v[132:135]
    ds_read_b64_tr_b16 v[90:91], v22 offset:25600
    s_waitcnt lgkmcnt(14)
    v_mfma_f32_16x16x32_bf16 v[136:139], v[96:99], v[48:51], v[136:139]
    ds_read_b128 v[56:59], v17 offset:0
    v_mfma_f32_16x16x32_bf16 v[140:143], v[96:99], v[52:55], v[140:143]
    v_mfma_f32_16x16x32_bf16 v[192:195], v[100:103], v[40:43], v[192:195]
    ds_read_b64_tr_b16 v[92:93], v22 offset:40960
    v_mfma_f32_16x16x32_bf16 v[196:199], v[100:103], v[44:47], v[196:199]
    ds_read_b64_tr_b16 v[94:95], v22 offset:41984
    v_mfma_f32_16x16x32_bf16 v[200:203], v[100:103], v[48:51], v[200:203]
    ds_read_b128 v[60:63], v17 offset:2048
    v_mfma_f32_16x16x32_bf16 v[204:207], v[100:103], v[52:55], v[204:207]
    s_waitcnt lgkmcnt(14)
    v_mfma_f32_16x16x32_bf16 v[144:147], v[104:107], v[40:43], v[144:147]
    ds_read_b64_tr_b16 v[96:97], v23 offset:24576
    v_mfma_f32_16x16x32_bf16 v[148:151], v[104:107], v[44:47], v[148:151]
    ds_read_b64_tr_b16 v[98:99], v23 offset:25600
    v_mfma_f32_16x16x32_bf16 v[152:155], v[104:107], v[48:51], v[152:155]
    ds_read_b128 v[64:67], v17 offset:4096
    v_mfma_f32_16x16x32_bf16 v[156:159], v[104:107], v[52:55], v[156:159]
    v_mfma_f32_16x16x32_bf16 v[208:211], v[108:111], v[40:43], v[208:211]
    ds_read_b64_tr_b16 v[100:101], v23 offset:40960
    v_mfma_f32_16x16x32_bf16 v[212:215], v[108:111], v[44:47], v[212:215]
    ds_read_b64_tr_b16 v[102:103], v23 offset:41984
    v_mfma_f32_16x16x32_bf16 v[216:219], v[108:111], v[48:51], v[216:219]
    ds_read_b128 v[68:71], v17 offset:6144
    v_mfma_f32_16x16x32_bf16 v[220:223], v[108:111], v[52:55], v[220:223]
    s_waitcnt lgkmcnt(14)
    v_mfma_f32_16x16x32_bf16 v[160:163], v[72:75], v[40:43], v[160:163]
    ds_read_b64_tr_b16 v[104:105], v24 offset:24576
    v_mfma_f32_16x16x32_bf16 v[164:167], v[72:75], v[44:47], v[164:167]
    ds_read_b64_tr_b16 v[106:107], v24 offset:25600
    v_mfma_f32_16x16x32_bf16 v[168:171], v[72:75], v[48:51], v[168:171]
    v_mfma_f32_16x16x32_bf16 v[172:175], v[72:75], v[52:55], v[172:175]
    v_mfma_f32_16x16x32_bf16 v[224:227], v[76:79], v[40:43], v[224:227]
    ds_read_b64_tr_b16 v[108:109], v24 offset:40960
    v_mfma_f32_16x16x32_bf16 v[228:231], v[76:79], v[44:47], v[228:231]
    ds_read_b64_tr_b16 v[110:111], v24 offset:41984
    v_mfma_f32_16x16x32_bf16 v[232:235], v[76:79], v[48:51], v[232:235]
    v_mfma_f32_16x16x32_bf16 v[236:239], v[76:79], v[52:55], v[236:239]
    v_mfma_f32_16x16x32_bf16 v[176:179], v[80:83], v[40:43], v[176:179]
    ds_read_b64_tr_b16 v[72:73], v25 offset:24576
    v_mfma_f32_16x16x32_bf16 v[180:183], v[80:83], v[44:47], v[180:183]
    ds_read_b64_tr_b16 v[74:75], v25 offset:25600
    v_mfma_f32_16x16x32_bf16 v[184:187], v[80:83], v[48:51], v[184:187]
    v_mfma_f32_16x16x32_bf16 v[188:191], v[80:83], v[52:55], v[188:191]
    s_waitcnt lgkmcnt(14)
    v_mfma_f32_16x16x32_bf16 v[240:243], v[84:87], v[40:43], v[240:243]
    ds_read_b64_tr_b16 v[76:77], v25 offset:40960
    v_mfma_f32_16x16x32_bf16 v[244:247], v[84:87], v[44:47], v[244:247]
    ds_read_b64_tr_b16 v[78:79], v25 offset:41984
    v_mfma_f32_16x16x32_bf16 v[248:251], v[84:87], v[48:51], v[248:251]
    v_mfma_f32_16x16x32_bf16 v[252:255], v[84:87], v[52:55], v[252:255]
    v_mfma_f32_16x16x32_bf16 v[128:131], v[88:91], v[56:59], v[128:131]
    s_waitcnt lgkmcnt(14)
    v_mfma_f32_16x16x32_bf16 v[132:135], v[88:91], v[60:63], v[132:135]
    s_waitcnt lgkmcnt(11)
    v_mfma_f32_16x16x32_bf16 v[136:139], v[88:91], v[64:67], v[136:139]
    s_waitcnt lgkmcnt(8)
    v_mfma_f32_16x16x32_bf16 v[140:143], v[88:91], v[68:71], v[140:143]
    v_mfma_f32_16x16x32_bf16 v[192:195], v[92:95], v[56:59], v[192:195]
    v_mfma_f32_16x16x32_bf16 v[196:199], v[92:95], v[60:63], v[196:199]
    v_mfma_f32_16x16x32_bf16 v[200:203], v[92:95], v[64:67], v[200:203]
    v_mfma_f32_16x16x32_bf16 v[204:207], v[92:95], v[68:71], v[204:207]
    s_waitcnt lgkmcnt(0)
    s_barrier
    v_mfma_f32_16x16x32_bf16 v[144:147], v[96:99], v[56:59], v[144:147]
    ds_read_b64_tr_b16 v[80:81], v26 offset:16384
    v_mfma_f32_16x16x32_bf16 v[148:151], v[96:99], v[60:63], v[148:151]
    ds_read_b64_tr_b16 v[82:83], v26 offset:17408
    v_mfma_f32_16x16x32_bf16 v[152:155], v[96:99], v[64:67], v[152:155]
    ds_read_b128 v[40:43], v18 offset:0
    v_mfma_f32_16x16x32_bf16 v[156:159], v[96:99], v[68:71], v[156:159]
    ds_read_b128 v[44:47], v18 offset:2048
    v_mfma_f32_16x16x32_bf16 v[208:211], v[100:103], v[56:59], v[208:211]
    ds_read_b64_tr_b16 v[84:85], v26 offset:32768
    v_mfma_f32_16x16x32_bf16 v[212:215], v[100:103], v[60:63], v[212:215]
    ds_read_b64_tr_b16 v[86:87], v26 offset:33792
    v_mfma_f32_16x16x32_bf16 v[216:219], v[100:103], v[64:67], v[216:219]
    ds_read_b128 v[48:51], v18 offset:4096
    v_mfma_f32_16x16x32_bf16 v[220:223], v[100:103], v[68:71], v[220:223]
    ds_read_b128 v[52:55], v18 offset:6144
    v_mfma_f32_16x16x32_bf16 v[160:163], v[104:107], v[56:59], v[160:163]
    ds_read_b64_tr_b16 v[88:89], v27 offset:16384
    v_mfma_f32_16x16x32_bf16 v[164:167], v[104:107], v[60:63], v[164:167]
    ds_read_b64_tr_b16 v[90:91], v27 offset:17408
    v_mfma_f32_16x16x32_bf16 v[168:171], v[104:107], v[64:67], v[168:171]
    ds_read_b64_tr_b16 v[92:93], v27 offset:32768
    v_mfma_f32_16x16x32_bf16 v[172:175], v[104:107], v[68:71], v[172:175]
    ds_read_b64_tr_b16 v[94:95], v27 offset:33792
    v_mfma_f32_16x16x32_bf16 v[224:227], v[108:111], v[56:59], v[224:227]
    ds_read_b64_tr_b16 v[96:97], v28 offset:16384
    v_mfma_f32_16x16x32_bf16 v[228:231], v[108:111], v[60:63], v[228:231]
    ds_read_b64_tr_b16 v[98:99], v28 offset:17408
    v_mfma_f32_16x16x32_bf16 v[232:235], v[108:111], v[64:67], v[232:235]
    ds_read_b64_tr_b16 v[100:101], v28 offset:32768
    v_mfma_f32_16x16x32_bf16 v[236:239], v[108:111], v[68:71], v[236:239]
    ds_read_b64_tr_b16 v[102:103], v28 offset:33792
    v_mfma_f32_16x16x32_bf16 v[176:179], v[72:75], v[56:59], v[176:179]
    ds_read_b64_tr_b16 v[104:105], v29 offset:16384
    v_mfma_f32_16x16x32_bf16 v[180:183], v[72:75], v[60:63], v[180:183]
    ds_read_b64_tr_b16 v[106:107], v29 offset:17408
    v_mfma_f32_16x16x32_bf16 v[184:187], v[72:75], v[64:67], v[184:187]
    v_mfma_f32_16x16x32_bf16 v[188:191], v[72:75], v[68:71], v[188:191]
    v_mfma_f32_16x16x32_bf16 v[240:243], v[76:79], v[56:59], v[240:243]
    ds_read_b64_tr_b16 v[108:109], v29 offset:32768
    v_mfma_f32_16x16x32_bf16 v[244:247], v[76:79], v[60:63], v[244:247]
    ds_read_b64_tr_b16 v[110:111], v29 offset:33792
    v_mfma_f32_16x16x32_bf16 v[248:251], v[76:79], v[64:67], v[248:251]
    v_mfma_f32_16x16x32_bf16 v[252:255], v[76:79], v[68:71], v[252:255]
    s_waitcnt lgkmcnt(14)
    v_mfma_f32_16x16x32_bf16 v[128:131], v[80:83], v[40:43], v[128:131]
    ds_read_b64_tr_b16 v[72:73], v26 offset:24576
    v_mfma_f32_16x16x32_bf16 v[132:135], v[80:83], v[44:47], v[132:135]
    ds_read_b64_tr_b16 v[74:75], v26 offset:25600
    s_waitcnt lgkmcnt(14)
    v_mfma_f32_16x16x32_bf16 v[136:139], v[80:83], v[48:51], v[136:139]
    ds_read_b128 v[56:59], v19 offset:0
    v_mfma_f32_16x16x32_bf16 v[140:143], v[80:83], v[52:55], v[140:143]
    v_mfma_f32_16x16x32_bf16 v[192:195], v[84:87], v[40:43], v[192:195]
    ds_read_b64_tr_b16 v[76:77], v26 offset:40960
    v_mfma_f32_16x16x32_bf16 v[196:199], v[84:87], v[44:47], v[196:199]
    ds_read_b64_tr_b16 v[78:79], v26 offset:41984
    v_mfma_f32_16x16x32_bf16 v[200:203], v[84:87], v[48:51], v[200:203]
    ds_read_b128 v[60:63], v19 offset:2048
    v_mfma_f32_16x16x32_bf16 v[204:207], v[84:87], v[52:55], v[204:207]
    s_waitcnt lgkmcnt(14)
    v_mfma_f32_16x16x32_bf16 v[144:147], v[88:91], v[40:43], v[144:147]
    ds_read_b64_tr_b16 v[80:81], v27 offset:24576
    v_mfma_f32_16x16x32_bf16 v[148:151], v[88:91], v[44:47], v[148:151]
    ds_read_b64_tr_b16 v[82:83], v27 offset:25600
    v_mfma_f32_16x16x32_bf16 v[152:155], v[88:91], v[48:51], v[152:155]
    ds_read_b128 v[64:67], v19 offset:4096
    v_mfma_f32_16x16x32_bf16 v[156:159], v[88:91], v[52:55], v[156:159]
    v_mfma_f32_16x16x32_bf16 v[208:211], v[92:95], v[40:43], v[208:211]
    ds_read_b64_tr_b16 v[84:85], v27 offset:40960
    v_mfma_f32_16x16x32_bf16 v[212:215], v[92:95], v[44:47], v[212:215]
    ds_read_b64_tr_b16 v[86:87], v27 offset:41984
    v_mfma_f32_16x16x32_bf16 v[216:219], v[92:95], v[48:51], v[216:219]
    ds_read_b128 v[68:71], v19 offset:6144
    v_mfma_f32_16x16x32_bf16 v[220:223], v[92:95], v[52:55], v[220:223]
    s_waitcnt lgkmcnt(14)
    v_mfma_f32_16x16x32_bf16 v[160:163], v[96:99], v[40:43], v[160:163]
    ds_read_b64_tr_b16 v[88:89], v28 offset:24576
    v_mfma_f32_16x16x32_bf16 v[164:167], v[96:99], v[44:47], v[164:167]
    ds_read_b64_tr_b16 v[90:91], v28 offset:25600
    v_mfma_f32_16x16x32_bf16 v[168:171], v[96:99], v[48:51], v[168:171]
    v_mfma_f32_16x16x32_bf16 v[172:175], v[96:99], v[52:55], v[172:175]
    v_mfma_f32_16x16x32_bf16 v[224:227], v[100:103], v[40:43], v[224:227]
    ds_read_b64_tr_b16 v[92:93], v28 offset:40960
    v_mfma_f32_16x16x32_bf16 v[228:231], v[100:103], v[44:47], v[228:231]
    ds_read_b64_tr_b16 v[94:95], v28 offset:41984
    v_mfma_f32_16x16x32_bf16 v[232:235], v[100:103], v[48:51], v[232:235]
    v_mfma_f32_16x16x32_bf16 v[236:239], v[100:103], v[52:55], v[236:239]
    v_mfma_f32_16x16x32_bf16 v[176:179], v[104:107], v[40:43], v[176:179]
    ds_read_b64_tr_b16 v[96:97], v29 offset:24576
    v_mfma_f32_16x16x32_bf16 v[180:183], v[104:107], v[44:47], v[180:183]
    ds_read_b64_tr_b16 v[98:99], v29 offset:25600
    v_mfma_f32_16x16x32_bf16 v[184:187], v[104:107], v[48:51], v[184:187]
    v_mfma_f32_16x16x32_bf16 v[188:191], v[104:107], v[52:55], v[188:191]
    s_waitcnt lgkmcnt(14)
    v_mfma_f32_16x16x32_bf16 v[240:243], v[108:111], v[40:43], v[240:243]
    ds_read_b64_tr_b16 v[100:101], v29 offset:40960
    v_mfma_f32_16x16x32_bf16 v[244:247], v[108:111], v[44:47], v[244:247]
    ds_read_b64_tr_b16 v[102:103], v29 offset:41984
    v_mfma_f32_16x16x32_bf16 v[248:251], v[108:111], v[48:51], v[248:251]
    v_mfma_f32_16x16x32_bf16 v[252:255], v[108:111], v[52:55], v[252:255]
    v_mfma_f32_16x16x32_bf16 v[128:131], v[72:75], v[56:59], v[128:131]
    s_waitcnt lgkmcnt(14)
    v_mfma_f32_16x16x32_bf16 v[132:135], v[72:75], v[60:63], v[132:135]
    s_waitcnt lgkmcnt(11)
    v_mfma_f32_16x16x32_bf16 v[136:139], v[72:75], v[64:67], v[136:139]
    s_waitcnt lgkmcnt(8)
    v_mfma_f32_16x16x32_bf16 v[140:143], v[72:75], v[68:71], v[140:143]
    v_mfma_f32_16x16x32_bf16 v[192:195], v[76:79], v[56:59], v[192:195]
    v_mfma_f32_16x16x32_bf16 v[196:199], v[76:79], v[60:63], v[196:199]
    v_mfma_f32_16x16x32_bf16 v[200:203], v[76:79], v[64:67], v[200:203]
    v_mfma_f32_16x16x32_bf16 v[204:207], v[76:79], v[68:71], v[204:207]
    s_waitcnt lgkmcnt(0)
    s_barrier
    v_mfma_f32_16x16x32_bf16 v[144:147], v[80:83], v[56:59], v[144:147]
    v_mov_b32 v2, 142080
    ds_read_b32 v3, v2
    v_mfma_f32_16x16x32_bf16 v[148:151], v[80:83], v[60:63], v[148:151]
    v_mfma_f32_16x16x32_bf16 v[152:155], v[80:83], v[64:67], v[152:155]
    v_mfma_f32_16x16x32_bf16 v[156:159], v[80:83], v[68:71], v[156:159]
    v_mfma_f32_16x16x32_bf16 v[208:211], v[84:87], v[56:59], v[208:211]
    v_mfma_f32_16x16x32_bf16 v[212:215], v[84:87], v[60:63], v[212:215]
    v_mfma_f32_16x16x32_bf16 v[216:219], v[84:87], v[64:67], v[216:219]
    v_mfma_f32_16x16x32_bf16 v[220:223], v[84:87], v[68:71], v[220:223]
    v_mfma_f32_16x16x32_bf16 v[160:163], v[88:91], v[56:59], v[160:163]
    v_mfma_f32_16x16x32_bf16 v[164:167], v[88:91], v[60:63], v[164:167]
    v_mfma_f32_16x16x32_bf16 v[168:171], v[88:91], v[64:67], v[168:171]
    v_mfma_f32_16x16x32_bf16 v[172:175], v[88:91], v[68:71], v[172:175]
    v_mfma_f32_16x16x32_bf16 v[224:227], v[92:95], v[56:59], v[224:227]
    v_mfma_f32_16x16x32_bf16 v[228:231], v[92:95], v[60:63], v[228:231]
    v_mfma_f32_16x16x32_bf16 v[232:235], v[92:95], v[64:67], v[232:235]
    v_mfma_f32_16x16x32_bf16 v[236:239], v[92:95], v[68:71], v[236:239]
    v_mfma_f32_16x16x32_bf16 v[176:179], v[96:99], v[56:59], v[176:179]
    v_mfma_f32_16x16x32_bf16 v[180:183], v[96:99], v[60:63], v[180:183]
    v_mfma_f32_16x16x32_bf16 v[184:187], v[96:99], v[64:67], v[184:187]
    v_mfma_f32_16x16x32_bf16 v[188:191], v[96:99], v[68:71], v[188:191]
    v_mfma_f32_16x16x32_bf16 v[240:243], v[100:103], v[56:59], v[240:243]
    v_mfma_f32_16x16x32_bf16 v[244:247], v[100:103], v[60:63], v[244:247]
    v_mfma_f32_16x16x32_bf16 v[248:251], v[100:103], v[64:67], v[248:251]
    v_mfma_f32_16x16x32_bf16 v[252:255], v[100:103], v[68:71], v[252:255]
    s_waitcnt lgkmcnt(0)
    v_readfirstlane_b32 s23, v3
    s_nop 5
    v_pk_mul_f32 v[16:17], v[128:129], s[72:73]
    v_pk_mul_f32 v[18:19], v[130:131], s[72:73]
    v_pk_mul_f32 v[20:21], v[144:145], s[72:73]
    v_pk_mul_f32 v[22:23], v[146:147], s[72:73]
    v_exp_f32 v16, v16
    v_exp_f32 v17, v17
    v_pk_mul_f32 v[192:193], v[128:129], v[192:193]
    v_exp_f32 v18, v18
    v_exp_f32 v19, v19
    v_pk_mul_f32 v[194:195], v[130:131], v[194:195]
    v_exp_f32 v20, v20
    v_exp_f32 v21, v21
    v_pk_mul_f32 v[208:209], v[144:145], v[208:209]
    v_exp_f32 v22, v22
    v_exp_f32 v23, v23
    v_pk_mul_f32 v[210:211], v[146:147], v[210:211]
    v_pk_add_f32 v[16:17], v[16:17], 1.0 op_sel_hi:[1,0]
    v_pk_add_f32 v[18:19], v[18:19], 1.0 op_sel_hi:[1,0]
    v_pk_add_f32 v[20:21], v[20:21], 1.0 op_sel_hi:[1,0]
    v_pk_add_f32 v[22:23], v[22:23], 1.0 op_sel_hi:[1,0]
    v_rcp_f32 v16, v16
    v_rcp_f32 v17, v17
    v_rcp_f32 v18, v18
    v_rcp_f32 v19, v19
    v_rcp_f32 v20, v20
    v_rcp_f32 v21, v21
    v_rcp_f32 v22, v22
    v_rcp_f32 v23, v23
    v_pk_mul_f32 v[192:193], v[192:193], v[16:17]
    v_pk_mul_f32 v[194:195], v[194:195], v[18:19]
    v_pk_mul_f32 v[208:209], v[208:209], v[20:21]
    v_pk_mul_f32 v[210:211], v[210:211], v[22:23]
    v_cvt_pk_bf16_f32 v40, v192, v193
    v_cvt_pk_bf16_f32 v41, v194, v195
    v_cvt_pk_bf16_f32 v42, v208, v209
    v_cvt_pk_bf16_f32 v43, v210, v211
    buffer_store_dwordx4 v[40:43], v34, s[56:59], s70 offen offset:0 sc1
    v_pk_mul_f32 v[16:17], v[132:133], s[72:73]
    v_pk_mul_f32 v[18:19], v[134:135], s[72:73]
    v_pk_mul_f32 v[20:21], v[148:149], s[72:73]
    v_pk_mul_f32 v[22:23], v[150:151], s[72:73]
    v_exp_f32 v16, v16
    v_exp_f32 v17, v17
    v_pk_mul_f32 v[196:197], v[132:133], v[196:197]
    v_exp_f32 v18, v18
    v_exp_f32 v19, v19
    v_pk_mul_f32 v[198:199], v[134:135], v[198:199]
    v_exp_f32 v20, v20
    v_exp_f32 v21, v21
    v_pk_mul_f32 v[212:213], v[148:149], v[212:213]
    v_exp_f32 v22, v22
    v_exp_f32 v23, v23
    v_pk_mul_f32 v[214:215], v[150:151], v[214:215]
    v_pk_add_f32 v[16:17], v[16:17], 1.0 op_sel_hi:[1,0]
    v_pk_add_f32 v[18:19], v[18:19], 1.0 op_sel_hi:[1,0]
    v_pk_add_f32 v[20:21], v[20:21], 1.0 op_sel_hi:[1,0]
    v_pk_add_f32 v[22:23], v[22:23], 1.0 op_sel_hi:[1,0]
    v_rcp_f32 v16, v16
    v_rcp_f32 v17, v17
    v_rcp_f32 v18, v18
    v_rcp_f32 v19, v19
    v_rcp_f32 v20, v20
    v_rcp_f32 v21, v21
    v_rcp_f32 v22, v22
    v_rcp_f32 v23, v23
    v_pk_mul_f32 v[196:197], v[196:197], v[16:17]
    v_pk_mul_f32 v[198:199], v[198:199], v[18:19]
    v_pk_mul_f32 v[212:213], v[212:213], v[20:21]
    v_pk_mul_f32 v[214:215], v[214:215], v[22:23]
    v_cvt_pk_bf16_f32 v48, v196, v197
    v_cvt_pk_bf16_f32 v49, v198, v199
    v_cvt_pk_bf16_f32 v50, v212, v213
    v_cvt_pk_bf16_f32 v51, v214, v215
    buffer_store_dwordx4 v[48:51], v34, s[56:59], s70 offen offset:256 sc1
    v_pk_mul_f32 v[16:17], v[136:137], s[72:73]
    v_pk_mul_f32 v[18:19], v[138:139], s[72:73]
    v_pk_mul_f32 v[20:21], v[152:153], s[72:73]
    v_pk_mul_f32 v[22:23], v[154:155], s[72:73]
    v_exp_f32 v16, v16
    v_exp_f32 v17, v17
    v_pk_mul_f32 v[200:201], v[136:137], v[200:201]
    v_exp_f32 v18, v18
    v_exp_f32 v19, v19
    v_pk_mul_f32 v[202:203], v[138:139], v[202:203]
    v_exp_f32 v20, v20
    v_exp_f32 v21, v21
    v_pk_mul_f32 v[216:217], v[152:153], v[216:217]
    v_exp_f32 v22, v22
    v_exp_f32 v23, v23
    v_pk_mul_f32 v[218:219], v[154:155], v[218:219]
    v_pk_add_f32 v[16:17], v[16:17], 1.0 op_sel_hi:[1,0]
    v_pk_add_f32 v[18:19], v[18:19], 1.0 op_sel_hi:[1,0]
    v_pk_add_f32 v[20:21], v[20:21], 1.0 op_sel_hi:[1,0]
    v_pk_add_f32 v[22:23], v[22:23], 1.0 op_sel_hi:[1,0]
    v_rcp_f32 v16, v16
    v_rcp_f32 v17, v17
    v_rcp_f32 v18, v18
    v_rcp_f32 v19, v19
    v_rcp_f32 v20, v20
    v_rcp_f32 v21, v21
    v_rcp_f32 v22, v22
    v_rcp_f32 v23, v23
    v_pk_mul_f32 v[200:201], v[200:201], v[16:17]
    v_pk_mul_f32 v[202:203], v[202:203], v[18:19]
    v_pk_mul_f32 v[216:217], v[216:217], v[20:21]
    v_pk_mul_f32 v[218:219], v[218:219], v[22:23]
    v_cvt_pk_bf16_f32 v56, v200, v201
    v_cvt_pk_bf16_f32 v57, v202, v203
    v_cvt_pk_bf16_f32 v58, v216, v217
    v_cvt_pk_bf16_f32 v59, v218, v219
    buffer_store_dwordx4 v[56:59], v34, s[56:59], s71 offen offset:0 sc1
    v_pk_mul_f32 v[16:17], v[140:141], s[72:73]
    v_pk_mul_f32 v[18:19], v[142:143], s[72:73]
    v_pk_mul_f32 v[20:21], v[156:157], s[72:73]
    v_pk_mul_f32 v[22:23], v[158:159], s[72:73]
    v_exp_f32 v16, v16
    v_exp_f32 v17, v17
    v_pk_mul_f32 v[204:205], v[140:141], v[204:205]
    v_exp_f32 v18, v18
    v_exp_f32 v19, v19
    v_pk_mul_f32 v[206:207], v[142:143], v[206:207]
    v_exp_f32 v20, v20
    v_exp_f32 v21, v21
    v_pk_mul_f32 v[220:221], v[156:157], v[220:221]
    v_exp_f32 v22, v22
    v_exp_f32 v23, v23
    v_pk_mul_f32 v[222:223], v[158:159], v[222:223]
    v_pk_add_f32 v[16:17], v[16:17], 1.0 op_sel_hi:[1,0]
    v_pk_add_f32 v[18:19], v[18:19], 1.0 op_sel_hi:[1,0]
    v_pk_add_f32 v[20:21], v[20:21], 1.0 op_sel_hi:[1,0]
    v_pk_add_f32 v[22:23], v[22:23], 1.0 op_sel_hi:[1,0]
    v_rcp_f32 v16, v16
    v_rcp_f32 v17, v17
    v_rcp_f32 v18, v18
    v_rcp_f32 v19, v19
    v_rcp_f32 v20, v20
    v_rcp_f32 v21, v21
    v_rcp_f32 v22, v22
    v_rcp_f32 v23, v23
    v_pk_mul_f32 v[204:205], v[204:205], v[16:17]
    v_pk_mul_f32 v[206:207], v[206:207], v[18:19]
    v_pk_mul_f32 v[220:221], v[220:221], v[20:21]
    v_pk_mul_f32 v[222:223], v[222:223], v[22:23]
    v_cvt_pk_bf16_f32 v64, v204, v205
    v_cvt_pk_bf16_f32 v65, v206, v207
    v_cvt_pk_bf16_f32 v66, v220, v221
    v_cvt_pk_bf16_f32 v67, v222, v223
    buffer_store_dwordx4 v[64:67], v34, s[56:59], s71 offen offset:256 sc1
    v_pk_mul_f32 v[24:25], v[160:161], s[72:73]
    v_pk_mul_f32 v[26:27], v[162:163], s[72:73]
    v_pk_mul_f32 v[28:29], v[176:177], s[72:73]
    v_pk_mul_f32 v[30:31], v[178:179], s[72:73]
    v_exp_f32 v24, v24
    v_exp_f32 v25, v25
    v_pk_mul_f32 v[224:225], v[160:161], v[224:225]
    v_exp_f32 v26, v26
    v_exp_f32 v27, v27
    v_pk_mul_f32 v[226:227], v[162:163], v[226:227]
    v_exp_f32 v28, v28
    v_exp_f32 v29, v29
    v_pk_mul_f32 v[240:241], v[176:177], v[240:241]
    v_exp_f32 v30, v30
    v_exp_f32 v31, v31
    v_pk_mul_f32 v[242:243], v[178:179], v[242:243]
    v_pk_add_f32 v[24:25], v[24:25], 1.0 op_sel_hi:[1,0]
    v_pk_add_f32 v[26:27], v[26:27], 1.0 op_sel_hi:[1,0]
    v_pk_add_f32 v[28:29], v[28:29], 1.0 op_sel_hi:[1,0]
    v_pk_add_f32 v[30:31], v[30:31], 1.0 op_sel_hi:[1,0]
    v_rcp_f32 v24, v24
    v_rcp_f32 v25, v25
    v_rcp_f32 v26, v26
    v_rcp_f32 v27, v27
    v_rcp_f32 v28, v28
    v_rcp_f32 v29, v29
    v_rcp_f32 v30, v30
    v_rcp_f32 v31, v31
    v_pk_mul_f32 v[224:225], v[224:225], v[24:25]
    v_pk_mul_f32 v[226:227], v[226:227], v[26:27]
    v_pk_mul_f32 v[240:241], v[240:241], v[28:29]
    v_pk_mul_f32 v[242:243], v[242:243], v[30:31]
    v_cvt_pk_bf16_f32 v44, v224, v225
    v_cvt_pk_bf16_f32 v45, v226, v227
    v_cvt_pk_bf16_f32 v46, v240, v241
    v_cvt_pk_bf16_f32 v47, v242, v243
    buffer_store_dwordx4 v[44:47], v34, s[56:59], s70 offen offset:2048 sc1
    v_pk_mul_f32 v[24:25], v[164:165], s[72:73]
    v_pk_mul_f32 v[26:27], v[166:167], s[72:73]
    v_pk_mul_f32 v[28:29], v[180:181], s[72:73]
    v_pk_mul_f32 v[30:31], v[182:183], s[72:73]
    v_exp_f32 v24, v24
    v_exp_f32 v25, v25
    v_pk_mul_f32 v[228:229], v[164:165], v[228:229]
    v_exp_f32 v26, v26
    v_exp_f32 v27, v27
    v_pk_mul_f32 v[230:231], v[166:167], v[230:231]
    v_exp_f32 v28, v28
    v_exp_f32 v29, v29
    v_pk_mul_f32 v[244:245], v[180:181], v[244:245]
    v_exp_f32 v30, v30
    v_exp_f32 v31, v31
    v_pk_mul_f32 v[246:247], v[182:183], v[246:247]
    v_pk_add_f32 v[24:25], v[24:25], 1.0 op_sel_hi:[1,0]
    v_pk_add_f32 v[26:27], v[26:27], 1.0 op_sel_hi:[1,0]
    v_pk_add_f32 v[28:29], v[28:29], 1.0 op_sel_hi:[1,0]
    v_pk_add_f32 v[30:31], v[30:31], 1.0 op_sel_hi:[1,0]
    v_rcp_f32 v24, v24
    v_rcp_f32 v25, v25
    v_rcp_f32 v26, v26
    v_rcp_f32 v27, v27
    v_rcp_f32 v28, v28
    v_rcp_f32 v29, v29
    v_rcp_f32 v30, v30
    v_rcp_f32 v31, v31
    v_pk_mul_f32 v[228:229], v[228:229], v[24:25]
    v_pk_mul_f32 v[230:231], v[230:231], v[26:27]
    v_pk_mul_f32 v[244:245], v[244:245], v[28:29]
    v_pk_mul_f32 v[246:247], v[246:247], v[30:31]
    v_cvt_pk_bf16_f32 v52, v228, v229
    v_cvt_pk_bf16_f32 v53, v230, v231
    v_cvt_pk_bf16_f32 v54, v244, v245
    v_cvt_pk_bf16_f32 v55, v246, v247
    buffer_store_dwordx4 v[52:55], v34, s[56:59], s70 offen offset:2304 sc1
    v_pk_mul_f32 v[24:25], v[168:169], s[72:73]
    v_pk_mul_f32 v[26:27], v[170:171], s[72:73]
    v_pk_mul_f32 v[28:29], v[184:185], s[72:73]
    v_pk_mul_f32 v[30:31], v[186:187], s[72:73]
    v_exp_f32 v24, v24
    v_exp_f32 v25, v25
    v_pk_mul_f32 v[232:233], v[168:169], v[232:233]
    v_exp_f32 v26, v26
    v_exp_f32 v27, v27
    v_pk_mul_f32 v[234:235], v[170:171], v[234:235]
    v_exp_f32 v28, v28
    v_exp_f32 v29, v29
    v_pk_mul_f32 v[248:249], v[184:185], v[248:249]
    v_exp_f32 v30, v30
    v_exp_f32 v31, v31
    v_pk_mul_f32 v[250:251], v[186:187], v[250:251]
    v_pk_add_f32 v[24:25], v[24:25], 1.0 op_sel_hi:[1,0]
    v_pk_add_f32 v[26:27], v[26:27], 1.0 op_sel_hi:[1,0]
    v_pk_add_f32 v[28:29], v[28:29], 1.0 op_sel_hi:[1,0]
    v_pk_add_f32 v[30:31], v[30:31], 1.0 op_sel_hi:[1,0]
    v_rcp_f32 v24, v24
    v_rcp_f32 v25, v25
    v_rcp_f32 v26, v26
    v_rcp_f32 v27, v27
    v_rcp_f32 v28, v28
    v_rcp_f32 v29, v29
    v_rcp_f32 v30, v30
    v_rcp_f32 v31, v31
    v_pk_mul_f32 v[232:233], v[232:233], v[24:25]
    v_pk_mul_f32 v[234:235], v[234:235], v[26:27]
    v_pk_mul_f32 v[248:249], v[248:249], v[28:29]
    v_pk_mul_f32 v[250:251], v[250:251], v[30:31]
    v_cvt_pk_bf16_f32 v60, v232, v233
    v_cvt_pk_bf16_f32 v61, v234, v235
    v_cvt_pk_bf16_f32 v62, v248, v249
    v_cvt_pk_bf16_f32 v63, v250, v251
    buffer_store_dwordx4 v[60:63], v34, s[56:59], s71 offen offset:2048 sc1
    v_pk_mul_f32 v[24:25], v[172:173], s[72:73]
    v_pk_mul_f32 v[26:27], v[174:175], s[72:73]
    v_pk_mul_f32 v[28:29], v[188:189], s[72:73]
    v_pk_mul_f32 v[30:31], v[190:191], s[72:73]
    v_exp_f32 v24, v24
    v_exp_f32 v25, v25
    v_pk_mul_f32 v[236:237], v[172:173], v[236:237]
    v_exp_f32 v26, v26
    v_exp_f32 v27, v27
    v_pk_mul_f32 v[238:239], v[174:175], v[238:239]
    v_exp_f32 v28, v28
    v_exp_f32 v29, v29
    v_pk_mul_f32 v[252:253], v[188:189], v[252:253]
    v_exp_f32 v30, v30
    v_exp_f32 v31, v31
    v_pk_mul_f32 v[254:255], v[190:191], v[254:255]
    v_pk_add_f32 v[24:25], v[24:25], 1.0 op_sel_hi:[1,0]
    v_pk_add_f32 v[26:27], v[26:27], 1.0 op_sel_hi:[1,0]
    v_pk_add_f32 v[28:29], v[28:29], 1.0 op_sel_hi:[1,0]
    v_pk_add_f32 v[30:31], v[30:31], 1.0 op_sel_hi:[1,0]
    v_rcp_f32 v24, v24
    v_rcp_f32 v25, v25
    v_rcp_f32 v26, v26
    v_rcp_f32 v27, v27
    v_rcp_f32 v28, v28
    v_rcp_f32 v29, v29
    v_rcp_f32 v30, v30
    v_rcp_f32 v31, v31
    v_pk_mul_f32 v[236:237], v[236:237], v[24:25]
    v_pk_mul_f32 v[238:239], v[238:239], v[26:27]
    v_pk_mul_f32 v[252:253], v[252:253], v[28:29]
    v_pk_mul_f32 v[254:255], v[254:255], v[30:31]
    v_cvt_pk_bf16_f32 v68, v236, v237
    v_cvt_pk_bf16_f32 v69, v238, v239
    v_cvt_pk_bf16_f32 v70, v252, v253
    v_cvt_pk_bf16_f32 v71, v254, v255
    buffer_store_dwordx4 v[68:71], v34, s[56:59], s71 offen offset:2304 sc1
L_GEMM2:
    s_setprio 2
    v_mov_b32 v2, 0
    v_mov_b32 v3, s23
    s_mov_b32 s77, 0x100000
    s_waitcnt vmcnt(0)
    s_mov_b64 exec, 1
    buffer_store_dword v3, v2, s[56:59], s3 offen sc1
    s_mov_b64 exec, -1
    s_barrier
    s_and_b32 s74, s11, 1
    s_lshl_b32 s14, s11, 14
    s_lshl_b32 s74, s74, 13
    s_sub_u32 s14, s14, s74
    s_add_u32 m0, s8, 28672
    s_add_u32 s14, s14, s10
    buffer_load_dwordx4 v112, s[60:63], s14 offen lds
    s_add_u32 s11, s11, 1
    s_cmp_ge_u32 s11, 28
    s_cselect_b32 s11, 0, s11
    buffer_load_dwordx4 v113, s[60:63], s14 offen offset:1024 lds
    s_and_b32 s74, s11, 1
    s_lshl_b32 s14, s11, 14
    s_lshl_b32 s74, s74, 13
    s_sub_u32 s14, s14, s74
    s_add_u32 m0, s8, 30720
    s_add_u32 s14, s14, s10
    buffer_load_dwordx4 v112, s[60:63], s14 offen lds
    s_add_u32 s11, s11, 1
    s_cmp_ge_u32 s11, 28
    s_cselect_b32 s11, 0, s11
    buffer_load_dwordx4 v113, s[60:63], s14 offen offset:1024 lds
    ds_read_b64_tr_b16 v[16:17], v114 offset:0
    ds_read_b64_tr_b16 v[18:19], v114 offset:1024
    ds_read_b64_tr_b16 v[20:21], v115 offset:0
    ds_read_b64_tr_b16 v[22:23], v115 offset:1024
    ds_read_b64_tr_b16 v[24:25], v114 offset:2048
    ds_read_b64_tr_b16 v[26:27], v114 offset:3072
    ds_read_b64_tr_b16 v[28:29], v115 offset:2048
    ds_read_b64_tr_b16 v[30:31], v115 offset:3072
    s_waitcnt lgkmcnt(4)
    s_and_b32 s74, s11, 1
    s_lshl_b32 s14, s11, 14
    s_lshl_b32 s74, s74, 13
    s_sub_u32 s14, s14, s74
    s_add_u32 m0, s8, 0
    s_add_u32 s14, s14, s10
    buffer_load_dwordx4 v112, s[60:63], s14 offen lds
    s_add_u32 s11, s11, 1
    s_cmp_ge_u32 s11, 28
    s_cselect_b32 s11, 0, s11
    buffer_load_dwordx4 v113, s[60:63], s14 offen offset:1024 lds
    ds_read_b64_tr_b16 v[32:33], v114 offset:4096
    ds_read_b64_tr_b16 v[34:35], v114 offset:5120
    ds_read_b64_tr_b16 v[36:37], v115 offset:4096
    ds_read_b64_tr_b16 v[38:39], v115 offset:5120
    s_waitcnt lgkmcnt(4)
    s_and_b32 s74, s11, 1
    s_lshl_b32 s14, s11, 14
    s_lshl_b32 s74, s74, 13
    s_sub_u32 s14, s14, s74
    s_add_u32 m0, s8, 2048
    s_add_u32 s14, s14, s10
    buffer_load_dwordx4 v112, s[60:63], s14 offen lds
    s_add_u32 s11, s11, 1
    s_cmp_ge_u32 s11, 28
    s_cselect_b32 s11, 0, s11
    buffer_load_dwordx4 v113, s[60:63], s14 offen offset:1024 lds
    ds_read_b64_tr_b16 v[40:41], v114 offset:6144
    ds_read_b64_tr_b16 v[42:43], v114 offset:7168
    ds_read_b64_tr_b16 v[44:45], v115 offset:6144
    ds_read_b64_tr_b16 v[46:47], v115 offset:7168
    s_waitcnt lgkmcnt(4)
    s_and_b32 s74, s11, 1
    s_lshl_b32 s14, s11, 14
    s_lshl_b32 s74, s74, 13
    s_sub_u32 s14, s14, s74
    s_add_u32 m0, s8, 4096
    s_add_u32 s14, s14, s10
    buffer_load_dwordx4 v112, s[60:63], s14 offen lds
    s_add_u32 s11, s11, 1
    s_cmp_ge_u32 s11, 28
    s_cselect_b32 s11, 0, s11
    buffer_load_dwordx4 v113, s[60:63], s14 offen offset:1024 lds
    ds_read_b64_tr_b16 v[48:49], v114 offset:8192
    ds_read_b64_tr_b16 v[50:51], v114 offset:9216
    ds_read_b64_tr_b16 v[52:53], v115 offset:8192
    ds_read_b64_tr_b16 v[54:55], v115 offset:9216
    s_waitcnt lgkmcnt(4)
    s_and_b32 s74, s11, 1
    s_lshl_b32 s14, s11, 14
    s_lshl_b32 s74, s74, 13
    s_sub_u32 s14, s14, s74
    s_add_u32 m0, s8, 6144
    s_add_u32 s14, s14, s10
    buffer_load_dwordx4 v112, s[60:63], s14 offen lds
    s_add_u32 s11, s11, 1
    s_cmp_ge_u32 s11, 28
    s_cselect_b32 s11, 0, s11
    buffer_load_dwordx4 v113, s[60:63], s14 offen offset:1024 lds
    ds_read_b64_tr_b16 v[56:57], v114 offset:10240
    ds_read_b64_tr_b16 v[58:59], v114 offset:11264
    ds_read_b64_tr_b16 v[60:61], v115 offset:10240
    ds_read_b64_tr_b16 v[62:63], v115 offset:11264
    s_waitcnt lgkmcnt(4)
    s_and_b32 s74, s11, 1
    s_lshl_b32 s14, s11, 14
    s_lshl_b32 s74, s74, 13
    s_sub_u32 s14, s14, s74
    s_add_u32 m0, s8, 8192
    s_add_u32 s14, s14, s10
    buffer_load_dwordx4 v112, s[60:63], s14 offen lds
    s_add_u32 s11, s11, 1
    s_cmp_ge_u32 s11, 28
    s_cselect_b32 s11, 0, s11
    buffer_load_dwordx4 v113, s[60:63], s14 offen offset:1024 lds
    ds_read_b64_tr_b16 v[64:65], v114 offset:12288
    ds_read_b64_tr_b16 v[66:67], v114 offset:13312
    ds_read_b64_tr_b16 v[68:69], v115 offset:12288
    ds_read_b64_tr_b16 v[70:71], v115 offset:13312
    s_waitcnt lgkmcnt(4)
    s_and_b32 s74, s11, 1
    s_lshl_b32 s14, s11, 14
    s_lshl_b32 s74, s74, 13
    s_sub_u32 s14, s14, s74
    s_add_u32 m0, s8, 10240
    s_add_u32 s14, s14, s10
    buffer_load_dwordx4 v112, s[60:63], s14 offen lds
    s_add_u32 s11, s11, 1
    s_cmp_ge_u32 s11, 28
    s_cselect_b32 s11, 0, s11
    buffer_load_dwordx4 v113, s[60:63], s14 offen offset:1024 lds
    buffer_load_dword v4, v117, s[56:59], s15 offen sc1
    ds_read_b64_tr_b16 v[72:73], v114 offset:14336
    ds_read_b64_tr_b16 v[74:75], v114 offset:15360
    ds_read_b64_tr_b16 v[76:77], v115 offset:14336
    ds_read_b64_tr_b16 v[78:79], v115 offset:15360
    s_waitcnt lgkmcnt(4)
    s_and_b32 s74, s11, 1
    s_lshl_b32 s14, s11, 14
    s_lshl_b32 s74, s74, 13
    s_sub_u32 s14, s14, s74
    s_add_u32 m0, s8, 12288
    s_add_u32 s14, s14, s10
    buffer_load_dwordx4 v112, s[60:63], s14 offen lds
    s_add_u32 s11, s11, 1
    s_cmp_ge_u32 s11, 28
    s_cselect_b32 s11, 0, s11
    buffer_load_dwordx4 v113, s[60:63], s14 offen offset:1024 lds
    ds_read_b64_tr_b16 v[80:81], v114 offset:16384
    ds_read_b64_tr_b16 v[82:83], v114 offset:17408
    ds_read_b64_tr_b16 v[84:85], v115 offset:16384
    ds_read_b64_tr_b16 v[86:87], v115 offset:17408
    s_waitcnt lgkmcnt(4)
    s_and_b32 s74, s11, 1
    s_lshl_b32 s14, s11, 14
    s_lshl_b32 s74, s74, 13
    s_sub_u32 s14, s14, s74
    s_add_u32 m0, s8, 14336
    s_add_u32 s14, s14, s10
    buffer_load_dwordx4 v112, s[60:63], s14 offen lds
    s_add_u32 s11, s11, 1
    s_cmp_ge_u32 s11, 28
    s_cselect_b32 s11, 0, s11
    buffer_load_dwordx4 v113, s[60:63], s14 offen offset:1024 lds
    ds_read_b64_tr_b16 v[88:89], v114 offset:18432
    ds_read_b64_tr_b16 v[90:91], v114 offset:19456
    ds_read_b64_tr_b16 v[92:93], v115 offset:18432
    ds_read_b64_tr_b16 v[94:95], v115 offset:19456
    s_waitcnt lgkmcnt(4)
    s_and_b32 s74, s11, 1
    s_lshl_b32 s14, s11, 14
    s_lshl_b32 s74, s74, 13
    s_sub_u32 s14, s14, s74
    s_add_u32 m0, s8, 16384
    s_add_u32 s14, s14, s10
    buffer_load_dwordx4 v112, s[60:63], s14 offen lds
    s_add_u32 s11, s11, 1
    s_cmp_ge_u32 s11, 28
    s_cselect_b32 s11, 0, s11
    buffer_load_dwordx4 v113, s[60:63], s14 offen offset:1024 lds
    ds_read_b64_tr_b16 v[96:97], v114 offset:20480
    ds_read_b64_tr_b16 v[98:99], v114 offset:21504
    ds_read_b64_tr_b16 v[100:101], v115 offset:20480
    ds_read_b64_tr_b16 v[102:103], v115 offset:21504
    s_waitcnt lgkmcnt(4)
    s_and_b32 s74, s11, 1
    s_lshl_b32 s14, s11, 14
    s_lshl_b32 s74, s74, 13
    s_sub_u32 s14, s14, s74
    s_add_u32 m0, s8, 18432
    s_add_u32 s14, s14, s10
    buffer_load_dwordx4 v112, s[60:63], s14 offen lds
    s_add_u32 s11, s11, 1
    s_cmp_ge_u32 s11, 28
    s_cselect_b32 s11, 0, s11
    buffer_load_dwordx4 v113, s[60:63], s14 offen offset:1024 lds
    ds_read_b64_tr_b16 v[104:105], v114 offset:22528
    ds_read_b64_tr_b16 v[106:107], v114 offset:23552
    ds_read_b64_tr_b16 v[108:109], v115 offset:22528
    ds_read_b64_tr_b16 v[110:111], v115 offset:23552
    s_waitcnt lgkmcnt(4)
    s_and_b32 s74, s11, 1
    s_lshl_b32 s14, s11, 14
    s_lshl_b32 s74, s74, 13
    s_sub_u32 s14, s14, s74
    s_add_u32 m0, s8, 20480
    s_add_u32 s14, s14, s10
    buffer_load_dwordx4 v112, s[60:63], s14 offen lds
    s_add_u32 s11, s11, 1
    s_cmp_ge_u32 s11, 28
    s_cselect_b32 s11, 0, s11
    buffer_load_dwordx4 v113, s[60:63], s14 offen offset:1024 lds
    s_waitcnt lgkmcnt(0)
    s_and_b32 s74, s11, 1
    s_lshl_b32 s14, s11, 14
    s_lshl_b32 s74, s74, 13
    s_sub_u32 s14, s14, s74
    s_add_u32 m0, s8, 22528
    s_add_u32 s14, s14, s10
    buffer_load_dwordx4 v112, s[60:63], s14 offen lds
    s_add_u32 s11, s11, 1
    s_cmp_ge_u32 s11, 28
    s_cselect_b32 s11, 0, s11
    buffer_load_dwordx4 v113, s[60:63], s14 offen offset:1024 lds
    s_waitcnt vmcnt(12)
    s_branch PH_CHK
PH_SPIN:
    s_sleep 2
    buffer_load_dword v4, v117, s[56:59], s15 offen sc1
    s_waitcnt vmcnt(0)
    s_sub_u32 s77, s77, 1
    s_cmp_eq_u32 s77, 0
    s_cbranch_scc1 PH_OK
PH_CHK:
    v_cmp_eq_u32 vcc, s23, v4
    s_nop 3
    s_cmp_eq_u64 vcc, exec
    s_cbranch_scc0 PH_SPIN
PH_OK:
    s_lshl_b32 s13, s12, 10
    s_add_u32 s13, s13, s9
    buffer_load_dwordx4 v[144:147], v1, s[56:59], s13 offen sc1
    s_add_u32 s13, s13, s22
    s_add_u32 s12, s12, 1
    s_cmp_ge_u32 s12, 28
    s_cselect_b32 s12, 0, s12
    buffer_load_dwordx4 v[148:151], v1, s[56:59], s13 offen sc1
    s_lshl_b32 s13, s12, 10
    s_add_u32 s13, s13, s9
    buffer_load_dwordx4 v[152:155], v1, s[56:59], s13 offen sc1
    s_add_u32 s13, s13, s22
    s_add_u32 s12, s12, 1
    s_cmp_ge_u32 s12, 28
    s_cselect_b32 s12, 0, s12
    buffer_load_dwordx4 v[156:159], v1, s[56:59], s13 offen sc1
    s_lshl_b32 s13, s12, 10
    s_add_u32 s13, s13, s9
    buffer_load_dwordx4 v[160:163], v1, s[56:59], s13 offen sc1
    s_add_u32 s13, s13, s22
    s_add_u32 s12, s12, 1
    s_cmp_ge_u32 s12, 28
    s_cselect_b32 s12, 0, s12
    buffer_load_dwordx4 v[164:167], v1, s[56:59], s13 offen sc1
    s_lshl_b32 s13, s12, 10
    s_add_u32 s13, s13, s9
    buffer_load_dwordx4 v[168:171], v1, s[56:59], s13 offen sc1
    s_add_u32 s13, s13, s22
    s_add_u32 s12, s12, 1
    s_cmp_ge_u32 s12, 28
    s_cselect_b32 s12, 0, s12
    buffer_load_dwordx4 v[172:175], v1, s[56:59], s13 offen sc1
    s_lshl_b32 s13, s12, 10
    s_add_u32 s13, s13, s9
    buffer_load_dwordx4 v[176:179], v1, s[56:59], s13 offen sc1
    s_add_u32 s13, s13, s22
    s_add_u32 s12, s12, 1
    s_cmp_ge_u32 s12, 28
    s_cselect_b32 s12, 0, s12
    buffer_load_dwordx4 v[180:183], v1, s[56:59], s13 offen sc1
    s_lshl_b32 s13, s12, 10
    s_add_u32 s13, s13, s9
    buffer_load_dwordx4 v[184:187], v1, s[56:59], s13 offen sc1
    s_add_u32 s13, s13, s22
    s_add_u32 s12, s12, 1
    s_cmp_ge_u32 s12, 28
    s_cselect_b32 s12, 0, s12
    buffer_load_dwordx4 v[188:191], v1, s[56:59], s13 offen sc1
    s_waitcnt lgkmcnt(0)
    s_waitcnt vmcnt(10)
    v_mfma_f32_32x32x16_bf16 v[192:207], v[16:19], v[144:147], 0
    v_mfma_f32_32x32x16_bf16 v[224:239], v[16:19], v[148:151], 0
    v_mfma_f32_32x32x16_bf16 v[208:223], v[20:23], v[144:147], 0
    v_mfma_f32_32x32x16_bf16 v[240:255], v[20:23], v[148:151], 0
    s_waitcnt vmcnt(8)
    v_mfma_f32_32x32x16_bf16 v[192:207], v[24:27], v[152:155], v[192:207]
    s_lshl_b32 s13, s12, 10
    s_add_u32 s13, s13, s9
    buffer_load_dwordx4 v[144:147], v1, s[56:59], s13 offen sc1
    v_mfma_f32_32x32x16_bf16 v[224:239], v[24:27], v[156:159], v[224:239]
    s_add_u32 s13, s13, s22
    s_add_u32 s12, s12, 1
    s_cmp_ge_u32 s12, 28
    s_cselect_b32 s12, 0, s12
    buffer_load_dwordx4 v[148:151], v1, s[56:59], s13 offen sc1
    v_mfma_f32_32x32x16_bf16 v[208:223], v[28:31], v[152:155], v[208:223]
    v_mfma_f32_32x32x16_bf16 v[240:255], v[28:31], v[156:159], v[240:255]
    s_waitcnt vmcnt(8)
    v_mfma_f32_32x32x16_bf16 v[192:207], v[32:35], v[160:163], v[192:207]
    s_lshl_b32 s13, s12, 10
    s_add_u32 s13, s13, s9
    buffer_load_dwordx4 v[152:155], v1, s[56:59], s13 offen sc1
    v_mfma_f32_32x32x16_bf16 v[224:239], v[32:35], v[164:167], v[224:239]
    s_add_u32 s13, s13, s22
    s_add_u32 s12, s12, 1
    s_cmp_ge_u32 s12, 28
    s_cselect_b32 s12, 0, s12
    buffer_load_dwordx4 v[156:159], v1, s[56:59], s13 offen sc1
    v_mfma_f32_32x32x16_bf16 v[208:223], v[36:39], v[160:163], v[208:223]
    v_mfma_f32_32x32x16_bf16 v[240:255], v[36:39], v[164:167], v[240:255]
    s_waitcnt vmcnt(8)
    v_mfma_f32_32x32x16_bf16 v[192:207], v[40:43], v[168:171], v[192:207]
    s_lshl_b32 s13, s12, 10
    s_add_u32 s13, s13, s9
    buffer_load_dwordx4 v[160:163], v1, s[56:59], s13 offen sc1
    v_mfma_f32_32x32x16_bf16 v[224:239], v[40:43], v[172:175], v[224:239]
    s_add_u32 s13, s13, s22
    s_add_u32 s12, s12, 1
    s_cmp_ge_u32 s12, 28
    s_cselect_b32 s12, 0, s12
    buffer_load_dwordx4 v[164:167], v1, s[56:59], s13 offen sc1
    v_mfma_f32_32x32x16_bf16 v[208:223], v[44:47], v[168:171], v[208:223]
    v_mfma_f32_32x32x16_bf16 v[240:255], v[44:47], v[172:175], v[240:255]
    s_waitcnt vmcnt(8)
    v_mfma_f32_32x32x16_bf16 v[192:207], v[48:51], v[176:179], v[192:207]
    s_lshl_b32 s13, s12, 10
    s_add_u32 s13, s13, s9
    buffer_load_dwordx4 v[168:171], v1, s[56:59], s13 offen sc1
    v_mfma_f32_32x32x16_bf16 v[224:239], v[48:51], v[180:183], v[224:239]
    s_add_u32 s13, s13, s22
    s_add_u32 s12, s12, 1
    s_cmp_ge_u32 s12, 28
    s_cselect_b32 s12, 0, s12
    buffer_load_dwordx4 v[172:175], v1, s[56:59], s13 offen sc1
    v_mfma_f32_32x32x16_bf16 v[208:223], v[52:55], v[176:179], v[208:223]
    v_mfma_f32_32x32x16_bf16 v[240:255], v[52:55], v[180:183], v[240:255]
    s_waitcnt vmcnt(8)
    v_mfma_f32_32x32x16_bf16 v[192:207], v[56:59], v[184:187], v[192:207]
    s_lshl_b32 s13, s12, 10
    s_add_u32 s13, s13, s9
    buffer_load_dwordx4 v[176:179], v1, s[56:59], s13 offen sc1
    v_mfma_f32_32x32x16_bf16 v[224:239], v[56:59], v[188:191], v[224:239]
    s_add_u32 s13, s13, s22
    s_add_u32 s12, s12, 1
    s_cmp_ge_u32 s12, 28
    s_cselect_b32 s12, 0, s12
    buffer_load_dwordx4 v[180:183], v1, s[56:59], s13 offen sc1
    v_mfma_f32_32x32x16_bf16 v[208:223], v[60:63], v[184:187], v[208:223]
    v_mfma_f32_32x32x16_bf16 v[240:255], v[60:63], v[188:191], v[240:255]
    s_waitcnt vmcnt(8)
    v_mfma_f32_32x32x16_bf16 v[192:207], v[64:67], v[144:147], v[192:207]
    s_lshl_b32 s13, s12, 10
    s_add_u32 s13, s13, s9
    buffer_load_dwordx4 v[184:187], v1, s[56:59], s13 offen sc1
    v_mfma_f32_32x32x16_bf16 v[224:239], v[64:67], v[148:151], v[224:239]
    s_add_u32 s13, s13, s22
    s_add_u32 s12, s12, 1
    s_cmp_ge_u32 s12, 28
    s_cselect_b32 s12, 0, s12
    buffer_load_dwordx4 v[188:191], v1, s[56:59], s13 offen sc1
    v_mfma_f32_32x32x16_bf16 v[208:223], v[68:71], v[144:147], v[208:223]
    v_mfma_f32_32x32x16_bf16 v[240:255], v[68:71], v[148:151], v[240:255]
    s_waitcnt vmcnt(8)
    v_mfma_f32_32x32x16_bf16 v[192:207], v[72:75], v[152:155], v[192:207]
    s_lshl_b32 s13, s12, 10
    s_add_u32 s13, s13, s9
    buffer_load_dwordx4 v[144:147], v1, s[56:59], s13 offen sc1
    v_mfma_f32_32x32x16_bf16 v[224:239], v[72:75], v[156:159], v[224:239]
    s_add_u32 s13, s13, s22
    s_add_u32 s12, s12, 1
    s_cmp_ge_u32 s12, 28
    s_cselect_b32 s12, 0, s12
    buffer_load_dwordx4 v[148:151], v1, s[56:59], s13 offen sc1
    v_mfma_f32_32x32x16_bf16 v[208:223], v[76:79], v[152:155], v[208:223]
    v_mfma_f32_32x32x16_bf16 v[240:255], v[76:79], v[156:159], v[240:255]
    s_waitcnt vmcnt(8)
    v_mfma_f32_32x32x16_bf16 v[192:207], v[80:83], v[160:163], v[192:207]
    s_lshl_b32 s13, s12, 10
    s_add_u32 s13, s13, s9
    buffer_load_dwordx4 v[152:155], v1, s[56:59], s13 offen sc1
    v_mfma_f32_32x32x16_bf16 v[224:239], v[80:83], v[164:167], v[224:239]
    s_add_u32 s13, s13, s22
    s_add_u32 s12, s12, 1
    s_cmp_ge_u32 s12, 28
    s_cselect_b32 s12, 0, s12
    buffer_load_dwordx4 v[156:159], v1, s[56:59], s13 offen sc1
    v_mfma_f32_32x32x16_bf16 v[208:223], v[84:87], v[160:163], v[208:223]
    v_mfma_f32_32x32x16_bf16 v[240:255], v[84:87], v[164:167], v[240:255]
    s_waitcnt vmcnt(8)
    v_mfma_f32_32x32x16_bf16 v[192:207], v[88:91], v[168:171], v[192:207]
    s_lshl_b32 s13, s12, 10
    s_add_u32 s13, s13, s9
    buffer_load_dwordx4 v[160:163], v1, s[56:59], s13 offen sc1
    v_mfma_f32_32x32x16_bf16 v[224:239], v[88:91], v[172:175], v[224:239]
    s_add_u32 s13, s13, s22
    s_add_u32 s12, s12, 1
    s_cmp_ge_u32 s12, 28
    s_cselect_b32 s12, 0, s12
    buffer_load_dwordx4 v[164:167], v1, s[56:59], s13 offen sc1
    v_mfma_f32_32x32x16_bf16 v[208:223], v[92:95], v[168:171], v[208:223]
    v_mfma_f32_32x32x16_bf16 v[240:255], v[92:95], v[172:175], v[240:255]
    s_waitcnt vmcnt(8)
    v_mfma_f32_32x32x16_bf16 v[192:207], v[96:99], v[176:179], v[192:207]
    s_lshl_b32 s13, s12, 10
    s_add_u32 s13, s13, s9
    buffer_load_dwordx4 v[168:171], v1, s[56:59], s13 offen sc1
    v_mfma_f32_32x32x16_bf16 v[224:239], v[96:99], v[180:183], v[224:239]
    s_add_u32 s13, s13, s22
    s_add_u32 s12, s12, 1
    s_cmp_ge_u32 s12, 28
    s_cselect_b32 s12, 0, s12
    buffer_load_dwordx4 v[172:175], v1, s[56:59], s13 offen sc1
    v_mfma_f32_32x32x16_bf16 v[208:223], v[100:103], v[176:179], v[208:223]
    v_mfma_f32_32x32x16_bf16 v[240:255], v[100:103], v[180:183], v[240:255]
    s_waitcnt vmcnt(8)
    v_mfma_f32_32x32x16_bf16 v[192:207], v[104:107], v[184:187], v[192:207]
    ds_read_b64_tr_b16 v[128:129], v114 offset:24576
    ds_read_b64_tr_b16 v[130:131], v114 offset:25600
    ds_read_b64_tr_b16 v[132:133], v115 offset:24576
    ds_read_b64_tr_b16 v[134:135], v115 offset:25600
    s_lshl_b32 s13, s12, 10
    s_add_u32 s13, s13, s9
    buffer_load_dwordx4 v[176:179], v1, s[56:59], s13 offen sc1
    v_mfma_f32_32x32x16_bf16 v[224:239], v[104:107], v[188:191], v[224:239]
    s_add_u32 s13, s13, s22
    s_add_u32 s12, s12, 1
    s_cmp_ge_u32 s12, 28
    s_cselect_b32 s12, 0, s12
    buffer_load_dwordx4 v[180:183], v1, s[56:59], s13 offen sc1
    v_mfma_f32_32x32x16_bf16 v[208:223], v[108:111], v[184:187], v[208:223]
    v_mfma_f32_32x32x16_bf16 v[240:255], v[108:111], v[188:191], v[240:255]
    s_waitcnt vmcnt(8)
    s_waitcnt lgkmcnt(0)
    v_mfma_f32_32x32x16_bf16 v[192:207], v[128:131], v[144:147], v[192:207]
    ds_read_b64_tr_b16 v[136:137], v114 offset:26624
    ds_read_b64_tr_b16 v[138:139], v114 offset:27648
    ds_read_b64_tr_b16 v[140:141], v115 offset:26624
    ds_read_b64_tr_b16 v[142:143], v115 offset:27648
    s_lshl_b32 s13, s12, 10
    s_add_u32 s13, s13, s9
    buffer_load_dwordx4 v[184:187], v1, s[56:59], s13 offen sc1
    v_mfma_f32_32x32x16_bf16 v[224:239], v[128:131], v[148:151], v[224:239]
    s_add_u32 s13, s13, s22
    s_add_u32 s12, s12, 1
    s_cmp_ge_u32 s12, 28
    s_cselect_b32 s12, 0, s12
    buffer_load_dwordx4 v[188:191], v1, s[56:59], s13 offen sc1
    v_mfma_f32_32x32x16_bf16 v[208:223], v[132:135], v[144:147], v[208:223]
    v_mfma_f32_32x32x16_bf16 v[240:255], v[132:135], v[148:151], v[240:255]
    s_waitcnt vmcnt(8)
    s_waitcnt lgkmcnt(0)
    v_mfma_f32_32x32x16_bf16 v[192:207], v[136:139], v[152:155], v[192:207]
    ds_read_b64_tr_b16 v[128:129], v114 offset:28672
    ds_read_b64_tr_b16 v[130:131], v114 offset:29696
    ds_read_b64_tr_b16 v[132:133], v115 offset:28672
    ds_read_b64_tr_b16 v[134:135], v115 offset:29696
    s_lshl_b32 s13, s12, 10
    s_add_u32 s13, s13, s9
    buffer_load_dwordx4 v[144:147], v1, s[56:59], s13 offen sc1
    v_mfma_f32_32x32x16_bf16 v[224:239], v[136:139], v[156:159], v[224:239]
    s_add_u32 s13, s13, s22
    s_add_u32 s12, s12, 1
    s_cmp_ge_u32 s12, 28
    s_cselect_b32 s12, 0, s12
    buffer_load_dwordx4 v[148:151], v1, s[56:59], s13 offen sc1
    v_mfma_f32_32x32x16_bf16 v[208:223], v[140:143], v[152:155], v[208:223]
    v_mfma_f32_32x32x16_bf16 v[240:255], v[140:143], v[156:159], v[240:255]
    s_waitcnt vmcnt(8)
    s_waitcnt lgkmcnt(0)
    v_mfma_f32_32x32x16_bf16 v[192:207], v[128:131], v[160:163], v[192:207]
    ds_read_b64_tr_b16 v[136:137], v114 offset:30720
    ds_read_b64_tr_b16 v[138:139], v114 offset:31744
    ds_read_b64_tr_b16 v[140:141], v115 offset:30720
    ds_read_b64_tr_b16 v[142:143], v115 offset:31744
    s_lshl_b32 s13, s12, 10
    s_add_u32 s13, s13, s9
    buffer_load_dwordx4 v[152:155], v1, s[56:59], s13 offen sc1
    v_mfma_f32_32x32x16_bf16 v[224:239], v[128:131], v[164:167], v[224:239]
    s_add_u32 s13, s13, s22
    s_add_u32 s12, s12, 1
    s_cmp_ge_u32 s12, 28
    s_cselect_b32 s12, 0, s12
    buffer_load_dwordx4 v[156:159], v1, s[56:59], s13 offen sc1
    v_mfma_f32_32x32x16_bf16 v[208:223], v[132:135], v[160:163], v[208:223]
    v_mfma_f32_32x32x16_bf16 v[240:255], v[132:135], v[164:167], v[240:255]
    s_waitcnt vmcnt(8)
    s_waitcnt lgkmcnt(0)
    v_mfma_f32_32x32x16_bf16 v[192:207], v[136:139], v[168:171], v[192:207]
    ds_read_b64_tr_b16 v[128:129], v114 offset:0
    ds_read_b64_tr_b16 v[130:131], v114 offset:1024
    ds_read_b64_tr_b16 v[132:133], v115 offset:0
    ds_read_b64_tr_b16 v[134:135], v115 offset:1024
    s_lshl_b32 s13, s12, 10
    s_add_u32 s13, s13, s9
    buffer_load_dwordx4 v[160:163], v1, s[56:59], s13 offen sc1
    v_mfma_f32_32x32x16_bf16 v[224:239], v[136:139], v[172:175], v[224:239]
    s_add_u32 s13, s13, s22
    s_add_u32 s12, s12, 1
    s_cmp_ge_u32 s12, 28
    s_cselect_b32 s12, 0, s12
    buffer_load_dwordx4 v[164:167], v1, s[56:59], s13 offen sc1
    v_mfma_f32_32x32x16_bf16 v[208:223], v[140:143], v[168:171], v[208:223]
    v_mfma_f32_32x32x16_bf16 v[240:255], v[140:143], v[172:175], v[240:255]
    s_waitcnt vmcnt(8)
    s_waitcnt lgkmcnt(0)
    v_mfma_f32_32x32x16_bf16 v[192:207], v[128:131], v[176:179], v[192:207]
    ds_read_b64_tr_b16 v[136:137], v114 offset:2048
    ds_read_b64_tr_b16 v[138:139], v114 offset:3072
    ds_read_b64_tr_b16 v[140:141], v115 offset:2048
    ds_read_b64_tr_b16 v[142:143], v115 offset:3072
    s_lshl_b32 s13, s12, 10
    s_add_u32 s13, s13, s9
    buffer_load_dwordx4 v[168:171], v1, s[56:59], s13 offen sc1
    v_mfma_f32_32x32x16_bf16 v[224:239], v[128:131], v[180:183], v[224:239]
    s_add_u32 s13, s13, s22
    s_add_u32 s12, s12, 1
    s_cmp_ge_u32 s12, 28
    s_cselect_b32 s12, 0, s12
    buffer_load_dwordx4 v[172:175], v1, s[56:59], s13 offen sc1
    v_mfma_f32_32x32x16_bf16 v[208:223], v[132:135], v[176:179], v[208:223]
    v_mfma_f32_32x32x16_bf16 v[240:255], v[132:135], v[180:183], v[240:255]
    s_waitcnt vmcnt(8)
    s_waitcnt lgkmcnt(0)
    v_mfma_f32_32x32x16_bf16 v[192:207], v[136:139], v[184:187], v[192:207]
    ds_read_b64_tr_b16 v[128:129], v114 offset:4096
    ds_read_b64_tr_b16 v[130:131], v114 offset:5120
    ds_read_b64_tr_b16 v[132:133], v115 offset:4096
    ds_read_b64_tr_b16 v[134:135], v115 offset:5120
    s_lshl_b32 s13, s12, 10
    s_add_u32 s13, s13, s9
    buffer_load_dwordx4 v[176:179], v1, s[56:59], s13 offen sc1
    v_mfma_f32_32x32x16_bf16 v[224:239], v[136:139], v[188:191], v[224:239]
    s_add_u32 s13, s13, s22
    s_add_u32 s12, s12, 1
    s_cmp_ge_u32 s12, 28
    s_cselect_b32 s12, 0, s12
    buffer_load_dwordx4 v[180:183], v1, s[56:59], s13 offen sc1
    v_mfma_f32_32x32x16_bf16 v[208:223], v[140:143], v[184:187], v[208:223]
    v_mfma_f32_32x32x16_bf16 v[240:255], v[140:143], v[188:191], v[240:255]
    s_waitcnt vmcnt(8)
    s_waitcnt lgkmcnt(0)
    v_mfma_f32_32x32x16_bf16 v[192:207], v[128:131], v[144:147], v[192:207]
    ds_read_b64_tr_b16 v[136:137], v114 offset:6144
    ds_read_b64_tr_b16 v[138:139], v114 offset:7168
    ds_read_b64_tr_b16 v[140:141], v115 offset:6144
    ds_read_b64_tr_b16 v[142:143], v115 offset:7168
    s_lshl_b32 s13, s12, 10
    s_add_u32 s13, s13, s9
    buffer_load_dwordx4 v[184:187], v1, s[56:59], s13 offen sc1
    v_mfma_f32_32x32x16_bf16 v[224:239], v[128:131], v[148:151], v[224:239]
    s_add_u32 s13, s13, s22
    s_add_u32 s12, s12, 1
    s_cmp_ge_u32 s12, 28
    s_cselect_b32 s12, 0, s12
    buffer_load_dwordx4 v[188:191], v1, s[56:59], s13 offen sc1
    v_mfma_f32_32x32x16_bf16 v[208:223], v[132:135], v[144:147], v[208:223]
    v_mfma_f32_32x32x16_bf16 v[240:255], v[132:135], v[148:151], v[240:255]
    s_waitcnt vmcnt(8)
    s_waitcnt lgkmcnt(0)
    v_mfma_f32_32x32x16_bf16 v[192:207], v[136:139], v[152:155], v[192:207]
    ds_read_b64_tr_b16 v[128:129], v114 offset:8192
    ds_read_b64_tr_b16 v[130:131], v114 offset:9216
    ds_read_b64_tr_b16 v[132:133], v115 offset:8192
    ds_read_b64_tr_b16 v[134:135], v115 offset:9216
    s_lshl_b32 s13, s12, 10
    s_add_u32 s13, s13, s9
    buffer_load_dwordx4 v[144:147], v1, s[56:59], s13 offen sc1
    v_mfma_f32_32x32x16_bf16 v[224:239], v[136:139], v[156:159], v[224:239]
    s_add_u32 s13, s13, s22
    s_add_u32 s12, s12, 1
    s_cmp_ge_u32 s12, 28
    s_cselect_b32 s12, 0, s12
    buffer_load_dwordx4 v[148:151], v1, s[56:59], s13 offen sc1
    v_mfma_f32_32x32x16_bf16 v[208:223], v[140:143], v[152:155], v[208:223]
    v_mfma_f32_32x32x16_bf16 v[240:255], v[140:143], v[156:159], v[240:255]
    s_waitcnt vmcnt(8)
    s_waitcnt lgkmcnt(0)
    v_mfma_f32_32x32x16_bf16 v[192:207], v[128:131], v[160:163], v[192:207]
    ds_read_b64_tr_b16 v[136:137], v114 offset:10240
    ds_read_b64_tr_b16 v[138:139], v114 offset:11264
    ds_read_b64_tr_b16 v[140:141], v115 offset:10240
    ds_read_b64_tr_b16 v[142:143], v115 offset:11264
    s_lshl_b32 s13, s12, 10
    s_add_u32 s13, s13, s9
    buffer_load_dwordx4 v[152:155], v1, s[56:59], s13 offen sc1
    v_mfma_f32_32x32x16_bf16 v[224:239], v[128:131], v[164:167], v[224:239]
    s_add_u32 s13, s13, s22
    s_add_u32 s12, s12, 1
    s_cmp_ge_u32 s12, 28
    s_cselect_b32 s12, 0, s12
    buffer_load_dwordx4 v[156:159], v1, s[56:59], s13 offen sc1
    v_mfma_f32_32x32x16_bf16 v[208:223], v[132:135], v[160:163], v[208:223]
    v_mfma_f32_32x32x16_bf16 v[240:255], v[132:135], v[164:167], v[240:255]
    s_waitcnt vmcnt(8)
    s_waitcnt lgkmcnt(0)
    v_mfma_f32_32x32x16_bf16 v[192:207], v[136:139], v[168:171], v[192:207]
    ds_read_b64_tr_b16 v[128:129], v114 offset:12288
    ds_read_b64_tr_b16 v[130:131], v114 offset:13312
    ds_read_b64_tr_b16 v[132:133], v115 offset:12288
    ds_read_b64_tr_b16 v[134:135], v115 offset:13312
    s_lshl_b32 s13, s12, 10
    s_add_u32 s13, s13, s9
    buffer_load_dwordx4 v[160:163], v1, s[56:59], s13 offen sc1
    v_mfma_f32_32x32x16_bf16 v[224:239], v[136:139], v[172:175], v[224:239]
    s_add_u32 s13, s13, s22
    s_add_u32 s12, s12, 1
    s_cmp_ge_u32 s12, 28
    s_cselect_b32 s12, 0, s12
    buffer_load_dwordx4 v[164:167], v1, s[56:59], s13 offen sc1
    v_mfma_f32_32x32x16_bf16 v[208:223], v[140:143], v[168:171], v[208:223]
    v_mfma_f32_32x32x16_bf16 v[240:255], v[140:143], v[172:175], v[240:255]
    s_waitcnt vmcnt(8)
    s_waitcnt lgkmcnt(0)
    v_mfma_f32_32x32x16_bf16 v[192:207], v[128:131], v[176:179], v[192:207]
    ds_read_b64_tr_b16 v[136:137], v114 offset:14336
    ds_read_b64_tr_b16 v[138:139], v114 offset:15360
    ds_read_b64_tr_b16 v[140:141], v115 offset:14336
    ds_read_b64_tr_b16 v[142:143], v115 offset:15360
    s_lshl_b32 s13, s12, 10
    s_add_u32 s13, s13, s9
    buffer_load_dwordx4 v[168:171], v1, s[56:59], s13 offen sc1
    v_mfma_f32_32x32x16_bf16 v[224:239], v[128:131], v[180:183], v[224:239]
    s_add_u32 s13, s13, s22
    s_add_u32 s12, s12, 1
    s_cmp_ge_u32 s12, 28
    s_cselect_b32 s12, 0, s12
    buffer_load_dwordx4 v[172:175], v1, s[56:59], s13 offen sc1
    v_mfma_f32_32x32x16_bf16 v[208:223], v[132:135], v[176:179], v[208:223]
    v_mfma_f32_32x32x16_bf16 v[240:255], v[132:135], v[180:183], v[240:255]
    buffer_load_dword v2, v118, s[56:59], s16 offen sc1
    s_waitcnt vmcnt(9)
    s_waitcnt lgkmcnt(0)
    v_mfma_f32_32x32x16_bf16 v[192:207], v[136:139], v[184:187], v[192:207]
    ds_read_b64_tr_b16 v[128:129], v114 offset:16384
    ds_read_b64_tr_b16 v[130:131], v114 offset:17408
    ds_read_b64_tr_b16 v[132:133], v115 offset:16384
    ds_read_b64_tr_b16 v[134:135], v115 offset:17408
    v_mfma_f32_32x32x16_bf16 v[224:239], v[136:139], v[188:191], v[224:239]
    v_mfma_f32_32x32x16_bf16 v[208:223], v[140:143], v[184:187], v[208:223]
    v_mfma_f32_32x32x16_bf16 v[240:255], v[140:143], v[188:191], v[240:255]
    s_waitcnt vmcnt(7)
    s_waitcnt lgkmcnt(0)
    v_mfma_f32_32x32x16_bf16 v[192:207], v[128:131], v[144:147], v[192:207]
    ds_read_b64_tr_b16 v[136:137], v114 offset:18432
    ds_read_b64_tr_b16 v[138:139], v114 offset:19456
    ds_read_b64_tr_b16 v[140:141], v115 offset:18432
    ds_read_b64_tr_b16 v[142:143], v115 offset:19456
    v_mfma_f32_32x32x16_bf16 v[224:239], v[128:131], v[148:151], v[224:239]
    v_mfma_f32_32x32x16_bf16 v[208:223], v[132:135], v[144:147], v[208:223]
    v_mfma_f32_32x32x16_bf16 v[240:255], v[132:135], v[148:151], v[240:255]
    s_waitcnt vmcnt(5)
    s_waitcnt lgkmcnt(0)
    v_mfma_f32_32x32x16_bf16 v[192:207], v[136:139], v[152:155], v[192:207]
    ds_read_b64_tr_b16 v[128:129], v114 offset:20480
    ds_read_b64_tr_b16 v[130:131], v114 offset:21504
    ds_read_b64_tr_b16 v[132:133], v115 offset:20480
    ds_read_b64_tr_b16 v[134:135], v115 offset:21504
    v_mfma_f32_32x32x16_bf16 v[224:239], v[136:139], v[156:159], v[224:239]
    v_mfma_f32_32x32x16_bf16 v[208:223], v[140:143], v[152:155], v[208:223]
    v_mfma_f32_32x32x16_bf16 v[240:255], v[140:143], v[156:159], v[240:255]
    s_waitcnt vmcnt(0)
    buffer_load_dwordx4 v[80:83], v120, s[56:59], s19 offen sc1
    s_add_u32 s13, s19, 33792
    buffer_load_dwordx4 v[84:87], v120, s[56:59], s13 offen sc1
    s_waitcnt lgkmcnt(0)
    v_mfma_f32_32x32x16_bf16 v[192:207], v[128:131], v[160:163], v[192:207]
    ds_read_b64_tr_b16 v[136:137], v114 offset:22528
    ds_read_b64_tr_b16 v[138:139], v114 offset:23552
    ds_read_b64_tr_b16 v[140:141], v115 offset:22528
    ds_read_b64_tr_b16 v[142:143], v115 offset:23552
    v_mfma_f32_32x32x16_bf16 v[224:239], v[128:131], v[164:167], v[224:239]
    v_mfma_f32_32x32x16_bf16 v[208:223], v[132:135], v[160:163], v[208:223]
    v_mfma_f32_32x32x16_bf16 v[240:255], v[132:135], v[164:167], v[240:255]
    s_waitcnt lgkmcnt(0)
    v_mfma_f32_32x32x16_bf16 v[192:207], v[136:139], v[168:171], v[192:207]
    v_mfma_f32_32x32x16_bf16 v[224:239], v[136:139], v[172:175], v[224:239]
    v_mfma_f32_32x32x16_bf16 v[208:223], v[140:143], v[168:171], v[208:223]
    v_mfma_f32_32x32x16_bf16 v[240:255], v[140:143], v[172:175], v[240:255]
    v_cmp_eq_u32 vcc, s23, v2
    s_nop 3
    s_cmp_eq_u64 vcc, exec
    s_cbranch_scc1 PY_DONE
PY_SPIN:
    s_sleep 2
    buffer_load_dword v2, v118, s[56:59], s16 offen sc1
    s_waitcnt vmcnt(0)
    s_sub_u32 s77, s77, 1
    s_cmp_eq_u32 s77, 0
    s_cbranch_scc1 PY_OK
PY_CHK:
    v_cmp_eq_u32 vcc, s23, v2
    s_nop 3
    s_cmp_eq_u64 vcc, exec
    s_cbranch_scc0 PY_SPIN
PY_OK:
    buffer_load_dwordx4 v[80:83], v120, s[56:59], s19 offen sc1
    s_add_u32 s13, s19, 33792
    buffer_load_dwordx4 v[84:87], v120, s[56:59], s13 offen sc1
PY_DONE:
    s_nop 5
    ds_write_b128 v123, v[208:211] offset:4096
    ds_write_b128 v123, v[212:215] offset:5120
    ds_write_b128 v123, v[216:219] offset:6144
    ds_write_b128 v123, v[220:223] offset:7168
    ds_write_b128 v123, v[224:227] offset:8192
    ds_write_b128 v123, v[228:231] offset:9216
    ds_write_b128 v123, v[232:235] offset:10240
    ds_write_b128 v123, v[236:239] offset:11264
    ds_write_b128 v123, v[240:243] offset:12288
    ds_write_b128 v123, v[244:247] offset:13312
    ds_write_b128 v123, v[248:251] offset:14336
    ds_write_b128 v123, v[252:255] offset:15360
    v_mov_b32 v5, 0xffff0000
    s_waitcnt vmcnt(0)
    ds_write_b128 v121, v[80:83] offset:16384
    ds_write_b128 v121, v[84:87] offset:17408
    s_waitcnt lgkmcnt(0)
    s_barrier
    ds_read_b32 v6, v119
    ds_read_b64_tr_b16 v[128:129], v122 offset:16384
    ds_read_b64_tr_b16 v[130:131], v122 offset:16896
    ds_read_b64_tr_b16 v[132:133], v122 offset:17408
    ds_read_b64_tr_b16 v[134:135], v122 offset:17920
    ds_read_b128 v[16:19], v126 offset:4096
    ds_read_b128 v[20:23], v126 offset:5120
    ds_read_b128 v[24:27], v126 offset:6144
    ds_read_b128 v[28:31], v126 offset:7168
    ds_read_b128 v[32:35], v124 offset:8192
    ds_read_b128 v[36:39], v124 offset:9216
    ds_read_b128 v[40:43], v124 offset:10240
    ds_read_b128 v[44:47], v124 offset:11264
    ds_read_b128 v[48:51], v125 offset:12288
    ds_read_b128 v[52:55], v125 offset:13312
    ds_read_b128 v[56:59], v125 offset:14336
    ds_read_b128 v[60:63], v125 offset:15360
    s_waitcnt lgkmcnt(12)
    v_lshlrev_b32 v160, 16, v128
    v_and_b32 v161, v5, v128
    v_lshlrev_b32 v162, 16, v129
    v_and_b32 v163, v5, v129
    v_lshlrev_b32 v164, 16, v130
    v_and_b32 v165, v5, v130
    v_lshlrev_b32 v166, 16, v131
    v_and_b32 v167, v5, v131
    v_lshlrev_b32 v168, 16, v132
    v_and_b32 v169, v5, v132
    v_lshlrev_b32 v170, 16, v133
    v_and_b32 v171, v5, v133
    v_lshlrev_b32 v172, 16, v134
    v_and_b32 v173, v5, v134
    v_lshlrev_b32 v174, 16, v135
    v_and_b32 v175, v5, v135
    s_waitcnt lgkmcnt(8)
    v_pk_add_f32 v[192:193], v[192:193], v[16:17]
    v_pk_add_f32 v[194:195], v[194:195], v[18:19]
    v_pk_add_f32 v[196:197], v[196:197], v[20:21]
    v_pk_add_f32 v[198:199], v[198:199], v[22:23]
    v_pk_add_f32 v[200:201], v[200:201], v[24:25]
    v_pk_add_f32 v[202:203], v[202:203], v[26:27]
    v_pk_add_f32 v[204:205], v[204:205], v[28:29]
    v_pk_add_f32 v[206:207], v[206:207], v[30:31]
    s_waitcnt lgkmcnt(0)
    v_pk_add_f32 v[32:33], v[32:33], v[48:49]
    v_pk_add_f32 v[34:35], v[34:35], v[50:51]
    v_pk_add_f32 v[36:37], v[36:37], v[52:53]
    v_pk_add_f32 v[38:39], v[38:39], v[54:55]
    v_pk_add_f32 v[40:41], v[40:41], v[56:57]
    v_pk_add_f32 v[42:43], v[42:43], v[58:59]
    v_pk_add_f32 v[44:45], v[44:45], v[60:61]
    v_pk_add_f32 v[46:47], v[46:47], v[62:63]
    v_pk_add_f32 v[192:193], v[192:193], v[32:33]
    v_pk_add_f32 v[194:195], v[194:195], v[34:35]
    v_pk_add_f32 v[196:197], v[196:197], v[36:37]
    v_pk_add_f32 v[198:199], v[198:199], v[38:39]
    v_pk_add_f32 v[200:201], v[200:201], v[40:41]
    v_pk_add_f32 v[202:203], v[202:203], v[42:43]
    v_pk_add_f32 v[204:205], v[204:205], v[44:45]
    v_pk_add_f32 v[206:207], v[206:207], v[46:47]
    v_pk_add_f32 v[160:161], v[160:161], v[192:193] neg_lo:[0,1] neg_hi:[0,1]
    v_pk_add_f32 v[162:163], v[162:163], v[194:195] neg_lo:[0,1] neg_hi:[0,1]
    v_pk_add_f32 v[164:165], v[164:165], v[196:197] neg_lo:[0,1] neg_hi:[0,1]
    v_pk_add_f32 v[166:167], v[166:167], v[198:199] neg_lo:[0,1] neg_hi:[0,1]
    v_pk_add_f32 v[168:169], v[168:169], v[200:201] neg_lo:[0,1] neg_hi:[0,1]
    v_pk_add_f32 v[170:171], v[170:171], v[202:203] neg_lo:[0,1] neg_hi:[0,1]
    v_pk_add_f32 v[172:173], v[172:173], v[204:205] neg_lo:[0,1] neg_hi:[0,1]
    v_pk_add_f32 v[174:175], v[174:175], v[206:207] neg_lo:[0,1] neg_hi:[0,1]
    v_pk_fma_f32 v[192:193], v[160:161], v[6:7], v[192:193] op_sel_hi:[1,0,1]
    v_pk_fma_f32 v[194:195], v[162:163], v[6:7], v[194:195] op_sel_hi:[1,0,1]
    v_pk_fma_f32 v[196:197], v[164:165], v[6:7], v[196:197] op_sel_hi:[1,0,1]
    v_pk_fma_f32 v[198:199], v[166:167], v[6:7], v[198:199] op_sel_hi:[1,0,1]
    v_pk_fma_f32 v[200:201], v[168:169], v[6:7], v[200:201] op_sel_hi:[1,0,1]
    v_pk_fma_f32 v[202:203], v[170:171], v[6:7], v[202:203] op_sel_hi:[1,0,1]
    v_pk_fma_f32 v[204:205], v[172:173], v[6:7], v[204:205] op_sel_hi:[1,0,1]
    v_pk_fma_f32 v[206:207], v[174:175], v[6:7], v[206:207] op_sel_hi:[1,0,1]
    v_cvt_pk_bf16_f32 v144, v192, v193
    v_cvt_pk_bf16_f32 v145, v194, v195
    v_cvt_pk_bf16_f32 v146, v196, v197
    v_cvt_pk_bf16_f32 v147, v198, v199
    v_cvt_pk_bf16_f32 v148, v200, v201
    v_cvt_pk_bf16_f32 v149, v202, v203
    v_cvt_pk_bf16_f32 v150, v204, v205
    v_cvt_pk_bf16_f32 v151, v206, v207
    buffer_store_dwordx4 v[144:147], v116, s[64:67], 0 offen
    buffer_store_dwordx4 v[148:151], v116, s[64:67], 0 offen offset:16
    s_endpgm
L_LWAVE_S:
    s_setprio 3
    s_waitcnt lgkmcnt(0)
    s_mov_b32 s56, s36
    s_and_b32 s57, s37, 0xffff
    s_mov_b32 s58, 16777216
    s_mov_b32 s59, 0x00020000
    s_mov_b32 s60, s28
    s_and_b32 s61, s29, 0xffff
    s_mov_b32 s62, 1835008
    s_mov_b32 s63, 0x00020000
    s_lshl_b32 s7, s2, 1
    s_add_u32 s7, s7, s6
    v_lshlrev_b32 v2, 4, v0
    s_mov_b32 s77, 0x100000
    v_mov_b32 v20, 0
    v_mov_b32 v21, 0
    v_mov_b32 v22, 0
    v_mov_b32 v23, 0
    s_lshr_b32 s16, s7, 7
    s_lshl_b32 s16, s16, 7
    s_lshr_b32 s17, s7, 3
    s_and_b32 s17, s17, 8
    s_add_u32 s16, s16, s17
    s_add_u32 s16, s16, 16154624
    v_and_b32 v4, 7, v0
    v_lshlrev_b32 v4, 9, v4
    v_lshrrev_b32 v20, 3, v0
    v_and_b32 v21, 7, v0
    v_lshrrev_b32 v22, 1, v20
    v_and_b32 v22, 1, v22
    v_lshlrev_b32 v22, 2, v22
    v_xor_b32 v21, v21, v22
    v_lshlrev_b32 v18, 10, v20
    v_lshl_add_u32 v18, v21, 4, v18
    v_add_u32 v19, 16384, v18
    s_lshr_b32 s17, s40, 2
    s_lshr_b32 s3, s28, 7
    s_sub_u32 s17, s17, s3
    s_add_u32 s17, s17, 4
    s_and_b32 s17, s17, 7
    s_lshl_b32 s17, s17, 7
    s_mul_i32 s3, s6, 1376256
    s_add_u32 s3, s3, s17
    s_sub_u32 s48, 2, s6
    s_lshl_b32 s49, s48, 15
    v_add_u32 v1, s49, v2
    s_mul_i32 s48, s48, 458752
    s_add_u32 s48, s48, s17
    s_mul_i32 s17, s6, 98304
    v_add_u32 v7, s17, v2
    s_lshr_b32 s76, s40, 1
    s_and_b32 s76, s76, 2
    s_add_u32 s76, s76, s40
    s_and_b32 s76, s76, 3
    s_mul_i32 s76, s76, 7
    s_mov_b32 s49, s76
    v_mov_b32 v3, 0
    s_barrier
    s_and_b32 s17, s76, 1
    s_lshl_b32 s22, s76, 14
    s_lshl_b32 s17, s17, 13
    s_sub_u32 s22, s22, s17
    s_add_u32 s22, s22, s3
    buffer_load_dwordx4 v[24:27], v18, s[60:63], s22 offen
    s_add_u32 s76, s76, 1
    s_cmp_ge_u32 s76, 28
    s_cselect_b32 s76, 0, s76
    buffer_load_dwordx4 v[28:31], v19, s[60:63], s22 offen
    s_and_b32 s17, s76, 1
    s_lshl_b32 s22, s76, 14
    s_lshl_b32 s17, s17, 13
    s_sub_u32 s22, s22, s17
    s_add_u32 s22, s22, s3
    buffer_load_dwordx4 v[32:35], v18, s[60:63], s22 offen
    s_add_u32 s76, s76, 1
    s_cmp_ge_u32 s76, 28
    s_cselect_b32 s76, 0, s76
    buffer_load_dwordx4 v[36:39], v19, s[60:63], s22 offen
    s_waitcnt vmcnt(0)
    s_and_b32 s17, s76, 1
    s_lshl_b32 s22, s76, 14
    s_lshl_b32 s17, s17, 13
    s_sub_u32 s22, s22, s17
    s_add_u32 s22, s22, s3
    buffer_load_dwordx4 v[40:43], v18, s[60:63], s22 offen
    s_add_u32 s76, s76, 1
    s_cmp_ge_u32 s76, 28
    s_cselect_b32 s76, 0, s76
    buffer_load_dwordx4 v[44:47], v19, s[60:63], s22 offen
    s_and_b32 s17, s76, 1
    s_lshl_b32 s22, s76, 14
    s_lshl_b32 s17, s17, 13
    s_sub_u32 s22, s22, s17
    s_add_u32 s22, s22, s3
    buffer_load_dwordx4 v[48:51], v18, s[60:63], s22 offen
    s_add_u32 s76, s76, 1
    s_cmp_ge_u32 s76, 28
    s_cselect_b32 s76, 0, s76
    buffer_load_dwordx4 v[52:55], v19, s[60:63], s22 offen
    s_waitcnt vmcnt(0)
    s_and_b32 s17, s76, 1
    s_lshl_b32 s22, s76, 14
    s_lshl_b32 s17, s17, 13
    s_sub_u32 s22, s22, s17
    s_add_u32 s22, s22, s3
    buffer_load_dwordx4 v[56:59], v18, s[60:63], s22 offen
    s_add_u32 s76, s76, 1
    s_cmp_ge_u32 s76, 28
    s_cselect_b32 s76, 0, s76
    buffer_load_dwordx4 v[60:63], v19, s[60:63], s22 offen
    s_and_b32 s17, s76, 1
    s_lshl_b32 s22, s76, 14
    s_lshl_b32 s17, s17, 13
    s_sub_u32 s22, s22, s17
    s_add_u32 s22, s22, s3
    buffer_load_dwordx4 v[64:67], v18, s[60:63], s22 offen
    s_add_u32 s76, s76, 1
    s_cmp_ge_u32 s76, 28
    s_cselect_b32 s76, 0, s76
    buffer_load_dwordx4 v[68:71], v19, s[60:63], s22 offen
    s_waitcnt vmcnt(0)
    s_and_b32 s17, s76, 1
    s_lshl_b32 s22, s76, 14
    s_lshl_b32 s17, s17, 13
    s_sub_u32 s22, s22, s17
    s_add_u32 s22, s22, s3
    buffer_load_dwordx4 v[72:75], v18, s[60:63], s22 offen
    s_add_u32 s76, s76, 1
    s_cmp_ge_u32 s76, 28
    s_cselect_b32 s76, 0, s76
    buffer_load_dwordx4 v[76:79], v19, s[60:63], s22 offen
    s_and_b32 s17, s76, 1
    s_lshl_b32 s22, s76, 14
    s_lshl_b32 s17, s17, 13
    s_sub_u32 s22, s22, s17
    s_add_u32 s22, s22, s3
    buffer_load_dwordx4 v[80:83], v18, s[60:63], s22 offen
    s_add_u32 s76, s76, 1
    s_cmp_ge_u32 s76, 28
    s_cselect_b32 s76, 0, s76
    buffer_load_dwordx4 v[84:87], v19, s[60:63], s22 offen
    s_waitcnt vmcnt(0)
    s_and_b32 s17, s76, 1
    s_lshl_b32 s22, s76, 14
    s_lshl_b32 s17, s17, 13
    s_sub_u32 s22, s22, s17
    s_add_u32 s22, s22, s3
    buffer_load_dwordx4 v[88:91], v18, s[60:63], s22 offen
    s_add_u32 s76, s76, 1
    s_cmp_ge_u32 s76, 28
    s_cselect_b32 s76, 0, s76
    buffer_load_dwordx4 v[92:95], v19, s[60:63], s22 offen
    s_and_b32 s17, s76, 1
    s_lshl_b32 s22, s76, 14
    s_lshl_b32 s17, s17, 13
    s_sub_u32 s22, s22, s17
    s_add_u32 s22, s22, s3
    buffer_load_dwordx4 v[96:99], v18, s[60:63], s22 offen
    s_add_u32 s76, s76, 1
    s_cmp_ge_u32 s76, 28
    s_cselect_b32 s76, 0, s76
    buffer_load_dwordx4 v[100:103], v19, s[60:63], s22 offen
    s_and_b32 s17, s76, 1
    s_lshl_b32 s22, s76, 14
    s_lshl_b32 s17, s17, 13
    s_sub_u32 s22, s22, s17
    s_add_u32 s22, s22, s3
    buffer_load_dwordx4 v[104:107], v18, s[60:63], s22 offen
    s_add_u32 s76, s76, 1
    s_cmp_ge_u32 s76, 28
    s_cselect_b32 s76, 0, s76
    buffer_load_dwordx4 v[108:111], v19, s[60:63], s22 offen
    s_and_b32 s17, s76, 1
    s_lshl_b32 s22, s76, 14
    s_lshl_b32 s17, s17, 13
    s_sub_u32 s22, s22, s17
    s_add_u32 s22, s22, s3
    buffer_load_dwordx4 v[112:115], v18, s[60:63], s22 offen
    s_add_u32 s76, s76, 1
    s_cmp_ge_u32 s76, 28
    s_cselect_b32 s76, 0, s76
    buffer_load_dwordx4 v[116:119], v19, s[60:63], s22 offen
    s_and_b32 s17, s76, 1
    s_lshl_b32 s22, s76, 14
    s_lshl_b32 s17, s17, 13
    s_sub_u32 s22, s22, s17
    s_add_u32 s22, s22, s3
    buffer_load_dwordx4 v[120:123], v18, s[60:63], s22 offen
    s_add_u32 s76, s76, 1
    s_cmp_ge_u32 s76, 28
    s_cselect_b32 s76, 0, s76
    buffer_load_dwordx4 v[124:127], v19, s[60:63], s22 offen
    s_and_b32 s17, s76, 1
    s_lshl_b32 s22, s76, 14
    s_lshl_b32 s17, s17, 13
    s_sub_u32 s22, s22, s17
    s_add_u32 s22, s22, s3
    buffer_load_dwordx4 v[128:131], v18, s[60:63], s22 offen
    s_add_u32 s76, s76, 1
    s_cmp_ge_u32 s76, 28
    s_cselect_b32 s76, 0, s76
    buffer_load_dwordx4 v[132:135], v19, s[60:63], s22 offen
    s_and_b32 s17, s49, 1
    s_lshl_b32 s22, s49, 14
    s_lshl_b32 s17, s17, 13
    s_sub_u32 s22, s22, s17
    s_add_u32 s22, s22, s48
    buffer_load_dwordx4 v[136:139], v18, s[60:63], s22 offen
    s_add_u32 s49, s49, 1
    s_cmp_ge_u32 s49, 28
    s_cselect_b32 s49, 0, s49
    buffer_load_dwordx4 v[140:143], v19, s[60:63], s22 offen
    s_and_b32 s17, s49, 1
    s_lshl_b32 s22, s49, 14
    s_lshl_b32 s17, s17, 13
    s_sub_u32 s22, s22, s17
    s_add_u32 s22, s22, s48
    buffer_load_dwordx4 v[144:147], v18, s[60:63], s22 offen
    s_add_u32 s49, s49, 1
    s_cmp_ge_u32 s49, 28
    s_cselect_b32 s49, 0, s49
    buffer_load_dwordx4 v[148:151], v19, s[60:63], s22 offen
    s_and_b32 s17, s49, 1
    s_lshl_b32 s22, s49, 14
    s_lshl_b32 s17, s17, 13
    s_sub_u32 s22, s22, s17
    s_add_u32 s22, s22, s48
    buffer_load_dwordx4 v[152:155], v18, s[60:63], s22 offen
    s_add_u32 s49, s49, 1
    s_cmp_ge_u32 s49, 28
    s_cselect_b32 s49, 0, s49
    buffer_load_dwordx4 v[156:159], v19, s[60:63], s22 offen
    s_and_b32 s17, s49, 1
    s_lshl_b32 s22, s49, 14
    s_lshl_b32 s17, s17, 13
    s_sub_u32 s22, s22, s17
    s_add_u32 s22, s22, s48
    buffer_load_dwordx4 v[160:163], v18, s[60:63], s22 offen
    s_add_u32 s49, s49, 1
    s_cmp_ge_u32 s49, 28
    s_cselect_b32 s49, 0, s49
    buffer_load_dwordx4 v[164:167], v19, s[60:63], s22 offen
    s_and_b32 s17, s49, 1
    s_lshl_b32 s22, s49, 14
    s_lshl_b32 s17, s17, 13
    s_sub_u32 s22, s22, s17
    s_add_u32 s22, s22, s48
    buffer_load_dwordx4 v[168:171], v18, s[60:63], s22 offen
    s_add_u32 s49, s49, 1
    s_cmp_ge_u32 s49, 28
    s_cselect_b32 s49, 0, s49
    buffer_load_dwordx4 v[172:175], v19, s[60:63], s22 offen
    s_and_b32 s17, s49, 1
    s_lshl_b32 s22, s49, 14
    s_lshl_b32 s17, s17, 13
    s_sub_u32 s22, s22, s17
    s_add_u32 s22, s22, s48
    buffer_load_dwordx4 v[176:179], v18, s[60:63], s22 offen
    s_add_u32 s49, s49, 1
    s_cmp_ge_u32 s49, 28
    s_cselect_b32 s49, 0, s49
    buffer_load_dwordx4 v[180:183], v19, s[60:63], s22 offen
    s_and_b32 s17, s49, 1
    s_lshl_b32 s22, s49, 14
    s_lshl_b32 s17, s17, 13
    s_sub_u32 s22, s22, s17
    s_add_u32 s22, s22, s48
    buffer_load_dwordx4 v[184:187], v18, s[60:63], s22 offen
    s_add_u32 s49, s49, 1
    s_cmp_ge_u32 s49, 28
    s_cselect_b32 s49, 0, s49
    buffer_load_dwordx4 v[188:191], v19, s[60:63], s22 offen
    s_and_b32 s17, s49, 1
    s_lshl_b32 s22, s49, 14
    s_lshl_b32 s17, s17, 13
    s_sub_u32 s22, s22, s17
    s_add_u32 s22, s22, s48
    buffer_load_dwordx4 v[192:195], v18, s[60:63], s22 offen
    s_add_u32 s49, s49, 1
    s_cmp_ge_u32 s49, 28
    s_cselect_b32 s49, 0, s49
    buffer_load_dwordx4 v[196:199], v19, s[60:63], s22 offen
    s_and_b32 s17, s49, 1
    s_lshl_b32 s22, s49, 14
    s_lshl_b32 s17, s17, 13
    s_sub_u32 s22, s22, s17
    s_add_u32 s22, s22, s48
    buffer_load_dwordx4 v[200:203], v18, s[60:63], s22 offen
    s_add_u32 s49, s49, 1
    s_cmp_ge_u32 s49, 28
    s_cselect_b32 s49, 0, s49
    buffer_load_dwordx4 v[204:207], v19, s[60:63], s22 offen
    s_and_b32 s17, s49, 1
    s_lshl_b32 s22, s49, 14
    s_lshl_b32 s17, s17, 13
    s_sub_u32 s22, s22, s17
    s_add_u32 s22, s22, s48
    buffer_load_dwordx4 v[208:211], v18, s[60:63], s22 offen
    s_add_u32 s49, s49, 1
    s_cmp_ge_u32 s49, 28
    s_cselect_b32 s49, 0, s49
    buffer_load_dwordx4 v[212:215], v19, s[60:63], s22 offen
    s_and_b32 s17, s49, 1
    s_lshl_b32 s22, s49, 14
    s_lshl_b32 s17, s17, 13
    s_sub_u32 s22, s22, s17
    s_add_u32 s22, s22, s48
    buffer_load_dwordx4 v[216:219], v18, s[60:63], s22 offen
    s_add_u32 s49, s49, 1
    s_cmp_ge_u32 s49, 28
    s_cselect_b32 s49, 0, s49
    buffer_load_dwordx4 v[220:223], v19, s[60:63], s22 offen
    s_and_b32 s17, s49, 1
    s_lshl_b32 s22, s49, 14
    s_lshl_b32 s17, s17, 13
    s_sub_u32 s22, s22, s17
    s_add_u32 s22, s22, s48
    buffer_load_dwordx4 v[224:227], v18, s[60:63], s22 offen
    s_add_u32 s49, s49, 1
    s_cmp_ge_u32 s49, 28
    s_cselect_b32 s49, 0, s49
    buffer_load_dwordx4 v[228:231], v19, s[60:63], s22 offen
    s_and_b32 s17, s49, 1
    s_lshl_b32 s22, s49, 14
    s_lshl_b32 s17, s17, 13
    s_sub_u32 s22, s22, s17
    s_add_u32 s22, s22, s48
    buffer_load_dwordx4 v[232:235], v18, s[60:63], s22 offen
    s_add_u32 s49, s49, 1
    s_cmp_ge_u32 s49, 28
    s_cselect_b32 s49, 0, s49
    buffer_load_dwordx4 v[236:239], v19, s[60:63], s22 offen
    s_and_b32 s17, s49, 1
    s_lshl_b32 s22, s49, 14
    s_lshl_b32 s17, s17, 13
    s_sub_u32 s22, s22, s17
    s_add_u32 s22, s22, s48
    buffer_load_dwordx4 v[240:243], v18, s[60:63], s22 offen
    s_add_u32 s49, s49, 1
    s_cmp_ge_u32 s49, 28
    s_cselect_b32 s49, 0, s49
    buffer_load_dwordx4 v[244:247], v19, s[60:63], s22 offen
    global_load_dword v6, v3, s[34:35] sc1
    buffer_load_dwordx2 v[16:17], v4, s[56:59], s16 offen sc1
    s_waitcnt vmcnt(56)
    ds_write_b128 v7, v[24:27] offset:0
    ds_write_b128 v7, v[28:31] offset:1024
    s_waitcnt vmcnt(54)
    ds_write_b128 v7, v[32:35] offset:2048
    ds_write_b128 v7, v[36:39] offset:3072
    s_waitcnt vmcnt(52)
    ds_write_b128 v7, v[40:43] offset:4096
    ds_write_b128 v7, v[44:47] offset:5120
    s_waitcnt vmcnt(50)
    ds_write_b128 v7, v[48:51] offset:6144
    ds_write_b128 v7, v[52:55] offset:7168
    s_waitcnt vmcnt(48)
    ds_write_b128 v7, v[56:59] offset:8192
    ds_write_b128 v7, v[60:63] offset:9216
    s_waitcnt vmcnt(46)
    ds_write_b128 v7, v[64:67] offset:10240
    ds_write_b128 v7, v[68:71] offset:11264
    s_waitcnt vmcnt(44)
    ds_write_b128 v7, v[72:75] offset:12288
    ds_write_b128 v7, v[76:79] offset:13312
    s_waitcnt vmcnt(42)
    ds_write_b128 v7, v[80:83] offset:14336
    ds_write_b128 v7, v[84:87] offset:15360
    s_waitcnt vmcnt(40)
    ds_write_b128 v7, v[88:91] offset:16384
    ds_write_b128 v7, v[92:95] offset:17408
    s_waitcnt vmcnt(38)
    ds_write_b128 v7, v[96:99] offset:18432
    ds_write_b128 v7, v[100:103] offset:19456
    s_waitcnt vmcnt(36)
    ds_write_b128 v7, v[104:107] offset:20480
    ds_write_b128 v7, v[108:111] offset:21504
    s_waitcnt vmcnt(34)
    ds_write_b128 v7, v[112:115] offset:22528
    ds_write_b128 v7, v[116:119] offset:23552
    s_waitcnt vmcnt(32)
    ds_write_b128 v7, v[120:123] offset:24576
    ds_write_b128 v7, v[124:127] offset:25600
    s_waitcnt vmcnt(30)
    ds_write_b128 v7, v[128:131] offset:26624
    ds_write_b128 v7, v[132:135] offset:27648
    s_waitcnt vmcnt(0)
    s_mov_b32 s77, 0x100000
    s_branch NLS_CHK
NLS_SPIN:
    s_sleep 8
    global_load_dword v6, v3, s[34:35] sc1
    s_waitcnt vmcnt(0)
    s_sub_u32 s77, s77, 1
    s_cmp_eq_u32 s77, 0
    s_cbranch_scc1 NLS_OK
NLS_CHK:
    v_cmp_ne_u32 vcc, 0, v6
    s_nop 3
    s_cmp_eq_u64 vcc, exec
    s_cbranch_scc0 NLS_SPIN
NLS_OK:
    v_readfirstlane_b32 s23, v6
    s_nop 3
    v_cmp_eq_u32 vcc, s23, v16
    v_cmp_eq_u32 s[50:51], s23, v17
    s_nop 3
    s_and_b64 vcc, vcc, s[50:51]
    s_cmp_eq_u64 vcc, exec
    s_cselect_b32 s19, 1, 0
    s_mul_i32 s18, s6, 5376
    s_add_u32 s18, s18, 131072
    v_mov_b32 v20, 0
    v_mov_b32 v21, 0
    v_mov_b32 v22, 0
    v_mov_b32 v23, 0
    v_and_b32 v5, 7, v0
    v_lshrrev_b32 v6, 3, v0
    v_and_b32 v6, 3, v6
    v_min_u32 v5, 6, v5
    v_mul_u32_u24 v6, 1344, v6
    v_lshl_add_u32 v5, v5, 4, v6
    v_add_u32 v5, s18, v5
    ds_write_b128 v5, v[20:23]
    s_lshl_b32 s18, s6, 2
    s_add_u32 s18, s18, 142096
    v_mov_b32 v5, s18
    v_mov_b32 v6, s19
    ds_write_b32 v5, v6
    s_cmp_eq_u32 s19, 0
    s_cbranch_scc1 NOUS
    s_mul_i32 s52, s6, 5376
    s_mul_i32 s53, s7, 4224
    s_add_u32 s53, s53, 8388608
    s_add_u32 m0, s52, 131184
    s_nop 0
    buffer_load_dwordx4 v2, s[56:59], s53 offen sc1 lds
    s_add_u32 s53, s53, 1024
    s_add_u32 m0, s52, 132528
    s_nop 0
    buffer_load_dwordx4 v2, s[56:59], s53 offen sc1 lds
    s_add_u32 s53, s53, 1024
    s_add_u32 m0, s52, 133872
    s_nop 0
    buffer_load_dwordx4 v2, s[56:59], s53 offen sc1 lds
    s_add_u32 s53, s53, 1024
    s_add_u32 m0, s52, 135216
    s_nop 0
    buffer_load_dwordx4 v2, s[56:59], s53 offen sc1 lds
    s_add_u32 s53, s53, 1024
NOUS:
    ds_write_b128 v1, v[136:139] offset:0
    ds_write_b128 v1, v[140:143] offset:1024
    ds_write_b128 v1, v[144:147] offset:2048
    ds_write_b128 v1, v[148:151] offset:3072
    ds_write_b128 v1, v[152:155] offset:4096
    ds_write_b128 v1, v[156:159] offset:5120
    ds_write_b128 v1, v[160:163] offset:6144
    ds_write_b128 v1, v[164:167] offset:7168
    ds_write_b128 v1, v[168:171] offset:8192
    ds_write_b128 v1, v[172:175] offset:9216
    ds_write_b128 v1, v[176:179] offset:10240
    ds_write_b128 v1, v[180:183] offset:11264
    ds_write_b128 v1, v[184:187] offset:12288
    ds_write_b128 v1, v[188:191] offset:13312
    ds_write_b128 v1, v[192:195] offset:14336
    ds_write_b128 v1, v[196:199] offset:15360
    ds_write_b128 v1, v[200:203] offset:16384
    ds_write_b128 v1, v[204:207] offset:17408
    ds_write_b128 v1, v[208:211] offset:18432
    ds_write_b128 v1, v[212:215] offset:19456
    ds_write_b128 v1, v[216:219] offset:20480
    ds_write_b128 v1, v[220:223] offset:21504
    ds_write_b128 v1, v[224:227] offset:22528
    ds_write_b128 v1, v[228:231] offset:23552
    ds_write_b128 v1, v[232:235] offset:24576
    ds_write_b128 v1, v[236:239] offset:25600
    ds_write_b128 v1, v[240:243] offset:26624
    ds_write_b128 v1, v[244:247] offset:27648
    s_waitcnt vmcnt(0) lgkmcnt(0)
    s_branch L_CONVA
L_KWAVE:
    s_setprio 0
    s_lshl_b32 s70, s68, 13
    s_add_u32 s70, s70, 147456
    s_cmp_lg_u32 s69, 0
    s_cbranch_scc1 KG_NOTAG
    s_memrealtime s[72:73]
    v_mov_b32 v2, 0
    s_waitcnt lgkmcnt(0)
    s_or_b32 s72, s72, 1
    v_mov_b32 v3, s72
    s_mov_b64 exec, 1
    global_store_dword v2, v3, s[34:35] sc1
    s_mov_b64 exec, -1
KG_NOTAG:
    v_lshrrev_b32 v2, 1, v0
    v_and_b32 v3, 7, v2
    v_lshlrev_b32 v2, 8, v2
    v_and_b32 v4, 1, v0
    v_lshl_add_u32 v2, v4, 3, v2
    v_add_u32 v2, s70, v2
    v_xor_b32 v4, 0, v3
    v_lshl_add_u32 v14, v4, 4, v2
    v_xor_b32 v4, 1, v3
    v_lshl_add_u32 v15, v4, 4, v2
    v_xor_b32 v4, 2, v3
    v_lshl_add_u32 v16, v4, 4, v2
    v_xor_b32 v4, 3, v3
    v_lshl_add_u32 v17, v4, 4, v2
    v_xor_b32 v4, 4, v3
    v_lshl_add_u32 v18, v4, 4, v2
    v_xor_b32 v4, 5, v3
    v_lshl_add_u32 v19, v4, 4, v2
    v_xor_b32 v4, 6, v3
    v_lshl_add_u32 v20, v4, 4, v2
    v_xor_b32 v4, 7, v3
    v_lshl_add_u32 v21, v4, 4, v2
    v_and_b32 v2, 15, v0
    v_lshrrev_b32 v3, 4, v0
    v_add_u32 v4, 0, v3
    v_xor_b32 v5, v4, v2
    v_lshlrev_b32 v5, 4, v5
    v_lshl_add_u32 v5, v4, 8, v5
    v_add_u32 v22, s70, v5
    v_add_u32 v4, 4, v3
    v_xor_b32 v5, v4, v2
    v_lshlrev_b32 v5, 4, v5
    v_lshl_add_u32 v5, v4, 8, v5
    v_add_u32 v23, s70, v5
    v_and_b32 v4, 1, v3
    v_lshrrev_b32 v5, 1, v3
    v_lshlrev_b32 v24, 5, v2
    v_lshl_add_u32 v24, v4, 4, v24
    v_lshl_add_u32 v24, v5, 9, v24
    v_lshrrev_b32 v28, 2, v24
    v_cvt_f32_u32 v28, v28
    v_add_u32 v24, s70, v24
    v_add_f32 v29, 1.0, v28
    v_add_f32 v30, 2.0, v28
    v_add_f32 v31, 2.0, v29
    v_cmp_gt_u32 vcc, 2, v3
    v_lshlrev_b32 v25, 4, v2
    v_lshlrev_b32 v26, 3, v2
    v_cndmask_b32 v25, v26, v25, vcc
    v_lshl_add_u32 v25, v3, 8, v25
    v_add_u32 v25, s70, v25
    v_add_u32 v25, 1024, v25
    v_mov_b32 v26, 128
    v_cndmask_b32 v26, v26, 8, vcc
    v_add_u32 v26, v26, v25
    v_lshlrev_b32 v27, 2, v2
    v_lshl_add_u32 v27, v3, 8, v27
    v_add_u32 v27, s70, v27
    v_lshlrev_b32 v4, 7, v3
    v_add_u32 v4, 256, v4
    v_lshlrev_b32 v5, 8, v3
    v_cndmask_b32 v4, v5, v4, vcc
    v_lshl_add_u32 v4, v2, 3, v4
    v_cvt_f32_u32 v32, v4
    v_mov_b32 v4, 4.0
    v_cndmask_b32 v4, v4, 2.0, vcc
    v_mov_b32 v5, 0x43000000
    v_cndmask_b32 v5, v5, 4.0, vcc
    v_add_f32 v33, v32, v4
    v_add_f32 v34, v32, v5
    v_add_f32 v35, v34, v4
    v_lshlrev_b32 v4, 9, v3
    v_lshl_add_u32 v4, v2, 3, v4
    v_add_u32 v4, 1024, v4
    v_cvt_f32_u32 v36, v4
    v_add_f32 v37, 0x43000000, v36
    v_add_f32 v38, 0x43800000, v36
    v_add_f32 v39, 0x43c00000, v36
    s_sub_u32 s72, s70, 68096
    v_lshlrev_b32 v2, 3, v0
    v_cvt_f32_u32 v3, v2
    v_cmp_gt_u32 vcc, 16, v0
    v_add_u32 v48, s70, v2
    v_lshlrev_b32 v2, 2, v2
    v_add_u32 v2, s70, v2
    v_lshlrev_b32 v49, 2, v0
    v_add_u32 v49, s70, v49
    v_add_u32 v49, 2048, v49
    v_add_f32 v4, 1.0, v3
    v_cvt_pk_bf16_f32 v5, v3, v4
    v_add_f32 v3, 2.0, v3
    v_and_b32 v40, 0xffff, v5
    v_lshrrev_b32 v41, 16, v5
    v_lshl_add_u32 v40, v40, 2, s72
    v_lshl_add_u32 v41, v41, 2, s72
    v_add_u32 v4, 0, v2
    v_add_u32 v5, 4, v2
    v_cndmask_b32 v40, v40, v4, vcc
    v_cndmask_b32 v41, v41, v5, vcc
    v_add_f32 v4, 1.0, v3
    v_cvt_pk_bf16_f32 v5, v3, v4
    v_add_f32 v3, 2.0, v3
    v_and_b32 v42, 0xffff, v5
    v_lshrrev_b32 v43, 16, v5
    v_lshl_add_u32 v42, v42, 2, s72
    v_lshl_add_u32 v43, v43, 2, s72
    v_add_u32 v4, 8, v2
    v_add_u32 v5, 12, v2
    v_cndmask_b32 v42, v42, v4, vcc
    v_cndmask_b32 v43, v43, v5, vcc
    v_add_f32 v4, 1.0, v3
    v_cvt_pk_bf16_f32 v5, v3, v4
    v_add_f32 v3, 2.0, v3
    v_and_b32 v44, 0xffff, v5
    v_lshrrev_b32 v45, 16, v5
    v_lshl_add_u32 v44, v44, 2, s72
    v_lshl_add_u32 v45, v45, 2, s72
    v_add_u32 v4, 16, v2
    v_add_u32 v5, 20, v2
    v_cndmask_b32 v44, v44, v4, vcc
    v_cndmask_b32 v45, v45, v5, vcc
    v_add_f32 v4, 1.0, v3
    v_cvt_pk_bf16_f32 v5, v3, v4
    v_add_f32 v3, 2.0, v3
    v_and_b32 v46, 0xffff, v5
    v_lshrrev_b32 v47, 16, v5
    v_lshl_add_u32 v46, v46, 2, s72
    v_lshl_add_u32 v47, v47, 2, s72
    v_add_u32 v4, 24, v2
    v_add_u32 v5, 28, v2
    v_cndmask_b32 v46, v46, v4, vcc
    v_cndmask_b32 v47, v47, v5, vcc
    global_load_dword v6, v11, s[54:55]
    global_load_dword v7, v11, s[56:57]
    global_load_dword v8, v11, s[58:59]
    global_load_dword v9, v11, s[60:61]
    global_load_dword v10, v11, s[62:63]
    global_load_dword v11, v11, s[64:65]
    global_load_ushort v12, v13, s[66:67]
    global_load_ushort v13, v13, s[20:21]
    s_mov_b32 s56, s36
    s_and_b32 s57, s37, 0xffff
    s_mov_b32 s58, 16777216
    s_mov_b32 s59, 0x00020000
    s_barrier
    s_waitcnt vmcnt(0)
    v_mov_b32 v50, 0xffff0000
    v_cmp_eq_u32 vcc, 0, v0
    v_lshlrev_b32 v13, 16, v13
    s_nop 0
    v_cndmask_b32 v13, 0, v13, vcc
    v_lshlrev_b32 v52, 16, v6
    v_and_b32 v53, v50, v6
    v_lshlrev_b32 v54, 16, v7
    v_and_b32 v55, v50, v7
    v_lshlrev_b32 v56, 16, v8
    v_and_b32 v57, v50, v8
    v_lshlrev_b32 v58, 16, v9
    v_and_b32 v59, v50, v9
    v_lshlrev_b32 v60, 16, v10
    v_and_b32 v61, v50, v10
    v_lshlrev_b32 v62, 16, v11
    v_and_b32 v63, v50, v11
    v_lshlrev_b32 v12, 16, v12
    v_mul_f32 v2, 0x3fb8aa3b, v12
    s_mov_b32 s72, 0x3fb8aa3b
    v_fma_f32 v3, v12, s72, -v2
    v_fmac_f32 v3, 0x32a57060, v12
    v_exp_f32 v2, v2
    v_mul_f32 v3, 0x3f317218, v3
    v_fmac_f32 v2, v2, v3
    v_cvt_pk_bf16_f32 v2, v2, v2
    v_lshlrev_b32 v51, 16, v2
    v_mul_f32 v52, v51, v52
    v_mul_f32 v54, v51, v54
    v_mul_f32 v56, v51, v56
    v_mul_f32 v58, v51, v58
    v_mul_f32 v52, 0x3fb8aa3b, v52
    v_mul_f32 v54, 0x3e22f983, v54
    v_mul_f32 v53, v51, v53
    v_mul_f32 v55, v51, v55
    v_mul_f32 v57, v51, v57
    v_mul_f32 v59, v51, v59
    v_mul_f32 v53, 0x3fb8aa3b, v53
    v_mul_f32 v55, 0x3e22f983, v55
    v_mul_f32 v64, v60, v56
    v_mul_f32 v65, v60, v58
    v_fma_f32 v64, -v62, v58, v64
    v_fmac_f32 v65, v62, v56
    v_sub_f32 v65, 0, v65
    v_mul_f32 v66, v61, v57
    v_mul_f32 v67, v61, v59
    v_fma_f32 v66, -v63, v59, v66
    v_fmac_f32 v67, v63, v57
    v_sub_f32 v67, 0, v67
    v_max_f32 v72, v52, v53
    v_max3_f32 v73, |v64|, |v65|, |v66|
    v_max_f32 v73, |v67|, v73
    s_nop 1
    v_max_f32_dpp v72, v72, v72 quad_perm:[1,0,3,2] row_mask:0xf bank_mask:0xf
    v_max_f32_dpp v73, v73, v73 quad_perm:[1,0,3,2] row_mask:0xf bank_mask:0xf
    s_nop 0
    v_max_f32_dpp v72, v72, v72 quad_perm:[2,3,0,1] row_mask:0xf bank_mask:0xf
    v_max_f32_dpp v73, v73, v73 quad_perm:[2,3,0,1] row_mask:0xf bank_mask:0xf
    s_nop 0
    v_max_f32_dpp v72, v72, v72 row_half_mirror row_mask:0xf bank_mask:0xf
    v_max_f32_dpp v73, v73, v73 row_half_mirror row_mask:0xf bank_mask:0xf
    s_nop 0
    v_max_f32_dpp v72, v72, v72 row_mirror row_mask:0xf bank_mask:0xf
    v_max_f32_dpp v73, v73, v73 row_mirror row_mask:0xf bank_mask:0xf
    s_nop 0
    v_readlane_b32 s72, v72, 0
    v_readlane_b32 s73, v72, 16
    v_readlane_b32 s74, v72, 32
    v_readlane_b32 s75, v72, 48
    v_readlane_b32 s6, v73, 0
    v_readlane_b32 s7, v73, 16
    v_readlane_b32 s8, v73, 32
    v_readlane_b32 s9, v73, 48
    v_max_f32 v72, s72, v72
    v_max_f32 v72, s73, v72
    v_max_f32 v72, s74, v72
    v_max_f32 v72, s75, v72
    v_max_f32 v73, s6, v73
    v_max_f32 v73, s7, v73
    v_max_f32 v73, s8, v73
    v_max_f32 v73, s9, v73
    v_sub_f32 v52, v52, v72
    v_sub_f32 v53, v53, v72
    v_frexp_exp_i32_f32 v74, v73
    v_sub_u32 v2, 14, v74
    v_subrev_u32 v74, 29, v74
    v_ldexp_f32 v64, v64, v2
    v_ldexp_f32 v65, v65, v2
    v_ldexp_f32 v66, v66, v2
    v_ldexp_f32 v67, v67, v2
    v_mul_f32 v2, 0x41000000, v52
    v_mul_f32 v3, 0x41000000, v54
    v_exp_f32 v2, v2
    v_fract_f32 v3, v3
    v_cos_f32 v4, v3
    v_sin_f32 v5, v3
    s_nop 0
    v_mul_f32 v192, v2, v4
    v_mul_f32 v193, v2, v5
    v_sub_f32 v196, 0, v193
    v_mul_f32 v2, 0x41000000, v53
    v_mul_f32 v3, 0x41000000, v55
    v_exp_f32 v2, v2
    v_fract_f32 v3, v3
    v_cos_f32 v4, v3
    v_sin_f32 v5, v3
    s_nop 0
    v_mul_f32 v194, v2, v4
    v_mul_f32 v195, v2, v5
    v_sub_f32 v197, 0, v195
    v_mul_f32 v68, v64, v192
    v_mul_f32 v69, v64, v196
    v_fmac_f32 v68, v65, v193
    v_fmac_f32 v69, v65, v192
    v_mul_f32 v70, v66, v194
    v_mul_f32 v71, v66, v197
    v_fmac_f32 v70, v67, v195
    v_fmac_f32 v71, v67, v194
    v_cvt_pk_f16_f32 v76, v64, v65
    v_cvt_pk_f16_f32 v77, v66, v67
    v_mul_f32 v64, v68, v192
    v_mul_f32 v65, v68, v196
    v_fmac_f32 v64, v69, v193
    s_barrier
    v_fmac_f32 v65, v69, v192
    v_mul_f32 v66, v70, v194
    v_mul_f32 v67, v70, v197
    v_fmac_f32 v66, v71, v195
    v_fmac_f32 v67, v71, v194
    v_cvt_pk_f16_f32 v78, v68, v69
    v_cvt_pk_f16_f32 v79, v70, v71
    v_mul_f32 v68, v64, v192
    v_mul_f32 v69, v64, v196
    v_fmac_f32 v68, v65, v193
    v_fmac_f32 v69, v65, v192
    v_mul_f32 v70, v66, v194
    v_mul_f32 v71, v66, v197
    v_fmac_f32 v70, v67, v195
    v_fmac_f32 v71, v67, v194
    v_cvt_pk_f16_f32 v80, v64, v65
    v_cvt_pk_f16_f32 v81, v66, v67
    v_mul_f32 v64, v68, v192
    v_mul_f32 v65, v68, v196
    v_fmac_f32 v64, v69, v193
    v_fmac_f32 v65, v69, v192
    v_mul_f32 v66, v70, v194
    v_mul_f32 v67, v70, v197
    v_fmac_f32 v66, v71, v195
    v_fmac_f32 v67, v71, v194
    v_cvt_pk_f16_f32 v82, v68, v69
    v_cvt_pk_f16_f32 v83, v70, v71
    v_mul_f32 v68, v64, v192
    v_mul_f32 v69, v64, v196
    v_fmac_f32 v68, v65, v193
    v_fmac_f32 v69, v65, v192
    v_mul_f32 v70, v66, v194
    v_mul_f32 v71, v66, v197
    v_fmac_f32 v70, v67, v195
    v_fmac_f32 v71, v67, v194
    v_cvt_pk_f16_f32 v84, v64, v65
    v_cvt_pk_f16_f32 v85, v66, v67
    v_mul_f32 v64, v68, v192
    v_mul_f32 v65, v68, v196
    v_fmac_f32 v64, v69, v193
    v_fmac_f32 v65, v69, v192
    v_mul_f32 v66, v70, v194
    v_mul_f32 v67, v70, v197
    v_fmac_f32 v66, v71, v195
    v_fmac_f32 v67, v71, v194
    v_cvt_pk_f16_f32 v86, v68, v69
    v_cvt_pk_f16_f32 v87, v70, v71
    v_mul_f32 v68, v64, v192
    v_mul_f32 v69, v64, v196
    v_fmac_f32 v68, v65, v193
    v_fmac_f32 v69, v65, v192
    v_mul_f32 v70, v66, v194
    v_mul_f32 v71, v66, v197
    v_fmac_f32 v70, v67, v195
    v_fmac_f32 v71, v67, v194
    v_cvt_pk_f16_f32 v88, v64, v65
    v_cvt_pk_f16_f32 v89, v66, v67
    v_mul_f32 v64, v68, v192
    v_mul_f32 v65, v68, v196
    v_fmac_f32 v64, v69, v193
    v_fmac_f32 v65, v69, v192
    v_mul_f32 v66, v70, v194
    v_mul_f32 v67, v70, v197
    v_fmac_f32 v66, v71, v195
    v_fmac_f32 v67, v71, v194
    v_cvt_pk_f16_f32 v90, v68, v69
    v_cvt_pk_f16_f32 v91, v70, v71
    v_mul_f32 v68, v64, v192
    v_mul_f32 v69, v64, v196
    v_fmac_f32 v68, v65, v193
    v_fmac_f32 v69, v65, v192
    v_mul_f32 v70, v66, v194
    v_mul_f32 v71, v66, v197
    v_fmac_f32 v70, v67, v195
    v_fmac_f32 v71, v67, v194
    v_cvt_pk_f16_f32 v92, v64, v65
    v_cvt_pk_f16_f32 v93, v66, v67
    v_mul_f32 v64, v68, v192
    v_mul_f32 v65, v68, v196
    v_fmac_f32 v64, v69, v193
    v_fmac_f32 v65, v69, v192
    v_mul_f32 v66, v70, v194
    v_mul_f32 v67, v70, v197
    v_fmac_f32 v66, v71, v195
    v_fmac_f32 v67, v71, v194
    v_cvt_pk_f16_f32 v94, v68, v69
    v_cvt_pk_f16_f32 v95, v70, v71
    v_mul_f32 v68, v64, v192
    v_mul_f32 v69, v64, v196
    v_fmac_f32 v68, v65, v193
    v_fmac_f32 v69, v65, v192
    v_mul_f32 v70, v66, v194
    v_mul_f32 v71, v66, v197
    v_fmac_f32 v70, v67, v195
    v_fmac_f32 v71, v67, v194
    v_cvt_pk_f16_f32 v96, v64, v65
    v_cvt_pk_f16_f32 v97, v66, v67
    v_mul_f32 v64, v68, v192
    v_mul_f32 v65, v68, v196
    v_fmac_f32 v64, v69, v193
    v_fmac_f32 v65, v69, v192
    v_mul_f32 v66, v70, v194
    v_mul_f32 v67, v70, v197
    v_fmac_f32 v66, v71, v195
    v_fmac_f32 v67, v71, v194
    v_cvt_pk_f16_f32 v98, v68, v69
    v_cvt_pk_f16_f32 v99, v70, v71
    v_mul_f32 v68, v64, v192
    v_mul_f32 v69, v64, v196
    v_fmac_f32 v68, v65, v193
    v_fmac_f32 v69, v65, v192
    v_mul_f32 v70, v66, v194
    v_mul_f32 v71, v66, v197
    v_fmac_f32 v70, v67, v195
    v_fmac_f32 v71, v67, v194
    v_cvt_pk_f16_f32 v100, v64, v65
    v_cvt_pk_f16_f32 v101, v66, v67
    v_mul_f32 v64, v68, v192
    v_mul_f32 v65, v68, v196
    v_fmac_f32 v64, v69, v193
    v_fmac_f32 v65, v69, v192
    v_mul_f32 v66, v70, v194
    v_mul_f32 v67, v70, v197
    v_fmac_f32 v66, v71, v195
    v_fmac_f32 v67, v71, v194
    v_cvt_pk_f16_f32 v102, v68, v69
    v_cvt_pk_f16_f32 v103, v70, v71
    v_mul_f32 v68, v64, v192
    v_mul_f32 v69, v64, v196
    v_fmac_f32 v68, v65, v193
    v_fmac_f32 v69, v65, v192
    v_mul_f32 v70, v66, v194
    v_mul_f32 v71, v66, v197
    v_fmac_f32 v70, v67, v195
    v_fmac_f32 v71, v67, v194
    v_cvt_pk_f16_f32 v104, v64, v65
    v_cvt_pk_f16_f32 v105, v66, v67
    v_cvt_pk_f16_f32 v106, v68, v69
    v_cvt_pk_f16_f32 v107, v70, v71
    v_mul_f32 v2, 0x3f800000, v52
    v_mul_f32 v3, 0x3f800000, v54
    v_exp_f32 v2, v2
    v_fract_f32 v3, v3
    v_cos_f32 v4, v3
    v_sin_f32 v5, v3
    s_nop 0
    v_mul_f32 v198, v2, v4
    v_mul_f32 v199, v2, v5
    v_sub_f32 v202, 0, v199
    v_mul_f32 v2, 0x3f800000, v53
    v_mul_f32 v3, 0x3f800000, v55
    v_exp_f32 v2, v2
    v_fract_f32 v3, v3
    v_cos_f32 v4, v3
    v_sin_f32 v5, v3
    s_nop 0
    v_mul_f32 v200, v2, v4
    v_mul_f32 v201, v2, v5
    v_sub_f32 v203, 0, v201
    v_mul_f32 v2, 0x43000000, v52
    v_mul_f32 v3, 0x43000000, v54
    v_exp_f32 v2, v2
    v_fract_f32 v3, v3
    v_cos_f32 v4, v3
    v_sin_f32 v5, v3
    s_barrier
    s_nop 0
    v_mul_f32 v204, v2, v4
    v_mul_f32 v205, v2, v5
    v_sub_f32 v208, 0, v205
    v_mul_f32 v2, 0x43000000, v53
    v_mul_f32 v3, 0x43000000, v55
    v_exp_f32 v2, v2
    v_fract_f32 v3, v3
    v_cos_f32 v4, v3
    v_sin_f32 v5, v3
    s_nop 0
    v_mul_f32 v206, v2, v4
    v_mul_f32 v207, v2, v5
    v_sub_f32 v209, 0, v207
    v_mul_f32 v2, 0x44800000, v52
    v_mul_f32 v3, 0x44800000, v54
    v_exp_f32 v2, v2
    v_fract_f32 v3, v3
    v_cos_f32 v4, v3
    v_sin_f32 v5, v3
    s_nop 0
    v_mul_f32 v210, v2, v4
    v_mul_f32 v211, v2, v5
    v_sub_f32 v214, 0, v211
    v_mul_f32 v2, 0x44800000, v53
    v_mul_f32 v3, 0x44800000, v55
    v_exp_f32 v2, v2
    v_fract_f32 v3, v3
    v_cos_f32 v4, v3
    v_sin_f32 v5, v3
    s_nop 0
    v_mul_f32 v212, v2, v4
    v_mul_f32 v213, v2, v5
    v_sub_f32 v215, 0, v213
    v_mul_f32 v216, 0x47000000, v198
    v_mul_f32 v217, 0x47000000, v199
    v_mul_f32 v218, 0x47000000, v200
    v_mul_f32 v219, 0x47000000, v201
    v_mul_f32 v220, v216, v198
    v_mul_f32 v221, v216, v199
    v_fmac_f32 v220, v217, v202
    v_fmac_f32 v221, v217, v198
    v_mul_f32 v222, v218, v200
    v_mul_f32 v223, v218, v201
    v_fmac_f32 v222, v219, v203
    v_fmac_f32 v223, v219, v200
    v_mul_f32 v224, v220, v198
    v_mul_f32 v225, v220, v199
    v_fmac_f32 v224, v221, v202
    v_fmac_f32 v225, v221, v198
    v_mul_f32 v226, v222, v200
    v_mul_f32 v227, v222, v201
    v_fmac_f32 v226, v223, v203
    v_fmac_f32 v227, v223, v200
    v_mul_f32 v228, v224, v198
    v_mul_f32 v229, v224, v199
    v_fmac_f32 v228, v225, v202
    v_fmac_f32 v229, v225, v198
    v_mul_f32 v230, v226, v200
    v_mul_f32 v231, v226, v201
    v_fmac_f32 v230, v227, v203
    v_fmac_f32 v231, v227, v200
    v_mul_f32 v234, v228, v198
    v_mul_f32 v235, v228, v199
    v_fmac_f32 v234, v229, v202
    v_fmac_f32 v235, v229, v198
    v_mul_f32 v236, v230, v200
    v_mul_f32 v237, v230, v201
    v_fmac_f32 v236, v231, v203
    v_fmac_f32 v237, v231, v200
    v_mul_f32 v238, v234, v198
    v_mul_f32 v239, v234, v199
    v_fmac_f32 v238, v235, v202
    v_fmac_f32 v239, v235, v198
    v_mul_f32 v240, v236, v200
    v_mul_f32 v241, v236, v201
    v_fmac_f32 v240, v237, v203
    v_fmac_f32 v241, v237, v200
    v_mul_f32 v242, v238, v198
    v_mul_f32 v243, v238, v199
    v_fmac_f32 v242, v239, v202
    v_fmac_f32 v243, v239, v198
    v_mul_f32 v244, v240, v200
    v_mul_f32 v245, v240, v201
    v_fmac_f32 v244, v241, v203
    v_fmac_f32 v245, v241, v200
    v_mov_b32 v108, 0x7800
    v_mov_b32 v109, 0x7800
    v_cvt_pk_f16_f32 v110, v216, v217
    v_cvt_pk_f16_f32 v111, v218, v219
    v_cvt_pk_f16_f32 v112, v220, v221
    v_cvt_pk_f16_f32 v113, v222, v223
    v_cvt_pk_f16_f32 v114, v224, v225
    v_cvt_pk_f16_f32 v115, v226, v227
    v_cvt_pk_f16_f32 v116, v228, v229
    v_cvt_pk_f16_f32 v117, v230, v231
    v_cvt_pk_f16_f32 v118, v234, v235
    v_cvt_pk_f16_f32 v119, v236, v237
    v_cvt_pk_f16_f32 v120, v238, v239
    v_cvt_pk_f16_f32 v121, v240, v241
    v_cvt_pk_f16_f32 v122, v242, v243
    v_cvt_pk_f16_f32 v123, v244, v245
    v_mul_f32 v64, 0x47000000, v204
    v_mul_f32 v65, 0x47000000, v205
    v_mul_f32 v66, 0x47000000, v206
    v_mul_f32 v67, 0x47000000, v207
    v_cvt_pk_f16_f32 v124, v64, v65
    v_cvt_pk_f16_f32 v125, v66, v67
    v_mul_f32 v64, v216, v204
    v_mul_f32 v65, v216, v205
    v_fmac_f32 v64, v217, v208
    v_fmac_f32 v65, v217, v204
    v_mul_f32 v66, v218, v206
    v_mul_f32 v67, v218, v207
    v_fmac_f32 v66, v219, v209
    v_fmac_f32 v67, v219, v206
    v_cvt_pk_f16_f32 v126, v64, v65
    v_cvt_pk_f16_f32 v127, v66, v67
    v_mul_f32 v64, v220, v204
    v_mul_f32 v65, v220, v205
    v_fmac_f32 v64, v221, v208
    v_fmac_f32 v65, v221, v204
    v_mul_f32 v66, v222, v206
    v_mul_f32 v67, v222, v207
    v_fmac_f32 v66, v223, v209
    v_fmac_f32 v67, v223, v206
    v_cvt_pk_f16_f32 v128, v64, v65
    v_cvt_pk_f16_f32 v129, v66, v67
    v_mul_f32 v64, v224, v204
    v_mul_f32 v65, v224, v205
    v_fmac_f32 v64, v225, v208
    v_fmac_f32 v65, v225, v204
    v_mul_f32 v66, v226, v206
    v_mul_f32 v67, v226, v207
    s_barrier
    v_fmac_f32 v66, v227, v209
    v_fmac_f32 v67, v227, v206
    v_cvt_pk_f16_f32 v130, v64, v65
    v_cvt_pk_f16_f32 v131, v66, v67
    v_mul_f32 v64, v228, v204
    v_mul_f32 v65, v228, v205
    v_fmac_f32 v64, v229, v208
    v_fmac_f32 v65, v229, v204
    v_mul_f32 v66, v230, v206
    v_mul_f32 v67, v230, v207
    v_fmac_f32 v66, v231, v209
    v_fmac_f32 v67, v231, v206
    v_cvt_pk_f16_f32 v132, v64, v65
    v_cvt_pk_f16_f32 v133, v66, v67
    v_mul_f32 v64, v234, v204
    v_mul_f32 v65, v234, v205
    v_fmac_f32 v64, v235, v208
    v_fmac_f32 v65, v235, v204
    v_mul_f32 v66, v236, v206
    v_mul_f32 v67, v236, v207
    v_fmac_f32 v66, v237, v209
    v_fmac_f32 v67, v237, v206
    v_cvt_pk_f16_f32 v134, v64, v65
    v_cvt_pk_f16_f32 v135, v66, v67
    v_mul_f32 v64, v238, v204
    v_mul_f32 v65, v238, v205
    v_fmac_f32 v64, v239, v208
    v_fmac_f32 v65, v239, v204
    v_mul_f32 v66, v240, v206
    v_mul_f32 v67, v240, v207
    v_fmac_f32 v66, v241, v209
    v_fmac_f32 v67, v241, v206
    v_cvt_pk_f16_f32 v136, v64, v65
    v_cvt_pk_f16_f32 v137, v66, v67
    v_mul_f32 v64, v242, v204
    v_mul_f32 v65, v242, v205
    v_fmac_f32 v64, v243, v208
    v_fmac_f32 v65, v243, v204
    v_mul_f32 v66, v244, v206
    v_mul_f32 v67, v244, v207
    v_fmac_f32 v66, v245, v209
    v_fmac_f32 v67, v245, v206
    v_cvt_pk_f16_f32 v138, v64, v65
    v_cvt_pk_f16_f32 v139, v66, v67
    v_mul_f32 v198, v204, v204
    v_mul_f32 v199, v204, v205
    v_fmac_f32 v198, v205, v208
    v_fmac_f32 v199, v205, v204
    v_mul_f32 v200, v206, v206
    v_mul_f32 v201, v206, v207
    v_fmac_f32 v200, v207, v209
    v_fmac_f32 v201, v207, v206
    v_mul_f32 v56, v198, v204
    v_mul_f32 v57, v198, v205
    v_fmac_f32 v56, v199, v208
    v_fmac_f32 v57, v199, v204
    v_mul_f32 v58, v200, v206
    v_mul_f32 v59, v200, v207
    v_fmac_f32 v58, v201, v209
    v_fmac_f32 v59, v201, v206
    v_mul_f32 v216, v56, v204
    v_mul_f32 v217, v56, v205
    v_fmac_f32 v216, v57, v208
    v_fmac_f32 v217, v57, v204
    v_mul_f32 v218, v58, v206
    v_mul_f32 v219, v58, v207
    v_fmac_f32 v218, v59, v209
    v_fmac_f32 v219, v59, v206
    v_mul_f32 v224, v216, v204
    v_mul_f32 v225, v216, v205
    v_fmac_f32 v224, v217, v208
    v_fmac_f32 v225, v217, v204
    v_mul_f32 v226, v218, v206
    v_mul_f32 v227, v218, v207
    v_fmac_f32 v226, v219, v209
    v_fmac_f32 v227, v219, v206
    v_mul_f32 v234, v224, v204
    v_mul_f32 v235, v224, v205
    v_fmac_f32 v234, v225, v208
    v_fmac_f32 v235, v225, v204
    v_mul_f32 v236, v226, v206
    v_mul_f32 v237, v226, v207
    v_fmac_f32 v236, v227, v209
    v_fmac_f32 v237, v227, v206
    v_mul_f32 v242, v234, v204
    v_mul_f32 v243, v234, v205
    v_fmac_f32 v242, v235, v208
    v_fmac_f32 v243, v235, v204
    v_mul_f32 v244, v236, v206
    v_mul_f32 v245, v236, v207
    v_fmac_f32 v244, v237, v209
    v_fmac_f32 v245, v237, v206
    v_sub_f32 v232, 0, v229
    v_sub_f32 v233, 0, v231
    v_sub_f32 v202, 0, v199
    v_sub_f32 v203, 0, v201
    v_sub_f32 v60, 0, v57
    v_sub_f32 v61, 0, v59
    v_mul_f32 v64, 0x47000000, v198
    v_mul_f32 v65, 0x47000000, v199
    v_mul_f32 v66, 0x47000000, v200
    v_mul_f32 v67, 0x47000000, v201
    v_cvt_pk_f16_f32 v140, v64, v65
    v_cvt_pk_f16_f32 v141, v66, v67
    v_mul_f32 v64, v220, v198
    v_mul_f32 v65, v220, v199
    v_fmac_f32 v64, v221, v202
    v_fmac_f32 v65, v221, v198
    v_mul_f32 v66, v222, v200
    v_mul_f32 v67, v222, v201
    v_fmac_f32 v66, v223, v203
    v_fmac_f32 v67, v223, v200
    v_cvt_pk_f16_f32 v142, v64, v65
    v_cvt_pk_f16_f32 v143, v66, v67
    v_mul_f32 v64, v228, v198
    v_mul_f32 v65, v228, v199
    v_fmac_f32 v64, v229, v202
    v_fmac_f32 v65, v229, v198
    v_mul_f32 v66, v230, v200
    v_mul_f32 v67, v230, v201
    s_barrier
    v_fmac_f32 v66, v231, v203
    v_fmac_f32 v67, v231, v200
    v_cvt_pk_f16_f32 v144, v64, v65
    v_cvt_pk_f16_f32 v145, v66, v67
    v_mul_f32 v64, v238, v198
    v_mul_f32 v65, v238, v199
    v_fmac_f32 v64, v239, v202
    v_fmac_f32 v65, v239, v198
    v_mul_f32 v66, v240, v200
    v_mul_f32 v67, v240, v201
    v_fmac_f32 v66, v241, v203
    v_fmac_f32 v67, v241, v200
    v_cvt_pk_f16_f32 v146, v64, v65
    v_cvt_pk_f16_f32 v147, v66, v67
    v_mul_f32 v64, 0x47000000, v56
    v_mul_f32 v65, 0x47000000, v57
    v_mul_f32 v66, 0x47000000, v58
    v_mul_f32 v67, 0x47000000, v59
    v_cvt_pk_f16_f32 v148, v64, v65
    v_cvt_pk_f16_f32 v149, v66, v67
    v_mul_f32 v64, v220, v56
    v_mul_f32 v65, v220, v57
    v_fmac_f32 v64, v221, v60
    v_fmac_f32 v65, v221, v56
    v_mul_f32 v66, v222, v58
    v_mul_f32 v67, v222, v59
    v_fmac_f32 v66, v223, v61
    v_fmac_f32 v67, v223, v58
    v_cvt_pk_f16_f32 v150, v64, v65
    v_cvt_pk_f16_f32 v151, v66, v67
    v_mul_f32 v64, v228, v56
    v_mul_f32 v65, v228, v57
    v_fmac_f32 v64, v229, v60
    v_fmac_f32 v65, v229, v56
    v_mul_f32 v66, v230, v58
    v_mul_f32 v67, v230, v59
    v_fmac_f32 v66, v231, v61
    v_fmac_f32 v67, v231, v58
    v_cvt_pk_f16_f32 v152, v64, v65
    v_cvt_pk_f16_f32 v153, v66, v67
    v_mul_f32 v64, v238, v56
    v_mul_f32 v65, v238, v57
    v_fmac_f32 v64, v239, v60
    v_fmac_f32 v65, v239, v56
    v_mul_f32 v66, v240, v58
    v_mul_f32 v67, v240, v59
    v_fmac_f32 v66, v241, v61
    v_fmac_f32 v67, v241, v58
    v_cvt_pk_f16_f32 v154, v64, v65
    v_cvt_pk_f16_f32 v155, v66, v67
    v_mul_f32 v64, 0x47000000, v216
    v_mul_f32 v65, 0x47000000, v217
    v_mul_f32 v66, 0x47000000, v218
    v_mul_f32 v67, 0x47000000, v219
    v_cvt_pk_f16_f32 v156, v64, v65
    v_cvt_pk_f16_f32 v157, v66, v67
    v_mul_f32 v64, v216, v228
    v_mul_f32 v65, v216, v229
    v_fmac_f32 v64, v217, v232
    v_fmac_f32 v65, v217, v228
    v_mul_f32 v66, v218, v230
    v_mul_f32 v67, v218, v231
    v_fmac_f32 v66, v219, v233
    v_fmac_f32 v67, v219, v230
    v_cvt_pk_f16_f32 v158, v64, v65
    v_cvt_pk_f16_f32 v159, v66, v67
    v_mul_f32 v64, 0x47000000, v224
    v_mul_f32 v65, 0x47000000, v225
    v_mul_f32 v66, 0x47000000, v226
    v_mul_f32 v67, 0x47000000, v227
    v_cvt_pk_f16_f32 v160, v64, v65
    v_cvt_pk_f16_f32 v161, v66, v67
    v_mul_f32 v64, v224, v228
    v_mul_f32 v65, v224, v229
    v_fmac_f32 v64, v225, v232
    v_fmac_f32 v65, v225, v228
    v_mul_f32 v66, v226, v230
    v_mul_f32 v67, v226, v231
    v_fmac_f32 v66, v227, v233
    v_fmac_f32 v67, v227, v230
    v_cvt_pk_f16_f32 v162, v64, v65
    v_cvt_pk_f16_f32 v163, v66, v67
    v_mul_f32 v64, 0x47000000, v234
    v_mul_f32 v65, 0x47000000, v235
    v_mul_f32 v66, 0x47000000, v236
    v_mul_f32 v67, 0x47000000, v237
    v_cvt_pk_f16_f32 v164, v64, v65
    v_cvt_pk_f16_f32 v165, v66, v67
    v_mul_f32 v64, v234, v228
    v_mul_f32 v65, v234, v229
    v_fmac_f32 v64, v235, v232
    v_fmac_f32 v65, v235, v228
    v_mul_f32 v66, v236, v230
    v_mul_f32 v67, v236, v231
    v_fmac_f32 v66, v237, v233
    v_fmac_f32 v67, v237, v230
    v_cvt_pk_f16_f32 v166, v64, v65
    v_cvt_pk_f16_f32 v167, v66, v67
    v_mul_f32 v64, 0x47000000, v242
    v_mul_f32 v65, 0x47000000, v243
    v_mul_f32 v66, 0x47000000, v244
    v_mul_f32 v67, 0x47000000, v245
    v_cvt_pk_f16_f32 v168, v64, v65
    v_cvt_pk_f16_f32 v169, v66, v67
    v_mul_f32 v64, v242, v228
    v_mul_f32 v65, v242, v229
    v_fmac_f32 v64, v243, v232
    v_fmac_f32 v65, v243, v228
    v_mul_f32 v66, v244, v230
    v_mul_f32 v67, v244, v231
    v_fmac_f32 v66, v245, v233
    v_fmac_f32 v67, v245, v230
    v_cvt_pk_f16_f32 v170, v64, v65
    v_cvt_pk_f16_f32 v171, v66, v67
    v_mov_b32 v6, 0
    global_load_dword v7, v6, s[34:35] sc1
    v_mul_f32 v192, 0x47000000, v210
    v_mul_f32 v193, 0x47000000, v211
    v_mul_f32 v194, 0x47000000, v212
    v_mul_f32 v195, 0x47000000, v213
    s_barrier
    v_sub_f32 v196, 0, v193
    v_sub_f32 v197, 0, v195
    v_cvt_pk_f16_f32 v172, v192, v193
    v_cvt_pk_f16_f32 v173, v194, v195
    v_mul_f32 v64, v204, v192
    v_mul_f32 v65, v204, v193
    v_fmac_f32 v64, v205, v196
    v_fmac_f32 v65, v205, v192
    v_mul_f32 v66, v206, v194
    v_mul_f32 v67, v206, v195
    v_fmac_f32 v66, v207, v197
    v_fmac_f32 v67, v207, v194
    v_cvt_pk_f16_f32 v174, v64, v65
    v_cvt_pk_f16_f32 v175, v66, v67
    v_mul_f32 v64, v198, v192
    v_mul_f32 v65, v198, v193
    v_fmac_f32 v64, v199, v196
    v_fmac_f32 v65, v199, v192
    v_mul_f32 v66, v200, v194
    v_mul_f32 v67, v200, v195
    v_fmac_f32 v66, v201, v197
    v_fmac_f32 v67, v201, v194
    v_cvt_pk_f16_f32 v176, v64, v65
    v_cvt_pk_f16_f32 v177, v66, v67
    v_mul_f32 v64, v56, v192
    v_mul_f32 v65, v56, v193
    v_fmac_f32 v64, v57, v196
    v_fmac_f32 v65, v57, v192
    v_mul_f32 v66, v58, v194
    v_mul_f32 v67, v58, v195
    v_fmac_f32 v66, v59, v197
    v_fmac_f32 v67, v59, v194
    v_cvt_pk_f16_f32 v178, v64, v65
    v_cvt_pk_f16_f32 v179, v66, v67
    v_mul_f32 v64, v216, v192
    v_mul_f32 v65, v216, v193
    v_fmac_f32 v64, v217, v196
    v_fmac_f32 v65, v217, v192
    v_mul_f32 v66, v218, v194
    v_mul_f32 v67, v218, v195
    v_fmac_f32 v66, v219, v197
    v_fmac_f32 v67, v219, v194
    v_cvt_pk_f16_f32 v180, v64, v65
    v_cvt_pk_f16_f32 v181, v66, v67
    v_mul_f32 v64, v224, v192
    v_mul_f32 v65, v224, v193
    v_fmac_f32 v64, v225, v196
    v_fmac_f32 v65, v225, v192
    v_mul_f32 v66, v226, v194
    v_mul_f32 v67, v226, v195
    v_fmac_f32 v66, v227, v197
    v_fmac_f32 v67, v227, v194
    v_cvt_pk_f16_f32 v182, v64, v65
    v_cvt_pk_f16_f32 v183, v66, v67
    v_mul_f32 v64, v234, v192
    v_mul_f32 v65, v234, v193
    v_fmac_f32 v64, v235, v196
    v_fmac_f32 v65, v235, v192
    v_mul_f32 v66, v236, v194
    v_mul_f32 v67, v236, v195
    v_fmac_f32 v66, v237, v197
    v_fmac_f32 v67, v237, v194
    v_cvt_pk_f16_f32 v184, v64, v65
    v_cvt_pk_f16_f32 v185, v66, v67
    v_mul_f32 v64, v242, v192
    v_mul_f32 v65, v242, v193
    v_fmac_f32 v64, v243, v196
    v_fmac_f32 v65, v243, v192
    v_mul_f32 v66, v244, v194
    v_mul_f32 v67, v244, v195
    v_fmac_f32 v66, v245, v197
    v_fmac_f32 v67, v245, v194
    v_cvt_pk_f16_f32 v186, v64, v65
    v_cvt_pk_f16_f32 v187, v66, v67
    v_mul_f32 v64, v210, v192
    v_mul_f32 v65, v210, v193
    v_fmac_f32 v64, v211, v196
    v_fmac_f32 v65, v211, v192
    v_mul_f32 v66, v212, v194
    v_mul_f32 v67, v212, v195
    v_fmac_f32 v66, v213, v197
    v_fmac_f32 v67, v213, v194
    v_cvt_pk_f16_f32 v188, v64, v65
    v_cvt_pk_f16_f32 v189, v66, v67
    v_mul_f32 v28, v72, v28
    v_mul_f32 v29, v72, v29
    v_mul_f32 v30, v72, v30
    v_mul_f32 v31, v72, v31
    v_mul_f32 v32, v72, v32
    v_mul_f32 v33, v72, v33
    v_mul_f32 v34, v72, v34
    v_mul_f32 v35, v72, v35
    v_mul_f32 v36, v72, v36
    v_mul_f32 v37, v72, v37
    v_mul_f32 v38, v72, v38
    v_mul_f32 v39, v72, v39
    v_exp_f32 v28, v28
    v_exp_f32 v29, v29
    v_exp_f32 v30, v30
    v_exp_f32 v31, v31
    v_exp_f32 v32, v32
    v_exp_f32 v33, v33
    v_exp_f32 v34, v34
    v_exp_f32 v35, v35
    v_exp_f32 v36, v36
    v_exp_f32 v37, v37
    v_exp_f32 v38, v38
    v_exp_f32 v39, v39
    s_barrier
    s_waitcnt vmcnt(0)
    s_mov_b32 s77, 0x100000
    s_branch NKG_CHK
    NKG_SPIN:
    s_sleep 8
    global_load_dword v7, v6, s[34:35] sc1
    s_waitcnt vmcnt(0)
    s_sub_u32 s77, s77, 1
    s_cmp_eq_u32 s77, 0
    s_cbranch_scc1 NKG_OK
    NKG_CHK:
    v_cmp_ne_u32 vcc, 0, v7
    s_nop 3
    s_cmp_eq_u64 vcc, exec
    s_cbranch_scc0 NKG_SPIN
    NKG_OK:
    v_readfirstlane_b32 s23, v7
    s_nop 3
    v_mov_b32 v4, 142080
    ds_write_b32 v4, v7
    ds_write_b64 v14, v[76:77] offset:0
    ds_write_b64 v15, v[78:79] offset:0
    ds_write_b64 v16, v[80:81] offset:0
    ds_write_b64 v17, v[82:83] offset:0
    ds_write_b64 v18, v[84:85] offset:0
    ds_write_b64 v19, v[86:87] offset:0
    ds_write_b64 v20, v[88:89] offset:0
    ds_write_b64 v21, v[90:91] offset:0
    ds_write_b64 v14, v[92:93] offset:128
    ds_write_b64 v15, v[94:95] offset:128
    ds_write_b64 v16, v[96:97] offset:128
    ds_write_b64 v17, v[98:99] offset:128
    ds_write_b64 v18, v[100:101] offset:128
    ds_write_b64 v19, v[102:103] offset:128
    ds_write_b64 v20, v[104:105] offset:128
    ds_write_b64 v21, v[106:107] offset:128
    ds_read_b128 v[192:195], v22 offset:0
    ds_read_b128 v[196:199], v23 offset:0
    ds_read_b128 v[200:203], v22 offset:2048
    ds_read_b128 v[204:207], v23 offset:2048
    ds_read_b128 v[208:211], v22 offset:4096
    ds_read_b128 v[212:215], v23 offset:4096
    ds_read_b128 v[216:219], v22 offset:6144
    ds_read_b128 v[220:223], v23 offset:6144
    ds_write_b64 v14, v[108:109] offset:0
    ds_write_b64 v15, v[110:111] offset:0
    ds_write_b64 v16, v[112:113] offset:0
    ds_write_b64 v17, v[114:115] offset:0
    ds_write_b64 v18, v[116:117] offset:0
    ds_write_b64 v19, v[118:119] offset:0
    ds_write_b64 v20, v[120:121] offset:0
    ds_write_b64 v21, v[122:123] offset:0
    ds_write_b64 v14, v[124:125] offset:128
    ds_write_b64 v15, v[126:127] offset:128
    ds_write_b64 v16, v[128:129] offset:128
    ds_write_b64 v17, v[130:131] offset:128
    ds_write_b64 v18, v[132:133] offset:128
    ds_write_b64 v19, v[134:135] offset:128
    ds_write_b64 v20, v[136:137] offset:128
    ds_write_b64 v21, v[138:139] offset:128
    ds_read_b128 v[76:79], v22 offset:0
    ds_read_b128 v[80:83], v23 offset:0
    ds_read_b128 v[84:87], v22 offset:2048
    ds_read_b128 v[88:91], v23 offset:2048
    s_barrier
    ds_read_b128 v[92:95], v22 offset:4096
    ds_read_b128 v[96:99], v23 offset:4096
    ds_read_b128 v[100:103], v22 offset:6144
    ds_read_b128 v[104:107], v23 offset:6144
    ds_write_b64 v14, v[140:141] offset:0
    ds_write_b64 v15, v[142:143] offset:0
    ds_write_b64 v16, v[144:145] offset:0
    ds_write_b64 v17, v[146:147] offset:0
    ds_write_b64 v18, v[148:149] offset:0
    ds_write_b64 v19, v[150:151] offset:0
    ds_write_b64 v20, v[152:153] offset:0
    ds_write_b64 v21, v[154:155] offset:0
    ds_write_b64 v14, v[156:157] offset:128
    ds_write_b64 v15, v[158:159] offset:128
    ds_write_b64 v16, v[160:161] offset:128
    ds_write_b64 v17, v[162:163] offset:128
    ds_write_b64 v18, v[164:165] offset:128
    ds_write_b64 v19, v[166:167] offset:128
    ds_write_b64 v20, v[168:169] offset:128
    ds_write_b64 v21, v[170:171] offset:128
    ds_read_b128 v[108:111], v22 offset:0
    ds_read_b128 v[112:115], v23 offset:0
    ds_read_b128 v[116:119], v22 offset:2048
    ds_read_b128 v[120:123], v23 offset:2048
    ds_read_b128 v[124:127], v22 offset:4096
    ds_read_b128 v[128:131], v23 offset:4096
    ds_read_b128 v[132:135], v22 offset:6144
    ds_read_b128 v[136:139], v23 offset:6144
    s_waitcnt lgkmcnt(14)
    ds_write_b64 v14, v[172:173] offset:0
    ds_write_b64 v15, v[174:175] offset:0
    v_mfma_f32_16x16x32_f16 v[224:227], v[76:79], v[192:195], 0
    ds_write_b64 v16, v[176:177] offset:0
    ds_write_b64 v17, v[178:179] offset:0
    v_mfma_f32_16x16x32_f16 v[224:227], v[80:83], v[196:199], v[224:227]
    ds_write_b64 v18, v[180:181] offset:0
    ds_write_b64 v19, v[182:183] offset:0
    v_mfma_f32_16x16x32_f16 v[224:227], v[84:87], v[200:203], v[224:227]
    ds_write_b64 v20, v[184:185] offset:0
    ds_write_b64 v21, v[186:187] offset:0
    v_mfma_f32_16x16x32_f16 v[224:227], v[88:91], v[204:207], v[224:227]
    ds_write_b64 v14, v[188:189] offset:128
    ds_read_b128 v[140:143], v22 offset:0
    v_mfma_f32_16x16x32_f16 v[224:227], v[92:95], v[208:211], v[224:227]
    ds_read_b128 v[144:147], v23 offset:0
    ds_read_b128 v[148:151], v22 offset:2048
    v_mfma_f32_16x16x32_f16 v[224:227], v[96:99], v[212:215], v[224:227]
    ds_read_b128 v[152:155], v23 offset:2048
    ds_read_b128 v[156:159], v22 offset:4096
    v_mfma_f32_16x16x32_f16 v[224:227], v[100:103], v[216:219], v[224:227]
    ds_read_b128 v[160:163], v23 offset:4096
    ds_read_b128 v[164:167], v22 offset:6144
    s_barrier
    v_mfma_f32_16x16x32_f16 v[224:227], v[104:107], v[220:223], v[224:227]
    ds_read_b128 v[168:171], v23 offset:6144
    s_waitcnt lgkmcnt(14)
    v_mfma_f32_16x16x32_f16 v[228:231], v[108:111], v[192:195], 0
    v_mfma_f32_16x16x32_f16 v[228:231], v[112:115], v[196:199], v[228:231]
    v_mfma_f32_16x16x32_f16 v[228:231], v[116:119], v[200:203], v[228:231]
    v_mfma_f32_16x16x32_f16 v[228:231], v[120:123], v[204:207], v[228:231]
    v_mfma_f32_16x16x32_f16 v[228:231], v[124:127], v[208:211], v[228:231]
    v_mfma_f32_16x16x32_f16 v[228:231], v[128:131], v[212:215], v[228:231]
    v_mfma_f32_16x16x32_f16 v[228:231], v[132:135], v[216:219], v[228:231]
    v_mfma_f32_16x16x32_f16 v[228:231], v[136:139], v[220:223], v[228:231]
    s_waitcnt lgkmcnt(0)
    v_mfma_f32_16x16x32_f16 v[232:235], v[140:143], v[192:195], 0
    v_mfma_f32_16x16x32_f16 v[232:235], v[144:147], v[196:199], v[232:235]
    v_mfma_f32_16x16x32_f16 v[232:235], v[148:151], v[200:203], v[232:235]
    v_mfma_f32_16x16x32_f16 v[232:235], v[152:155], v[204:207], v[232:235]
    v_mfma_f32_16x16x32_f16 v[232:235], v[156:159], v[208:211], v[232:235]
    v_mfma_f32_16x16x32_f16 v[232:235], v[160:163], v[212:215], v[232:235]
    v_mfma_f32_16x16x32_f16 v[232:235], v[164:167], v[216:219], v[232:235]
    v_mfma_f32_16x16x32_f16 v[232:235], v[168:171], v[220:223], v[232:235]
    s_nop 3
    v_mul_f32 v224, v224, v28
    v_mul_f32 v225, v225, v29
    v_mul_f32 v226, v226, v30
    v_mul_f32 v227, v227, v31
    v_mul_f32 v228, v228, v32
    v_mul_f32 v229, v229, v33
    v_mul_f32 v230, v230, v34
    v_mul_f32 v231, v231, v35
    v_mul_f32 v232, v232, v36
    v_mul_f32 v233, v233, v37
    v_mul_f32 v234, v234, v38
    v_mul_f32 v235, v235, v39
    v_ldexp_f32 v224, v224, v74
    v_ldexp_f32 v225, v225, v74
    v_ldexp_f32 v226, v226, v74
    v_ldexp_f32 v227, v227, v74
    v_ldexp_f32 v228, v228, v74
    v_ldexp_f32 v229, v229, v74
    v_ldexp_f32 v230, v230, v74
    v_ldexp_f32 v231, v231, v74
    v_ldexp_f32 v232, v232, v74
    v_ldexp_f32 v233, v233, v74
    v_ldexp_f32 v234, v234, v74
    v_ldexp_f32 v235, v235, v74
    v_add_f32 v224, v224, v13
    ds_write_b128 v24, v[224:227]
    ds_write_b64 v25, v[228:229]
    ds_write_b64 v26, v[230:231]
    ds_write_b32 v27, v232 offset:2048
    ds_write_b32 v27, v233 offset:2112
    ds_write_b32 v27, v234 offset:2176
    ds_write_b32 v27, v235 offset:2240
    ds_read_b32 v76, v40
    ds_read_b32 v77, v41
    ds_read_b32 v78, v42
    ds_read_b32 v79, v43
    ds_read_b32 v80, v44
    ds_read_b32 v81, v45
    ds_read_b32 v82, v46
    ds_read_b32 v83, v47
    ds_read_b64 v[84:85], v48 offset:1536
    ds_read_b32 v86, v48 offset:1544
    ds_read2_b32 v[88:89], v49 offset0:0 offset1:1
    ds_read2_b32 v[90:91], v49 offset0:64 offset1:65
    v_lshlrev_b32 v2, 4, v0
    v_add_u32 v2, s70, v2
    v_and_b32 v3, 3, v0
    v_lshlrev_b32 v3, 4, v3
    v_add_u32 v3, s70, v3
    v_mov_b32 v124, 0
    v_mov_b32 v125, 0
    v_mov_b32 v126, 0
    v_mov_b32 v127, 0
    s_mov_b32 s72, 0xaaaaaaaa
    s_mov_b32 s73, 0xaaaaaaaa
    ds_write_b128 v3, v[124:127] offset:3584
    s_waitcnt lgkmcnt(0)
    v_cvt_pk_bf16_f32 v108, v76, v77
    v_cvt_pk_bf16_f32 v109, v78, v79
    v_cvt_pk_bf16_f32 v110, v80, v81
    v_cvt_pk_bf16_f32 v111, v82, v83
    v_cvt_pk_bf16_f32 v112, v84, v84
    v_cvt_pk_bf16_f32 v113, v84, v85
    v_cvt_pk_bf16_f32 v114, v85, v85
    v_cvt_pk_bf16_f32 v115, v86, v86
    v_cndmask_b32 v4, v88, v89, s[72:73]
    v_cvt_pk_bf16_f32 v116, v88, v88
    v_cvt_pk_bf16_f32 v117, v88, v88
    v_cvt_pk_bf16_f32 v118, v4, v89
    v_cvt_pk_bf16_f32 v119, v89, v89
    v_cndmask_b32 v4, v90, v91, s[72:73]
    v_cvt_pk_bf16_f32 v120, v90, v90
    v_cvt_pk_bf16_f32 v121, v90, v90
    v_cvt_pk_bf16_f32 v122, v4, v91
    v_cvt_pk_bf16_f32 v123, v91, v91
    v_mov_b32 v4, 0
    ds_write_b128 v2, v[108:111] offset:3648
    ds_write_b128 v2, v[112:115] offset:4672
    ds_write_b128 v2, v[116:119] offset:5696
    ds_write_b128 v2, v[120:123] offset:6720
    s_waitcnt vmcnt(0) lgkmcnt(0)
    s_mov_b32 s6, s68
    s_branch L_CONVB
L_KWAVE_S:
    s_setprio 0
    s_lshl_b32 s70, s68, 13
    s_add_u32 s70, s70, 147456
    v_lshrrev_b32 v2, 1, v0
    v_and_b32 v3, 7, v2
    v_lshlrev_b32 v2, 8, v2
    v_and_b32 v4, 1, v0
    v_lshl_add_u32 v2, v4, 3, v2
    v_add_u32 v2, s70, v2
    v_xor_b32 v4, 0, v3
    v_lshl_add_u32 v14, v4, 4, v2
    v_xor_b32 v4, 1, v3
    v_lshl_add_u32 v15, v4, 4, v2
    v_xor_b32 v4, 2, v3
    v_lshl_add_u32 v16, v4, 4, v2
    v_xor_b32 v4, 3, v3
    v_lshl_add_u32 v17, v4, 4, v2
    v_xor_b32 v4, 4, v3
    v_lshl_add_u32 v18, v4, 4, v2
    v_xor_b32 v4, 5, v3
    v_lshl_add_u32 v19, v4, 4, v2
    v_xor_b32 v4, 6, v3
    v_lshl_add_u32 v20, v4, 4, v2
    v_xor_b32 v4, 7, v3
    v_lshl_add_u32 v21, v4, 4, v2
    v_and_b32 v2, 15, v0
    v_lshrrev_b32 v3, 4, v0
    v_add_u32 v4, 0, v3
    v_xor_b32 v5, v4, v2
    v_lshlrev_b32 v5, 4, v5
    v_lshl_add_u32 v5, v4, 8, v5
    v_add_u32 v22, s70, v5
    v_add_u32 v4, 4, v3
    v_xor_b32 v5, v4, v2
    v_lshlrev_b32 v5, 4, v5
    v_lshl_add_u32 v5, v4, 8, v5
    v_add_u32 v23, s70, v5
    v_and_b32 v4, 1, v3
    v_lshrrev_b32 v5, 1, v3
    v_lshlrev_b32 v24, 5, v2
    v_lshl_add_u32 v24, v4, 4, v24
    v_lshl_add_u32 v24, v5, 9, v24
    v_lshrrev_b32 v28, 2, v24
    v_cvt_f32_u32 v28, v28
    v_add_u32 v24, s70, v24
    v_add_f32 v29, 1.0, v28
    v_add_f32 v30, 2.0, v28
    v_add_f32 v31, 2.0, v29
    v_cmp_gt_u32 vcc, 2, v3
    v_lshlrev_b32 v25, 4, v2
    v_lshlrev_b32 v26, 3, v2
    v_cndmask_b32 v25, v26, v25, vcc
    v_lshl_add_u32 v25, v3, 8, v25
    v_add_u32 v25, s70, v25
    v_add_u32 v25, 1024, v25
    v_mov_b32 v26, 128
    v_cndmask_b32 v26, v26, 8, vcc
    v_add_u32 v26, v26, v25
    v_lshlrev_b32 v27, 2, v2
    v_lshl_add_u32 v27, v3, 8, v27
    v_add_u32 v27, s70, v27
    v_lshlrev_b32 v4, 7, v3
    v_add_u32 v4, 256, v4
    v_lshlrev_b32 v5, 8, v3
    v_cndmask_b32 v4, v5, v4, vcc
    v_lshl_add_u32 v4, v2, 3, v4
    v_cvt_f32_u32 v32, v4
    v_mov_b32 v4, 4.0
    v_cndmask_b32 v4, v4, 2.0, vcc
    v_mov_b32 v5, 0x43000000
    v_cndmask_b32 v5, v5, 4.0, vcc
    v_add_f32 v33, v32, v4
    v_add_f32 v34, v32, v5
    v_add_f32 v35, v34, v4
    v_lshlrev_b32 v4, 9, v3
    v_lshl_add_u32 v4, v2, 3, v4
    v_add_u32 v4, 1024, v4
    v_cvt_f32_u32 v36, v4
    v_add_f32 v37, 0x43000000, v36
    v_add_f32 v38, 0x43800000, v36
    v_add_f32 v39, 0x43c00000, v36
    s_sub_u32 s72, s70, 68096
    v_lshlrev_b32 v2, 3, v0
    v_cvt_f32_u32 v3, v2
    v_cmp_gt_u32 vcc, 16, v0
    v_add_u32 v48, s70, v2
    v_lshlrev_b32 v2, 2, v2
    v_add_u32 v2, s70, v2
    v_lshlrev_b32 v49, 2, v0
    v_add_u32 v49, s70, v49
    v_add_u32 v49, 2048, v49
    v_add_f32 v4, 1.0, v3
    v_cvt_pk_bf16_f32 v5, v3, v4
    v_add_f32 v3, 2.0, v3
    v_and_b32 v40, 0xffff, v5
    v_lshrrev_b32 v41, 16, v5
    v_lshl_add_u32 v40, v40, 2, s72
    v_lshl_add_u32 v41, v41, 2, s72
    v_add_u32 v4, 0, v2
    v_add_u32 v5, 4, v2
    v_cndmask_b32 v40, v40, v4, vcc
    v_cndmask_b32 v41, v41, v5, vcc
    v_add_f32 v4, 1.0, v3
    v_cvt_pk_bf16_f32 v5, v3, v4
    v_add_f32 v3, 2.0, v3
    v_and_b32 v42, 0xffff, v5
    v_lshrrev_b32 v43, 16, v5
    v_lshl_add_u32 v42, v42, 2, s72
    v_lshl_add_u32 v43, v43, 2, s72
    v_add_u32 v4, 8, v2
    v_add_u32 v5, 12, v2
    v_cndmask_b32 v42, v42, v4, vcc
    v_cndmask_b32 v43, v43, v5, vcc
    v_add_f32 v4, 1.0, v3
    v_cvt_pk_bf16_f32 v5, v3, v4
    v_add_f32 v3, 2.0, v3
    v_and_b32 v44, 0xffff, v5
    v_lshrrev_b32 v45, 16, v5
    v_lshl_add_u32 v44, v44, 2, s72
    v_lshl_add_u32 v45, v45, 2, s72
    v_add_u32 v4, 16, v2
    v_add_u32 v5, 20, v2
    v_cndmask_b32 v44, v44, v4, vcc
    v_cndmask_b32 v45, v45, v5, vcc
    v_add_f32 v4, 1.0, v3
    v_cvt_pk_bf16_f32 v5, v3, v4
    v_add_f32 v3, 2.0, v3
    v_and_b32 v46, 0xffff, v5
    v_lshrrev_b32 v47, 16, v5
    v_lshl_add_u32 v46, v46, 2, s72
    v_lshl_add_u32 v47, v47, 2, s72
    v_add_u32 v4, 24, v2
    v_add_u32 v5, 28, v2
    v_cndmask_b32 v46, v46, v4, vcc
    v_cndmask_b32 v47, v47, v5, vcc
    s_mov_b32 s56, s36
    s_and_b32 s57, s37, 0xffff
    s_mov_b32 s58, 16777216
    s_mov_b32 s59, 0x00020000
    s_waitcnt vmcnt(0)
    v_mov_b32 v50, 0xffff0000
    v_cmp_eq_u32 vcc, 0, v0
    v_lshlrev_b32 v13, 16, v13
    s_nop 0
    v_cndmask_b32 v13, 0, v13, vcc
    v_lshlrev_b32 v52, 16, v6
    v_and_b32 v53, v50, v6
    v_lshlrev_b32 v54, 16, v7
    v_and_b32 v55, v50, v7
    v_lshlrev_b32 v56, 16, v8
    v_and_b32 v57, v50, v8
    v_lshlrev_b32 v58, 16, v9
    v_and_b32 v59, v50, v9
    v_lshlrev_b32 v60, 16, v10
    v_and_b32 v61, v50, v10
    v_lshlrev_b32 v62, 16, v11
    v_and_b32 v63, v50, v11
    v_lshlrev_b32 v12, 16, v12
    v_mul_f32 v2, 0x3fb8aa3b, v12
    s_mov_b32 s72, 0x3fb8aa3b
    v_fma_f32 v3, v12, s72, -v2
    v_fmac_f32 v3, 0x32a57060, v12
    v_exp_f32 v2, v2
    v_mul_f32 v3, 0x3f317218, v3
    v_fmac_f32 v2, v2, v3
    v_cvt_pk_bf16_f32 v2, v2, v2
    v_lshlrev_b32 v51, 16, v2
    v_mul_f32 v52, v51, v52
    v_mul_f32 v54, v51, v54
    v_mul_f32 v56, v51, v56
    v_mul_f32 v58, v51, v58
    v_mul_f32 v52, 0x3fb8aa3b, v52
    v_mul_f32 v54, 0x3e22f983, v54
    v_mul_f32 v53, v51, v53
    v_mul_f32 v55, v51, v55
    v_mul_f32 v57, v51, v57
    v_mul_f32 v59, v51, v59
    v_mul_f32 v53, 0x3fb8aa3b, v53
    v_mul_f32 v55, 0x3e22f983, v55
    v_mul_f32 v64, v60, v56
    v_mul_f32 v65, v60, v58
    v_fma_f32 v64, -v62, v58, v64
    v_fmac_f32 v65, v62, v56
    v_sub_f32 v65, 0, v65
    v_mul_f32 v66, v61, v57
    v_mul_f32 v67, v61, v59
    v_fma_f32 v66, -v63, v59, v66
    v_fmac_f32 v67, v63, v57
    v_sub_f32 v67, 0, v67
    v_max_f32 v72, v52, v53
    v_max3_f32 v73, |v64|, |v65|, |v66|
    v_max_f32 v73, |v67|, v73
    s_nop 1
    v_max_f32_dpp v72, v72, v72 quad_perm:[1,0,3,2] row_mask:0xf bank_mask:0xf
    v_max_f32_dpp v73, v73, v73 quad_perm:[1,0,3,2] row_mask:0xf bank_mask:0xf
    s_nop 0
    v_max_f32_dpp v72, v72, v72 quad_perm:[2,3,0,1] row_mask:0xf bank_mask:0xf
    v_max_f32_dpp v73, v73, v73 quad_perm:[2,3,0,1] row_mask:0xf bank_mask:0xf
    s_nop 0
    v_max_f32_dpp v72, v72, v72 row_half_mirror row_mask:0xf bank_mask:0xf
    v_max_f32_dpp v73, v73, v73 row_half_mirror row_mask:0xf bank_mask:0xf
    s_nop 0
    v_max_f32_dpp v72, v72, v72 row_mirror row_mask:0xf bank_mask:0xf
    v_max_f32_dpp v73, v73, v73 row_mirror row_mask:0xf bank_mask:0xf
    s_nop 0
    v_readlane_b32 s72, v72, 0
    v_readlane_b32 s73, v72, 16
    v_readlane_b32 s74, v72, 32
    v_readlane_b32 s75, v72, 48
    v_readlane_b32 s6, v73, 0
    v_readlane_b32 s7, v73, 16
    v_readlane_b32 s8, v73, 32
    v_readlane_b32 s9, v73, 48
    v_max_f32 v72, s72, v72
    v_max_f32 v72, s73, v72
    v_max_f32 v72, s74, v72
    v_max_f32 v72, s75, v72
    v_max_f32 v73, s6, v73
    v_max_f32 v73, s7, v73
    v_max_f32 v73, s8, v73
    v_max_f32 v73, s9, v73
    v_sub_f32 v52, v52, v72
    v_sub_f32 v53, v53, v72
    v_frexp_exp_i32_f32 v74, v73
    v_sub_u32 v2, 14, v74
    v_subrev_u32 v74, 29, v74
    v_ldexp_f32 v64, v64, v2
    v_ldexp_f32 v65, v65, v2
    v_ldexp_f32 v66, v66, v2
    v_ldexp_f32 v67, v67, v2
    v_mul_f32 v2, 0x41000000, v52
    v_mul_f32 v3, 0x41000000, v54
    v_exp_f32 v2, v2
    v_fract_f32 v3, v3
    v_cos_f32 v4, v3
    v_sin_f32 v5, v3
    s_nop 0
    v_mul_f32 v192, v2, v4
    v_mul_f32 v193, v2, v5
    v_sub_f32 v196, 0, v193
    v_mul_f32 v2, 0x41000000, v53
    v_mul_f32 v3, 0x41000000, v55
    v_exp_f32 v2, v2
    v_fract_f32 v3, v3
    v_cos_f32 v4, v3
    v_sin_f32 v5, v3
    s_nop 0
    v_mul_f32 v194, v2, v4
    v_mul_f32 v195, v2, v5
    v_sub_f32 v197, 0, v195
    v_mul_f32 v68, v64, v192
    v_mul_f32 v69, v64, v196
    v_fmac_f32 v68, v65, v193
    v_fmac_f32 v69, v65, v192
    v_mul_f32 v70, v66, v194
    v_mul_f32 v71, v66, v197
    v_fmac_f32 v70, v67, v195
    v_fmac_f32 v71, v67, v194
    v_cvt_pk_f16_f32 v76, v64, v65
    v_cvt_pk_f16_f32 v77, v66, v67
    v_mul_f32 v64, v68, v192
    v_mul_f32 v65, v68, v196
    v_fmac_f32 v64, v69, v193
    v_fmac_f32 v65, v69, v192
    v_mul_f32 v66, v70, v194
    v_mul_f32 v67, v70, v197
    v_fmac_f32 v66, v71, v195
    v_fmac_f32 v67, v71, v194
    v_cvt_pk_f16_f32 v78, v68, v69
    v_cvt_pk_f16_f32 v79, v70, v71
    v_mul_f32 v68, v64, v192
    v_mul_f32 v69, v64, v196
    v_fmac_f32 v68, v65, v193
    v_fmac_f32 v69, v65, v192
    v_mul_f32 v70, v66, v194
    v_mul_f32 v71, v66, v197
    v_fmac_f32 v70, v67, v195
    v_fmac_f32 v71, v67, v194
    v_cvt_pk_f16_f32 v80, v64, v65
    v_cvt_pk_f16_f32 v81, v66, v67
    v_mul_f32 v64, v68, v192
    v_mul_f32 v65, v68, v196
    v_fmac_f32 v64, v69, v193
    v_fmac_f32 v65, v69, v192
    v_mul_f32 v66, v70, v194
    v_mul_f32 v67, v70, v197
    v_fmac_f32 v66, v71, v195
    v_fmac_f32 v67, v71, v194
    v_cvt_pk_f16_f32 v82, v68, v69
    v_cvt_pk_f16_f32 v83, v70, v71
    v_mul_f32 v68, v64, v192
    v_mul_f32 v69, v64, v196
    v_fmac_f32 v68, v65, v193
    v_fmac_f32 v69, v65, v192
    v_mul_f32 v70, v66, v194
    v_mul_f32 v71, v66, v197
    v_fmac_f32 v70, v67, v195
    v_fmac_f32 v71, v67, v194
    v_cvt_pk_f16_f32 v84, v64, v65
    v_cvt_pk_f16_f32 v85, v66, v67
    v_mul_f32 v64, v68, v192
    v_mul_f32 v65, v68, v196
    v_fmac_f32 v64, v69, v193
    v_fmac_f32 v65, v69, v192
    v_mul_f32 v66, v70, v194
    v_mul_f32 v67, v70, v197
    v_fmac_f32 v66, v71, v195
    v_fmac_f32 v67, v71, v194
    v_cvt_pk_f16_f32 v86, v68, v69
    v_cvt_pk_f16_f32 v87, v70, v71
    v_mul_f32 v68, v64, v192
    v_mul_f32 v69, v64, v196
    v_fmac_f32 v68, v65, v193
    v_fmac_f32 v69, v65, v192
    v_mul_f32 v70, v66, v194
    v_mul_f32 v71, v66, v197
    v_fmac_f32 v70, v67, v195
    v_fmac_f32 v71, v67, v194
    v_cvt_pk_f16_f32 v88, v64, v65
    v_cvt_pk_f16_f32 v89, v66, v67
    v_mul_f32 v64, v68, v192
    v_mul_f32 v65, v68, v196
    v_fmac_f32 v64, v69, v193
    v_fmac_f32 v65, v69, v192
    v_mul_f32 v66, v70, v194
    v_mul_f32 v67, v70, v197
    v_fmac_f32 v66, v71, v195
    v_fmac_f32 v67, v71, v194
    v_cvt_pk_f16_f32 v90, v68, v69
    v_cvt_pk_f16_f32 v91, v70, v71
    v_mul_f32 v68, v64, v192
    v_mul_f32 v69, v64, v196
    v_fmac_f32 v68, v65, v193
    v_fmac_f32 v69, v65, v192
    v_mul_f32 v70, v66, v194
    v_mul_f32 v71, v66, v197
    v_fmac_f32 v70, v67, v195
    v_fmac_f32 v71, v67, v194
    v_cvt_pk_f16_f32 v92, v64, v65
    v_cvt_pk_f16_f32 v93, v66, v67
    v_mul_f32 v64, v68, v192
    v_mul_f32 v65, v68, v196
    v_fmac_f32 v64, v69, v193
    v_fmac_f32 v65, v69, v192
    v_mul_f32 v66, v70, v194
    v_mul_f32 v67, v70, v197
    v_fmac_f32 v66, v71, v195
    v_fmac_f32 v67, v71, v194
    v_cvt_pk_f16_f32 v94, v68, v69
    v_cvt_pk_f16_f32 v95, v70, v71
    v_mul_f32 v68, v64, v192
    v_mul_f32 v69, v64, v196
    v_fmac_f32 v68, v65, v193
    v_fmac_f32 v69, v65, v192
    v_mul_f32 v70, v66, v194
    v_mul_f32 v71, v66, v197
    v_fmac_f32 v70, v67, v195
    v_fmac_f32 v71, v67, v194
    v_cvt_pk_f16_f32 v96, v64, v65
    v_cvt_pk_f16_f32 v97, v66, v67
    v_mul_f32 v64, v68, v192
    v_mul_f32 v65, v68, v196
    v_fmac_f32 v64, v69, v193
    v_fmac_f32 v65, v69, v192
    v_mul_f32 v66, v70, v194
    v_mul_f32 v67, v70, v197
    v_fmac_f32 v66, v71, v195
    v_fmac_f32 v67, v71, v194
    v_cvt_pk_f16_f32 v98, v68, v69
    v_cvt_pk_f16_f32 v99, v70, v71
    v_mul_f32 v68, v64, v192
    v_mul_f32 v69, v64, v196
    v_fmac_f32 v68, v65, v193
    v_fmac_f32 v69, v65, v192
    v_mul_f32 v70, v66, v194
    v_mul_f32 v71, v66, v197
    v_fmac_f32 v70, v67, v195
    v_fmac_f32 v71, v67, v194
    v_cvt_pk_f16_f32 v100, v64, v65
    v_cvt_pk_f16_f32 v101, v66, v67
    v_mul_f32 v64, v68, v192
    v_mul_f32 v65, v68, v196
    v_fmac_f32 v64, v69, v193
    v_fmac_f32 v65, v69, v192
    v_mul_f32 v66, v70, v194
    v_mul_f32 v67, v70, v197
    v_fmac_f32 v66, v71, v195
    v_fmac_f32 v67, v71, v194
    v_cvt_pk_f16_f32 v102, v68, v69
    s_barrier
    v_cvt_pk_f16_f32 v103, v70, v71
    v_mul_f32 v68, v64, v192
    v_mul_f32 v69, v64, v196
    v_fmac_f32 v68, v65, v193
    v_fmac_f32 v69, v65, v192
    v_mul_f32 v70, v66, v194
    v_mul_f32 v71, v66, v197
    v_fmac_f32 v70, v67, v195
    v_fmac_f32 v71, v67, v194
    v_cvt_pk_f16_f32 v104, v64, v65
    v_cvt_pk_f16_f32 v105, v66, v67
    v_cvt_pk_f16_f32 v106, v68, v69
    v_cvt_pk_f16_f32 v107, v70, v71
    v_mul_f32 v2, 0x3f800000, v52
    v_mul_f32 v3, 0x3f800000, v54
    v_exp_f32 v2, v2
    v_fract_f32 v3, v3
    v_cos_f32 v4, v3
    v_sin_f32 v5, v3
    s_nop 0
    v_mul_f32 v198, v2, v4
    v_mul_f32 v199, v2, v5
    v_sub_f32 v202, 0, v199
    v_mul_f32 v2, 0x3f800000, v53
    v_mul_f32 v3, 0x3f800000, v55
    v_exp_f32 v2, v2
    v_fract_f32 v3, v3
    v_cos_f32 v4, v3
    v_sin_f32 v5, v3
    s_nop 0
    v_mul_f32 v200, v2, v4
    v_mul_f32 v201, v2, v5
    v_sub_f32 v203, 0, v201
    v_mul_f32 v2, 0x43000000, v52
    v_mul_f32 v3, 0x43000000, v54
    v_exp_f32 v2, v2
    v_fract_f32 v3, v3
    v_cos_f32 v4, v3
    v_sin_f32 v5, v3
    s_nop 0
    v_mul_f32 v204, v2, v4
    v_mul_f32 v205, v2, v5
    v_sub_f32 v208, 0, v205
    v_mul_f32 v2, 0x43000000, v53
    v_mul_f32 v3, 0x43000000, v55
    v_exp_f32 v2, v2
    v_fract_f32 v3, v3
    v_cos_f32 v4, v3
    v_sin_f32 v5, v3
    s_nop 0
    v_mul_f32 v206, v2, v4
    v_mul_f32 v207, v2, v5
    v_sub_f32 v209, 0, v207
    v_mul_f32 v2, 0x44800000, v52
    v_mul_f32 v3, 0x44800000, v54
    v_exp_f32 v2, v2
    v_fract_f32 v3, v3
    v_cos_f32 v4, v3
    v_sin_f32 v5, v3
    s_nop 0
    v_mul_f32 v210, v2, v4
    v_mul_f32 v211, v2, v5
    v_sub_f32 v214, 0, v211
    v_mul_f32 v2, 0x44800000, v53
    v_mul_f32 v3, 0x44800000, v55
    v_exp_f32 v2, v2
    v_fract_f32 v3, v3
    v_cos_f32 v4, v3
    v_sin_f32 v5, v3
    s_nop 0
    v_mul_f32 v212, v2, v4
    v_mul_f32 v213, v2, v5
    v_sub_f32 v215, 0, v213
    v_mul_f32 v216, 0x47000000, v198
    v_mul_f32 v217, 0x47000000, v199
    v_mul_f32 v218, 0x47000000, v200
    v_mul_f32 v219, 0x47000000, v201
    v_mul_f32 v220, v216, v198
    v_mul_f32 v221, v216, v199
    v_fmac_f32 v220, v217, v202
    v_fmac_f32 v221, v217, v198
    v_mul_f32 v222, v218, v200
    v_mul_f32 v223, v218, v201
    v_fmac_f32 v222, v219, v203
    v_fmac_f32 v223, v219, v200
    v_mul_f32 v224, v220, v198
    v_mul_f32 v225, v220, v199
    v_fmac_f32 v224, v221, v202
    v_fmac_f32 v225, v221, v198
    v_mul_f32 v226, v222, v200
    v_mul_f32 v227, v222, v201
    v_fmac_f32 v226, v223, v203
    v_fmac_f32 v227, v223, v200
    v_mul_f32 v228, v224, v198
    v_mul_f32 v229, v224, v199
    v_fmac_f32 v228, v225, v202
    v_fmac_f32 v229, v225, v198
    v_mul_f32 v230, v226, v200
    v_mul_f32 v231, v226, v201
    v_fmac_f32 v230, v227, v203
    v_fmac_f32 v231, v227, v200
    v_mul_f32 v234, v228, v198
    v_mul_f32 v235, v228, v199
    v_fmac_f32 v234, v229, v202
    v_fmac_f32 v235, v229, v198
    v_mul_f32 v236, v230, v200
    v_mul_f32 v237, v230, v201
    v_fmac_f32 v236, v231, v203
    v_fmac_f32 v237, v231, v200
    v_mul_f32 v238, v234, v198
    v_mul_f32 v239, v234, v199
    v_fmac_f32 v238, v235, v202
    v_fmac_f32 v239, v235, v198
    v_mul_f32 v240, v236, v200
    v_mul_f32 v241, v236, v201
    v_fmac_f32 v240, v237, v203
    v_fmac_f32 v241, v237, v200
    v_mul_f32 v242, v238, v198
    v_mul_f32 v243, v238, v199
    v_fmac_f32 v242, v239, v202
    v_fmac_f32 v243, v239, v198
    v_mul_f32 v244, v240, v200
    v_mul_f32 v245, v240, v201
    v_fmac_f32 v244, v241, v203
    v_fmac_f32 v245, v241, v200
    v_mov_b32 v108, 0x7800
    v_mov_b32 v109, 0x7800
    v_cvt_pk_f16_f32 v110, v216, v217
    v_cvt_pk_f16_f32 v111, v218, v219
    v_cvt_pk_f16_f32 v112, v220, v221
    v_cvt_pk_f16_f32 v113, v222, v223
    v_cvt_pk_f16_f32 v114, v224, v225
    v_cvt_pk_f16_f32 v115, v226, v227
    v_cvt_pk_f16_f32 v116, v228, v229
    v_cvt_pk_f16_f32 v117, v230, v231
    v_cvt_pk_f16_f32 v118, v234, v235
    v_cvt_pk_f16_f32 v119, v236, v237
    v_cvt_pk_f16_f32 v120, v238, v239
    v_cvt_pk_f16_f32 v121, v240, v241
    v_cvt_pk_f16_f32 v122, v242, v243
    v_cvt_pk_f16_f32 v123, v244, v245
    v_mul_f32 v64, 0x47000000, v204
    v_mul_f32 v65, 0x47000000, v205
    v_mul_f32 v66, 0x47000000, v206
    v_mul_f32 v67, 0x47000000, v207
    v_cvt_pk_f16_f32 v124, v64, v65
    v_cvt_pk_f16_f32 v125, v66, v67
    v_mul_f32 v64, v216, v204
    v_mul_f32 v65, v216, v205
    v_fmac_f32 v64, v217, v208
    v_fmac_f32 v65, v217, v204
    v_mul_f32 v66, v218, v206
    v_mul_f32 v67, v218, v207
    v_fmac_f32 v66, v219, v209
    v_fmac_f32 v67, v219, v206
    v_cvt_pk_f16_f32 v126, v64, v65
    v_cvt_pk_f16_f32 v127, v66, v67
    v_mul_f32 v64, v220, v204
    v_mul_f32 v65, v220, v205
    v_fmac_f32 v64, v221, v208
    v_fmac_f32 v65, v221, v204
    v_mul_f32 v66, v222, v206
    v_mul_f32 v67, v222, v207
    v_fmac_f32 v66, v223, v209
    v_fmac_f32 v67, v223, v206
    v_cvt_pk_f16_f32 v128, v64, v65
    v_cvt_pk_f16_f32 v129, v66, v67
    v_mul_f32 v64, v224, v204
    v_mul_f32 v65, v224, v205
    v_fmac_f32 v64, v225, v208
    v_fmac_f32 v65, v225, v204
    v_mul_f32 v66, v226, v206
    v_mul_f32 v67, v226, v207
    v_fmac_f32 v66, v227, v209
    v_fmac_f32 v67, v227, v206
    v_cvt_pk_f16_f32 v130, v64, v65
    v_cvt_pk_f16_f32 v131, v66, v67
    v_mul_f32 v64, v228, v204
    v_mul_f32 v65, v228, v205
    v_fmac_f32 v64, v229, v208
    v_fmac_f32 v65, v229, v204
    v_mul_f32 v66, v230, v206
    v_mul_f32 v67, v230, v207
    v_fmac_f32 v66, v231, v209
    v_fmac_f32 v67, v231, v206
    v_cvt_pk_f16_f32 v132, v64, v65
    v_cvt_pk_f16_f32 v133, v66, v67
    v_mul_f32 v64, v234, v204
    v_mul_f32 v65, v234, v205
    v_fmac_f32 v64, v235, v208
    v_fmac_f32 v65, v235, v204
    v_mul_f32 v66, v236, v206
    v_mul_f32 v67, v236, v207
    v_fmac_f32 v66, v237, v209
    v_fmac_f32 v67, v237, v206
    v_cvt_pk_f16_f32 v134, v64, v65
    v_cvt_pk_f16_f32 v135, v66, v67
    v_mul_f32 v64, v238, v204
    v_mul_f32 v65, v238, v205
    v_fmac_f32 v64, v239, v208
    v_fmac_f32 v65, v239, v204
    v_mul_f32 v66, v240, v206
    v_mul_f32 v67, v240, v207
    v_fmac_f32 v66, v241, v209
    v_fmac_f32 v67, v241, v206
    v_cvt_pk_f16_f32 v136, v64, v65
    v_cvt_pk_f16_f32 v137, v66, v67
    v_mul_f32 v64, v242, v204
    v_mul_f32 v65, v242, v205
    v_fmac_f32 v64, v243, v208
    v_fmac_f32 v65, v243, v204
    v_mul_f32 v66, v244, v206
    v_mul_f32 v67, v244, v207
    v_fmac_f32 v66, v245, v209
    v_fmac_f32 v67, v245, v206
    v_cvt_pk_f16_f32 v138, v64, v65
    v_cvt_pk_f16_f32 v139, v66, v67
    v_mul_f32 v198, v204, v204
    v_mul_f32 v199, v204, v205
    v_fmac_f32 v198, v205, v208
    v_fmac_f32 v199, v205, v204
    v_mul_f32 v200, v206, v206
    v_mul_f32 v201, v206, v207
    v_fmac_f32 v200, v207, v209
    v_fmac_f32 v201, v207, v206
    v_mul_f32 v56, v198, v204
    v_mul_f32 v57, v198, v205
    v_fmac_f32 v56, v199, v208
    v_fmac_f32 v57, v199, v204
    v_mul_f32 v58, v200, v206
    v_mul_f32 v59, v200, v207
    v_fmac_f32 v58, v201, v209
    v_fmac_f32 v59, v201, v206
    v_mul_f32 v216, v56, v204
    v_mul_f32 v217, v56, v205
    v_fmac_f32 v216, v57, v208
    v_fmac_f32 v217, v57, v204
    v_mul_f32 v218, v58, v206
    v_mul_f32 v219, v58, v207
    v_fmac_f32 v218, v59, v209
    v_fmac_f32 v219, v59, v206
    v_mul_f32 v224, v216, v204
    v_mul_f32 v225, v216, v205
    v_fmac_f32 v224, v217, v208
    v_fmac_f32 v225, v217, v204
    v_mul_f32 v226, v218, v206
    v_mul_f32 v227, v218, v207
    v_fmac_f32 v226, v219, v209
    v_fmac_f32 v227, v219, v206
    v_mul_f32 v234, v224, v204
    v_mul_f32 v235, v224, v205
    v_fmac_f32 v234, v225, v208
    v_fmac_f32 v235, v225, v204
    v_mul_f32 v236, v226, v206
    v_mul_f32 v237, v226, v207
    v_fmac_f32 v236, v227, v209
    v_fmac_f32 v237, v227, v206
    v_mul_f32 v242, v234, v204
    v_mul_f32 v243, v234, v205
    v_fmac_f32 v242, v235, v208
    v_fmac_f32 v243, v235, v204
    v_mul_f32 v244, v236, v206
    v_mul_f32 v245, v236, v207
    v_fmac_f32 v244, v237, v209
    v_fmac_f32 v245, v237, v206
    v_sub_f32 v232, 0, v229
    v_sub_f32 v233, 0, v231
    v_sub_f32 v202, 0, v199
    v_sub_f32 v203, 0, v201
    v_sub_f32 v60, 0, v57
    v_sub_f32 v61, 0, v59
    v_mul_f32 v64, 0x47000000, v198
    v_mul_f32 v65, 0x47000000, v199
    v_mul_f32 v66, 0x47000000, v200
    v_mul_f32 v67, 0x47000000, v201
    v_cvt_pk_f16_f32 v140, v64, v65
    v_cvt_pk_f16_f32 v141, v66, v67
    v_mul_f32 v64, v220, v198
    v_mul_f32 v65, v220, v199
    v_fmac_f32 v64, v221, v202
    v_fmac_f32 v65, v221, v198
    v_mul_f32 v66, v222, v200
    v_mul_f32 v67, v222, v201
    v_fmac_f32 v66, v223, v203
    v_fmac_f32 v67, v223, v200
    v_cvt_pk_f16_f32 v142, v64, v65
    v_cvt_pk_f16_f32 v143, v66, v67
    v_mul_f32 v64, v228, v198
    v_mul_f32 v65, v228, v199
    v_fmac_f32 v64, v229, v202
    v_fmac_f32 v65, v229, v198
    v_mul_f32 v66, v230, v200
    v_mul_f32 v67, v230, v201
    v_fmac_f32 v66, v231, v203
    v_fmac_f32 v67, v231, v200
    v_cvt_pk_f16_f32 v144, v64, v65
    v_cvt_pk_f16_f32 v145, v66, v67
    v_mul_f32 v64, v238, v198
    v_mul_f32 v65, v238, v199
    v_fmac_f32 v64, v239, v202
    v_fmac_f32 v65, v239, v198
    v_mul_f32 v66, v240, v200
    v_mul_f32 v67, v240, v201
    v_fmac_f32 v66, v241, v203
    v_fmac_f32 v67, v241, v200
    v_cvt_pk_f16_f32 v146, v64, v65
    v_cvt_pk_f16_f32 v147, v66, v67
    v_mul_f32 v64, 0x47000000, v56
    v_mul_f32 v65, 0x47000000, v57
    v_mul_f32 v66, 0x47000000, v58
    v_mul_f32 v67, 0x47000000, v59
    v_cvt_pk_f16_f32 v148, v64, v65
    v_cvt_pk_f16_f32 v149, v66, v67
    v_mul_f32 v64, v220, v56
    v_mul_f32 v65, v220, v57
    v_fmac_f32 v64, v221, v60
    v_fmac_f32 v65, v221, v56
    v_mul_f32 v66, v222, v58
    v_mul_f32 v67, v222, v59
    v_fmac_f32 v66, v223, v61
    v_fmac_f32 v67, v223, v58
    v_cvt_pk_f16_f32 v150, v64, v65
    v_cvt_pk_f16_f32 v151, v66, v67
    v_mul_f32 v64, v228, v56
    v_mul_f32 v65, v228, v57
    v_fmac_f32 v64, v229, v60
    v_fmac_f32 v65, v229, v56
    v_mul_f32 v66, v230, v58
    v_mul_f32 v67, v230, v59
    v_fmac_f32 v66, v231, v61
    v_fmac_f32 v67, v231, v58
    v_cvt_pk_f16_f32 v152, v64, v65
    v_cvt_pk_f16_f32 v153, v66, v67
    v_mul_f32 v64, v238, v56
    v_mul_f32 v65, v238, v57
    v_fmac_f32 v64, v239, v60
    v_fmac_f32 v65, v239, v56
    v_mul_f32 v66, v240, v58
    v_mul_f32 v67, v240, v59
    v_fmac_f32 v66, v241, v61
    v_fmac_f32 v67, v241, v58
    v_cvt_pk_f16_f32 v154, v64, v65
    v_cvt_pk_f16_f32 v155, v66, v67
    v_mul_f32 v64, 0x47000000, v216
    v_mul_f32 v65, 0x47000000, v217
    v_mul_f32 v66, 0x47000000, v218
    v_mul_f32 v67, 0x47000000, v219
    v_cvt_pk_f16_f32 v156, v64, v65
    v_cvt_pk_f16_f32 v157, v66, v67
    v_mul_f32 v64, v216, v228
    v_mul_f32 v65, v216, v229
    v_fmac_f32 v64, v217, v232
    v_fmac_f32 v65, v217, v228
    v_mul_f32 v66, v218, v230
    v_mul_f32 v67, v218, v231
    v_fmac_f32 v66, v219, v233
    v_fmac_f32 v67, v219, v230
    v_cvt_pk_f16_f32 v158, v64, v65
    v_cvt_pk_f16_f32 v159, v66, v67
    v_mul_f32 v64, 0x47000000, v224
    v_mul_f32 v65, 0x47000000, v225
    v_mul_f32 v66, 0x47000000, v226
    v_mul_f32 v67, 0x47000000, v227
    v_cvt_pk_f16_f32 v160, v64, v65
    v_cvt_pk_f16_f32 v161, v66, v67
    v_mul_f32 v64, v224, v228
    v_mul_f32 v65, v224, v229
    v_fmac_f32 v64, v225, v232
    v_fmac_f32 v65, v225, v228
    v_mul_f32 v66, v226, v230
    v_mul_f32 v67, v226, v231
    v_fmac_f32 v66, v227, v233
    v_fmac_f32 v67, v227, v230
    v_cvt_pk_f16_f32 v162, v64, v65
    v_cvt_pk_f16_f32 v163, v66, v67
    v_mul_f32 v64, 0x47000000, v234
    v_mul_f32 v65, 0x47000000, v235
    v_mul_f32 v66, 0x47000000, v236
    v_mul_f32 v67, 0x47000000, v237
    v_cvt_pk_f16_f32 v164, v64, v65
    v_cvt_pk_f16_f32 v165, v66, v67
    v_mul_f32 v64, v234, v228
    v_mul_f32 v65, v234, v229
    v_fmac_f32 v64, v235, v232
    v_fmac_f32 v65, v235, v228
    v_mul_f32 v66, v236, v230
    v_mul_f32 v67, v236, v231
    v_fmac_f32 v66, v237, v233
    v_fmac_f32 v67, v237, v230
    v_cvt_pk_f16_f32 v166, v64, v65
    v_cvt_pk_f16_f32 v167, v66, v67
    v_mul_f32 v64, 0x47000000, v242
    v_mul_f32 v65, 0x47000000, v243
    v_mul_f32 v66, 0x47000000, v244
    v_mul_f32 v67, 0x47000000, v245
    v_cvt_pk_f16_f32 v168, v64, v65
    v_cvt_pk_f16_f32 v169, v66, v67
    v_mul_f32 v64, v242, v228
    v_mul_f32 v65, v242, v229
    v_fmac_f32 v64, v243, v232
    v_fmac_f32 v65, v243, v228
    v_mul_f32 v66, v244, v230
    v_mul_f32 v67, v244, v231
    v_fmac_f32 v66, v245, v233
    v_fmac_f32 v67, v245, v230
    v_cvt_pk_f16_f32 v170, v64, v65
    v_cvt_pk_f16_f32 v171, v66, v67
    v_mov_b32 v6, 0
    global_load_dword v7, v6, s[34:35] sc1
    v_mul_f32 v192, 0x47000000, v210
    v_mul_f32 v193, 0x47000000, v211
    v_mul_f32 v194, 0x47000000, v212
    v_mul_f32 v195, 0x47000000, v213
    v_sub_f32 v196, 0, v193
    v_sub_f32 v197, 0, v195
    v_cvt_pk_f16_f32 v172, v192, v193
    v_cvt_pk_f16_f32 v173, v194, v195
    v_mul_f32 v64, v204, v192
    v_mul_f32 v65, v204, v193
    v_fmac_f32 v64, v205, v196
    v_fmac_f32 v65, v205, v192
    v_mul_f32 v66, v206, v194
    v_mul_f32 v67, v206, v195
    v_fmac_f32 v66, v207, v197
    v_fmac_f32 v67, v207, v194
    v_cvt_pk_f16_f32 v174, v64, v65
    v_cvt_pk_f16_f32 v175, v66, v67
    v_mul_f32 v64, v198, v192
    v_mul_f32 v65, v198, v193
    v_fmac_f32 v64, v199, v196
    v_fmac_f32 v65, v199, v192
    v_mul_f32 v66, v200, v194
    v_mul_f32 v67, v200, v195
    v_fmac_f32 v66, v201, v197
    v_fmac_f32 v67, v201, v194
    v_cvt_pk_f16_f32 v176, v64, v65
    v_cvt_pk_f16_f32 v177, v66, v67
    v_mul_f32 v64, v56, v192
    v_mul_f32 v65, v56, v193
    v_fmac_f32 v64, v57, v196
    v_fmac_f32 v65, v57, v192
    v_mul_f32 v66, v58, v194
    v_mul_f32 v67, v58, v195
    v_fmac_f32 v66, v59, v197
    v_fmac_f32 v67, v59, v194
    v_cvt_pk_f16_f32 v178, v64, v65
    v_cvt_pk_f16_f32 v179, v66, v67
    v_mul_f32 v64, v216, v192
    v_mul_f32 v65, v216, v193
    v_fmac_f32 v64, v217, v196
    v_fmac_f32 v65, v217, v192
    v_mul_f32 v66, v218, v194
    v_mul_f32 v67, v218, v195
    v_fmac_f32 v66, v219, v197
    v_fmac_f32 v67, v219, v194
    v_cvt_pk_f16_f32 v180, v64, v65
    v_cvt_pk_f16_f32 v181, v66, v67
    v_mul_f32 v64, v224, v192
    v_mul_f32 v65, v224, v193
    v_fmac_f32 v64, v225, v196
    v_fmac_f32 v65, v225, v192
    v_mul_f32 v66, v226, v194
    v_mul_f32 v67, v226, v195
    v_fmac_f32 v66, v227, v197
    v_fmac_f32 v67, v227, v194
    v_cvt_pk_f16_f32 v182, v64, v65
    v_cvt_pk_f16_f32 v183, v66, v67
    v_mul_f32 v64, v234, v192
    v_mul_f32 v65, v234, v193
    v_fmac_f32 v64, v235, v196
    v_fmac_f32 v65, v235, v192
    v_mul_f32 v66, v236, v194
    v_mul_f32 v67, v236, v195
    v_fmac_f32 v66, v237, v197
    v_fmac_f32 v67, v237, v194
    v_cvt_pk_f16_f32 v184, v64, v65
    v_cvt_pk_f16_f32 v185, v66, v67
    v_mul_f32 v64, v242, v192
    v_mul_f32 v65, v242, v193
    v_fmac_f32 v64, v243, v196
    v_fmac_f32 v65, v243, v192
    v_mul_f32 v66, v244, v194
    v_mul_f32 v67, v244, v195
    v_fmac_f32 v66, v245, v197
    v_fmac_f32 v67, v245, v194
    v_cvt_pk_f16_f32 v186, v64, v65
    v_cvt_pk_f16_f32 v187, v66, v67
    v_mul_f32 v64, v210, v192
    v_mul_f32 v65, v210, v193
    v_fmac_f32 v64, v211, v196
    v_fmac_f32 v65, v211, v192
    v_mul_f32 v66, v212, v194
    v_mul_f32 v67, v212, v195
    v_fmac_f32 v66, v213, v197
    v_fmac_f32 v67, v213, v194
    v_cvt_pk_f16_f32 v188, v64, v65
    v_cvt_pk_f16_f32 v189, v66, v67
    v_mul_f32 v28, v72, v28
    v_mul_f32 v29, v72, v29
    v_mul_f32 v30, v72, v30
    v_mul_f32 v31, v72, v31
    v_mul_f32 v32, v72, v32
    v_mul_f32 v33, v72, v33
    v_mul_f32 v34, v72, v34
    v_mul_f32 v35, v72, v35
    v_mul_f32 v36, v72, v36
    v_mul_f32 v37, v72, v37
    v_mul_f32 v38, v72, v38
    v_mul_f32 v39, v72, v39
    v_exp_f32 v28, v28
    v_exp_f32 v29, v29
    v_exp_f32 v30, v30
    v_exp_f32 v31, v31
    v_exp_f32 v32, v32
    v_exp_f32 v33, v33
    v_exp_f32 v34, v34
    v_exp_f32 v35, v35
    v_exp_f32 v36, v36
    v_exp_f32 v37, v37
    v_exp_f32 v38, v38
    v_exp_f32 v39, v39
    s_waitcnt vmcnt(0)
    s_mov_b32 s77, 0x100000
    s_branch NKS_CHK
    NKS_SPIN:
    s_sleep 8
    global_load_dword v7, v6, s[34:35] sc1
    s_waitcnt vmcnt(0)
    s_sub_u32 s77, s77, 1
    s_cmp_eq_u32 s77, 0
    s_cbranch_scc1 NKS_OK
    NKS_CHK:
    v_cmp_ne_u32 vcc, 0, v7
    s_nop 3
    s_cmp_eq_u64 vcc, exec
    s_cbranch_scc0 NKS_SPIN
    NKS_OK:
    v_readfirstlane_b32 s23, v7
    s_nop 3
    v_mov_b32 v4, 142080
    ds_write_b32 v4, v7
    ds_write_b64 v14, v[76:77] offset:0
    ds_write_b64 v15, v[78:79] offset:0
    ds_write_b64 v16, v[80:81] offset:0
    ds_write_b64 v17, v[82:83] offset:0
    ds_write_b64 v18, v[84:85] offset:0
    ds_write_b64 v19, v[86:87] offset:0
    ds_write_b64 v20, v[88:89] offset:0
    ds_write_b64 v21, v[90:91] offset:0
    ds_write_b64 v14, v[92:93] offset:128
    ds_write_b64 v15, v[94:95] offset:128
    ds_write_b64 v16, v[96:97] offset:128
    ds_write_b64 v17, v[98:99] offset:128
    ds_write_b64 v18, v[100:101] offset:128
    ds_write_b64 v19, v[102:103] offset:128
    ds_write_b64 v20, v[104:105] offset:128
    ds_write_b64 v21, v[106:107] offset:128
    ds_read_b128 v[192:195], v22 offset:0
    ds_read_b128 v[196:199], v23 offset:0
    ds_read_b128 v[200:203], v22 offset:2048
    ds_read_b128 v[204:207], v23 offset:2048
    ds_read_b128 v[208:211], v22 offset:4096
    ds_read_b128 v[212:215], v23 offset:4096
    ds_read_b128 v[216:219], v22 offset:6144
    ds_read_b128 v[220:223], v23 offset:6144
    ds_write_b64 v14, v[108:109] offset:0
    ds_write_b64 v15, v[110:111] offset:0
    ds_write_b64 v16, v[112:113] offset:0
    ds_write_b64 v17, v[114:115] offset:0
    ds_write_b64 v18, v[116:117] offset:0
    ds_write_b64 v19, v[118:119] offset:0
    ds_write_b64 v20, v[120:121] offset:0
    ds_write_b64 v21, v[122:123] offset:0
    ds_write_b64 v14, v[124:125] offset:128
    ds_write_b64 v15, v[126:127] offset:128
    ds_write_b64 v16, v[128:129] offset:128
    ds_write_b64 v17, v[130:131] offset:128
    ds_write_b64 v18, v[132:133] offset:128
    ds_write_b64 v19, v[134:135] offset:128
    ds_write_b64 v20, v[136:137] offset:128
    ds_write_b64 v21, v[138:139] offset:128
    ds_read_b128 v[76:79], v22 offset:0
    ds_read_b128 v[80:83], v23 offset:0
    ds_read_b128 v[84:87], v22 offset:2048
    ds_read_b128 v[88:91], v23 offset:2048
    ds_read_b128 v[92:95], v22 offset:4096
    ds_read_b128 v[96:99], v23 offset:4096
    ds_read_b128 v[100:103], v22 offset:6144
    ds_read_b128 v[104:107], v23 offset:6144
    ds_write_b64 v14, v[140:141] offset:0
    ds_write_b64 v15, v[142:143] offset:0
    ds_write_b64 v16, v[144:145] offset:0
    ds_write_b64 v17, v[146:147] offset:0
    ds_write_b64 v18, v[148:149] offset:0
    ds_write_b64 v19, v[150:151] offset:0
    ds_write_b64 v20, v[152:153] offset:0
    ds_write_b64 v21, v[154:155] offset:0
    ds_write_b64 v14, v[156:157] offset:128
    ds_write_b64 v15, v[158:159] offset:128
    ds_write_b64 v16, v[160:161] offset:128
    ds_write_b64 v17, v[162:163] offset:128
    ds_write_b64 v18, v[164:165] offset:128
    ds_write_b64 v19, v[166:167] offset:128
    ds_write_b64 v20, v[168:169] offset:128
    ds_write_b64 v21, v[170:171] offset:128
    ds_read_b128 v[108:111], v22 offset:0
    ds_read_b128 v[112:115], v23 offset:0
    ds_read_b128 v[116:119], v22 offset:2048
    ds_read_b128 v[120:123], v23 offset:2048
    ds_read_b128 v[124:127], v22 offset:4096
    ds_read_b128 v[128:131], v23 offset:4096
    ds_read_b128 v[132:135], v22 offset:6144
    ds_read_b128 v[136:139], v23 offset:6144
    s_waitcnt lgkmcnt(14)
    ds_write_b64 v14, v[172:173] offset:0
    ds_write_b64 v15, v[174:175] offset:0
    v_mfma_f32_16x16x32_f16 v[224:227], v[76:79], v[192:195], 0
    ds_write_b64 v16, v[176:177] offset:0
    ds_write_b64 v17, v[178:179] offset:0
    v_mfma_f32_16x16x32_f16 v[224:227], v[80:83], v[196:199], v[224:227]
    ds_write_b64 v18, v[180:181] offset:0
    ds_write_b64 v19, v[182:183] offset:0
    v_mfma_f32_16x16x32_f16 v[224:227], v[84:87], v[200:203], v[224:227]
    ds_write_b64 v20, v[184:185] offset:0
    ds_write_b64 v21, v[186:187] offset:0
    v_mfma_f32_16x16x32_f16 v[224:227], v[88:91], v[204:207], v[224:227]
    ds_write_b64 v14, v[188:189] offset:128
    ds_read_b128 v[140:143], v22 offset:0
    v_mfma_f32_16x16x32_f16 v[224:227], v[92:95], v[208:211], v[224:227]
    ds_read_b128 v[144:147], v23 offset:0
    ds_read_b128 v[148:151], v22 offset:2048
    v_mfma_f32_16x16x32_f16 v[224:227], v[96:99], v[212:215], v[224:227]
    ds_read_b128 v[152:155], v23 offset:2048
    ds_read_b128 v[156:159], v22 offset:4096
    v_mfma_f32_16x16x32_f16 v[224:227], v[100:103], v[216:219], v[224:227]
    ds_read_b128 v[160:163], v23 offset:4096
    ds_read_b128 v[164:167], v22 offset:6144
    v_mfma_f32_16x16x32_f16 v[224:227], v[104:107], v[220:223], v[224:227]
    ds_read_b128 v[168:171], v23 offset:6144
    s_waitcnt lgkmcnt(14)
    v_mfma_f32_16x16x32_f16 v[228:231], v[108:111], v[192:195], 0
    v_mfma_f32_16x16x32_f16 v[228:231], v[112:115], v[196:199], v[228:231]
    v_mfma_f32_16x16x32_f16 v[228:231], v[116:119], v[200:203], v[228:231]
    v_mfma_f32_16x16x32_f16 v[228:231], v[120:123], v[204:207], v[228:231]
    v_mfma_f32_16x16x32_f16 v[228:231], v[124:127], v[208:211], v[228:231]
    v_mfma_f32_16x16x32_f16 v[228:231], v[128:131], v[212:215], v[228:231]
    v_mfma_f32_16x16x32_f16 v[228:231], v[132:135], v[216:219], v[228:231]
    v_mfma_f32_16x16x32_f16 v[228:231], v[136:139], v[220:223], v[228:231]
    s_waitcnt lgkmcnt(0)
    v_mfma_f32_16x16x32_f16 v[232:235], v[140:143], v[192:195], 0
    v_mfma_f32_16x16x32_f16 v[232:235], v[144:147], v[196:199], v[232:235]
    v_mfma_f32_16x16x32_f16 v[232:235], v[148:151], v[200:203], v[232:235]
    v_mfma_f32_16x16x32_f16 v[232:235], v[152:155], v[204:207], v[232:235]
    v_mfma_f32_16x16x32_f16 v[232:235], v[156:159], v[208:211], v[232:235]
    v_mfma_f32_16x16x32_f16 v[232:235], v[160:163], v[212:215], v[232:235]
    v_mfma_f32_16x16x32_f16 v[232:235], v[164:167], v[216:219], v[232:235]
    v_mfma_f32_16x16x32_f16 v[232:235], v[168:171], v[220:223], v[232:235]
    s_nop 3
    v_mul_f32 v224, v224, v28
    v_mul_f32 v225, v225, v29
    v_mul_f32 v226, v226, v30
    v_mul_f32 v227, v227, v31
    v_mul_f32 v228, v228, v32
    v_mul_f32 v229, v229, v33
    v_mul_f32 v230, v230, v34
    v_mul_f32 v231, v231, v35
    v_mul_f32 v232, v232, v36
    v_mul_f32 v233, v233, v37
    v_mul_f32 v234, v234, v38
    v_mul_f32 v235, v235, v39
    v_ldexp_f32 v224, v224, v74
    v_ldexp_f32 v225, v225, v74
    v_ldexp_f32 v226, v226, v74
    v_ldexp_f32 v227, v227, v74
    v_ldexp_f32 v228, v228, v74
    v_ldexp_f32 v229, v229, v74
    v_ldexp_f32 v230, v230, v74
    v_ldexp_f32 v231, v231, v74
    v_ldexp_f32 v232, v232, v74
    v_ldexp_f32 v233, v233, v74
    v_ldexp_f32 v234, v234, v74
    v_ldexp_f32 v235, v235, v74
    v_add_f32 v224, v224, v13
    ds_write_b128 v24, v[224:227]
    ds_write_b64 v25, v[228:229]
    ds_write_b64 v26, v[230:231]
    ds_write_b32 v27, v232 offset:2048
    ds_write_b32 v27, v233 offset:2112
    ds_write_b32 v27, v234 offset:2176
    ds_write_b32 v27, v235 offset:2240
    ds_read_b32 v76, v40
    ds_read_b32 v77, v41
    ds_read_b32 v78, v42
    ds_read_b32 v79, v43
    ds_read_b32 v80, v44
    ds_read_b32 v81, v45
    ds_read_b32 v82, v46
    ds_read_b32 v83, v47
    ds_read_b64 v[84:85], v48 offset:1536
    ds_read_b32 v86, v48 offset:1544
    ds_read2_b32 v[88:89], v49 offset0:0 offset1:1
    ds_read2_b32 v[90:91], v49 offset0:64 offset1:65
    v_lshlrev_b32 v2, 4, v0
    v_add_u32 v2, s70, v2
    v_and_b32 v3, 3, v0
    v_lshlrev_b32 v3, 4, v3
    v_add_u32 v3, s70, v3
    v_mov_b32 v124, 0
    v_mov_b32 v125, 0
    v_mov_b32 v126, 0
    v_mov_b32 v127, 0
    s_mov_b32 s72, 0xaaaaaaaa
    s_mov_b32 s73, 0xaaaaaaaa
    ds_write_b128 v3, v[124:127] offset:3584
    s_waitcnt lgkmcnt(0)
    v_cvt_pk_bf16_f32 v108, v76, v77
    v_cvt_pk_bf16_f32 v109, v78, v79
    v_cvt_pk_bf16_f32 v110, v80, v81
    v_cvt_pk_bf16_f32 v111, v82, v83
    v_cvt_pk_bf16_f32 v112, v84, v84
    v_cvt_pk_bf16_f32 v113, v84, v85
    v_cvt_pk_bf16_f32 v114, v85, v85
    v_cvt_pk_bf16_f32 v115, v86, v86
    v_cndmask_b32 v4, v88, v89, s[72:73]
    v_cvt_pk_bf16_f32 v116, v88, v88
    v_cvt_pk_bf16_f32 v117, v88, v88
    v_cvt_pk_bf16_f32 v118, v4, v89
    v_cvt_pk_bf16_f32 v119, v89, v89
    v_cndmask_b32 v4, v90, v91, s[72:73]
    v_cvt_pk_bf16_f32 v120, v90, v90
    v_cvt_pk_bf16_f32 v121, v90, v90
    v_cvt_pk_bf16_f32 v122, v4, v91
    v_cvt_pk_bf16_f32 v123, v91, v91
    v_mov_b32 v4, 0
    ds_write_b128 v2, v[108:111] offset:3648
    ds_write_b128 v2, v[112:115] offset:4672
    ds_write_b128 v2, v[116:119] offset:5696
    ds_write_b128 v2, v[120:123] offset:6720
    s_waitcnt vmcnt(0) lgkmcnt(0)
    s_mov_b32 s6, s68
    s_branch L_CONVB
L_CONVA:
    s_lshl_b32 s8, s6, 13
    s_add_u32 s8, s8, 151072
    s_mul_i32 s9, s6, 5376
    s_add_u32 s9, s9, 131088
    v_lshrrev_b32 v6, 2, v0
    v_and_b32 v10, 7, v6
    v_and_b32 v6, 3, v6
    v_and_b32 v7, 3, v0
    v_lshrrev_b32 v8, 4, v0
    v_and_b32 v8, 1, v8
    v_lshrrev_b32 v9, 5, v0
    v_mul_u32_u24 v3, 1344, v7
    v_sub_u32 v10, v10, v9
    v_lshl_add_u32 v3, v10, 4, v3
    v_add_u32 v3, s9, v3
    v_lshlrev_b32 v2, 5, v8
    v_lshl_add_u32 v2, v7, 3, v2
    v_lshl_add_u32 v2, v9, 6, v2
    v_lshlrev_b32 v10, 3, v6
    v_sub_u32 v2, v2, v10
    v_add_u32 v2, s8, v2
    v_and_b32 v4, 7, v0
    v_lshrrev_b32 v5, 3, v0
    v_lshlrev_b32 v5, 4, v5
    v_lshl_add_u32 v5, v4, 7, v5
    v_mov_b32 v6, 0
    v_mov_b32 v7, s23
    s_mov_b32 s12, 0
    s_mov_b32 s13, 0x80000000
    s_mov_b32 s14, 0
    s_mov_b32 s15, 0xc0000000
    s_mov_b32 s16, 0
    s_mov_b32 s17, 0xe0000000
    s_lshl_b32 s7, s2, 1
    s_add_u32 s7, s7, s6
    s_mul_i32 s18, s7, 4224
    s_add_u32 s18, s18, 11010048
    s_lshl_b32 s19, s2, 4
    s_add_u32 s19, s19, s6
    s_lshl_b32 s19, s19, 3
    s_add_u32 s19, s19, 16121856
    s_setprio 3
    s_lshl_b32 s52, s6, 2
    s_add_u32 s52, s52, 142096
    v_mov_b32 v4, s52
    s_barrier
    ds_read_b32 v4, v4
CVA_GO:
    ds_read_b128 v[8:11], v3 offset:0
    ds_read_b64_tr_b16 v[36:37], v2 offset:416
    ds_read_b64_tr_b16 v[38:39], v2 offset:384
    ds_read_b64_tr_b16 v[52:53], v2 offset:928
    ds_read_b64_tr_b16 v[54:55], v2 offset:896
    ds_read_b64_tr_b16 v[68:69], v2 offset:1440
    ds_read_b64_tr_b16 v[70:71], v2 offset:1408
    ds_read_b64_tr_b16 v[84:85], v2 offset:1952
    ds_read_b64_tr_b16 v[86:87], v2 offset:1920
    ds_read_b64_tr_b16 v[100:101], v2 offset:2464
    ds_read_b64_tr_b16 v[102:103], v2 offset:2432
    ds_read_b64_tr_b16 v[116:117], v2 offset:2976
    ds_read_b64_tr_b16 v[118:119], v2 offset:2944
    s_waitcnt lgkmcnt(13)
    v_readfirstlane_b32 s52, v4
    s_nop 3
    s_cmp_eq_u32 s52, 0
    s_cbranch_scc1 CVA_SLOW
    ds_read_b128 v[12:15], v3 offset:32
    ds_read_b64_tr_b16 v[32:33], v2 offset:288
    ds_read_b64_tr_b16 v[34:35], v2 offset:256
    ds_read_b64_tr_b16 v[48:49], v2 offset:800
    ds_read_b64_tr_b16 v[50:51], v2 offset:768
    ds_read_b64_tr_b16 v[64:65], v2 offset:1312
    ds_read_b64_tr_b16 v[66:67], v2 offset:1280
    ds_read_b64_tr_b16 v[80:81], v2 offset:1824
    ds_read_b64_tr_b16 v[82:83], v2 offset:1792
    ds_read_b64_tr_b16 v[96:97], v2 offset:2336
    ds_read_b64_tr_b16 v[98:99], v2 offset:2304
    ds_read_b64_tr_b16 v[112:113], v2 offset:2848
    ds_read_b64_tr_b16 v[114:115], v2 offset:2816
    s_waitcnt lgkmcnt(13)
    v_mfma_f32_32x32x16_bf16 v[120:135], v[8:11], v[36:39], 0
    ds_read_b128 v[16:19], v3 offset:64
    ds_read_b64_tr_b16 v[28:29], v2 offset:160
    ds_read_b64_tr_b16 v[30:31], v2 offset:128
    v_mfma_f32_32x32x16_bf16 v[136:151], v[8:11], v[52:55], 0
    ds_read_b64_tr_b16 v[44:45], v2 offset:672
    ds_read_b64_tr_b16 v[46:47], v2 offset:640
    ds_read_b64_tr_b16 v[60:61], v2 offset:1184
    v_mfma_f32_32x32x16_bf16 v[152:167], v[8:11], v[68:71], 0
    ds_read_b64_tr_b16 v[62:63], v2 offset:1152
    ds_read_b64_tr_b16 v[76:77], v2 offset:1696
    ds_read_b64_tr_b16 v[78:79], v2 offset:1664
    v_mfma_f32_32x32x16_bf16 v[168:183], v[8:11], v[84:87], 0
    ds_read_b64_tr_b16 v[92:93], v2 offset:2208
    ds_read_b64_tr_b16 v[94:95], v2 offset:2176
    ds_read_b64_tr_b16 v[108:109], v2 offset:2720
    v_mfma_f32_32x32x16_bf16 v[184:199], v[8:11], v[100:103], 0
    ds_read_b64_tr_b16 v[110:111], v2 offset:2688
    v_mfma_f32_32x32x16_bf16 v[200:215], v[8:11], v[116:119], 0
    s_waitcnt lgkmcnt(13)
    v_mfma_f32_32x32x16_bf16 v[120:135], v[12:15], v[32:35], v[120:135]
    ds_read_b128 v[20:23], v3 offset:96
    ds_read_b64_tr_b16 v[24:25], v2 offset:32
    ds_read_b64_tr_b16 v[26:27], v2 offset:0
    v_mfma_f32_32x32x16_bf16 v[136:151], v[12:15], v[48:51], v[136:151]
    ds_read_b64_tr_b16 v[40:41], v2 offset:544
    ds_read_b64_tr_b16 v[42:43], v2 offset:512
    ds_read_b64_tr_b16 v[56:57], v2 offset:1056
    v_mfma_f32_32x32x16_bf16 v[152:167], v[12:15], v[64:67], v[152:167]
    ds_read_b64_tr_b16 v[58:59], v2 offset:1024
    ds_read_b64_tr_b16 v[72:73], v2 offset:1568
    ds_read_b64_tr_b16 v[74:75], v2 offset:1536
    v_mfma_f32_32x32x16_bf16 v[168:183], v[12:15], v[80:83], v[168:183]
    ds_read_b64_tr_b16 v[88:89], v2 offset:2080
    ds_read_b64_tr_b16 v[90:91], v2 offset:2048
    ds_read_b64_tr_b16 v[104:105], v2 offset:2592
    v_mfma_f32_32x32x16_bf16 v[184:199], v[12:15], v[96:99], v[184:199]
    ds_read_b64_tr_b16 v[106:107], v2 offset:2560
    v_mfma_f32_32x32x16_bf16 v[200:215], v[12:15], v[112:115], v[200:215]
    s_waitcnt lgkmcnt(13)
    v_mfma_f32_32x32x16_bf16 v[120:135], v[16:19], v[28:31], v[120:135]
    ds_read_b128 v[8:11], v3 offset:128
    v_mfma_f32_32x32x16_bf16 v[136:151], v[16:19], v[44:47], v[136:151]
    v_mfma_f32_32x32x16_bf16 v[152:167], v[16:19], v[60:63], v[152:167]
    ds_read_b128 v[12:15], v3 offset:160
    v_mfma_f32_32x32x16_bf16 v[168:183], v[16:19], v[76:79], v[168:183]
    v_mfma_f32_32x32x16_bf16 v[184:199], v[16:19], v[92:95], v[184:199]
    v_mfma_f32_32x32x16_bf16 v[200:215], v[16:19], v[108:111], v[200:215]
    s_waitcnt lgkmcnt(2)
    v_mfma_f32_32x32x16_bf16 v[120:135], v[20:23], v[24:27], v[120:135]
    ds_read_b128 v[16:19], v3 offset:192
    v_mfma_f32_32x32x16_bf16 v[136:151], v[20:23], v[40:43], v[136:151]
    v_mfma_f32_32x32x16_bf16 v[152:167], v[20:23], v[56:59], v[152:167]
    v_mfma_f32_32x32x16_bf16 v[168:183], v[20:23], v[72:75], v[168:183]
    v_mfma_f32_32x32x16_bf16 v[184:199], v[20:23], v[88:91], v[184:199]
    v_mfma_f32_32x32x16_bf16 v[200:215], v[20:23], v[104:107], v[200:215]
    s_waitcnt lgkmcnt(2)
    v_mfma_f32_32x32x16_bf16 v[136:151], v[8:11], v[36:39], v[136:151]
    ds_read_b128 v[20:23], v3 offset:224
    v_mfma_f32_32x32x16_bf16 v[152:167], v[8:11], v[52:55], v[152:167]
    v_mfma_f32_32x32x16_bf16 v[168:183], v[8:11], v[68:71], v[168:183]
    v_mfma_f32_32x32x16_bf16 v[184:199], v[8:11], v[84:87], v[184:199]
    v_mfma_f32_32x32x16_bf16 v[200:215], v[8:11], v[100:103], v[200:215]
    s_waitcnt lgkmcnt(2)
    v_mfma_f32_32x32x16_bf16 v[136:151], v[12:15], v[32:35], v[136:151]
    ds_read_b128 v[8:11], v3 offset:256
    v_mfma_f32_32x32x16_bf16 v[152:167], v[12:15], v[48:51], v[152:167]
    v_cndmask_b32 v216, v133, v129, s[12:13]
    v_cndmask_b32 v217, v134, v130, s[14:15]
    v_cndmask_b32 v218, v135, v131, s[16:17]
    v_cndmask_b32 v129, v129, v125, s[12:13]
    v_mfma_f32_32x32x16_bf16 v[168:183], v[12:15], v[64:67], v[168:183]
    v_cndmask_b32 v130, v130, v126, s[14:15]
    v_cndmask_b32 v131, v131, v127, s[16:17]
    v_cndmask_b32 v125, v125, v121, s[12:13]
    v_cndmask_b32 v126, v126, v122, s[14:15]
    v_mfma_f32_32x32x16_bf16 v[184:199], v[12:15], v[80:83], v[184:199]
    v_cndmask_b32 v127, v127, v123, s[16:17]
    v_cndmask_b32 v121, v121, v6, s[12:13]
    v_cndmask_b32 v122, v122, v6, s[14:15]
    v_cndmask_b32 v123, v123, v6, s[16:17]
    v_mfma_f32_32x32x16_bf16 v[200:215], v[12:15], v[96:99], v[200:215]
    v_add_f32_dpp v217, v218, v217 wave_ror:1 row_mask:0xf bank_mask:0xf
    v_add_f32_dpp v130, v131, v130 wave_ror:1 row_mask:0xf bank_mask:0xf
    v_add_f32_dpp v126, v127, v126 wave_ror:1 row_mask:0xf bank_mask:0xf
    v_add_f32_dpp v122, v123, v122 wave_ror:1 row_mask:0xf bank_mask:0xf
    s_waitcnt lgkmcnt(2)
    v_mfma_f32_32x32x16_bf16 v[136:151], v[16:19], v[28:31], v[136:151]
    ds_read_b128 v[12:15], v3 offset:288
    v_add_f32_dpp v216, v217, v216 wave_ror:1 row_mask:0xf bank_mask:0xf
    v_add_f32_dpp v129, v130, v129 wave_ror:1 row_mask:0xf bank_mask:0xf
    v_add_f32_dpp v125, v126, v125 wave_ror:1 row_mask:0xf bank_mask:0xf
    v_add_f32_dpp v121, v122, v121 wave_ror:1 row_mask:0xf bank_mask:0xf
    v_mfma_f32_32x32x16_bf16 v[152:167], v[16:19], v[44:47], v[152:167]
    v_add_f32_dpp v132, v216, v132 wave_ror:1 row_mask:0xf bank_mask:0xf
    v_add_f32_dpp v128, v129, v128 wave_ror:1 row_mask:0xf bank_mask:0xf
    v_add_f32_dpp v124, v125, v124 wave_ror:1 row_mask:0xf bank_mask:0xf
    v_add_f32_dpp v120, v121, v120 wave_ror:1 row_mask:0xf bank_mask:0xf
    v_mfma_f32_32x32x16_bf16 v[168:183], v[16:19], v[60:63], v[168:183]
    v_mfma_f32_32x32x16_bf16 v[184:199], v[16:19], v[76:79], v[184:199]
    v_mfma_f32_32x32x16_bf16 v[200:215], v[16:19], v[92:95], v[200:215]
    s_waitcnt lgkmcnt(2)
    v_mfma_f32_32x32x16_bf16 v[136:151], v[20:23], v[24:27], v[136:151]
    ds_read_b128 v[16:19], v3 offset:320
    v_mfma_f32_32x32x16_bf16 v[152:167], v[20:23], v[40:43], v[152:167]
    v_mfma_f32_32x32x16_bf16 v[168:183], v[20:23], v[56:59], v[168:183]
    v_mfma_f32_32x32x16_bf16 v[184:199], v[20:23], v[72:75], v[184:199]
    v_mfma_f32_32x32x16_bf16 v[200:215], v[20:23], v[88:91], v[200:215]
    s_waitcnt lgkmcnt(2)
    v_mfma_f32_32x32x16_bf16 v[152:167], v[8:11], v[36:39], v[152:167]
    ds_read_b128 v[20:23], v3 offset:352
    v_mfma_f32_32x32x16_bf16 v[168:183], v[8:11], v[52:55], v[168:183]
    v_mfma_f32_32x32x16_bf16 v[184:199], v[8:11], v[68:71], v[184:199]
    v_mfma_f32_32x32x16_bf16 v[200:215], v[8:11], v[84:87], v[200:215]
    s_waitcnt lgkmcnt(2)
    v_mfma_f32_32x32x16_bf16 v[152:167], v[12:15], v[32:35], v[152:167]
    ds_read_b128 v[8:11], v3 offset:384
    v_mfma_f32_32x32x16_bf16 v[168:183], v[12:15], v[48:51], v[168:183]
    v_mfma_f32_32x32x16_bf16 v[184:199], v[12:15], v[64:67], v[184:199]
    v_mfma_f32_32x32x16_bf16 v[200:215], v[12:15], v[80:83], v[200:215]
    v_cndmask_b32 v219, v149, v145, s[12:13]
    v_cndmask_b32 v220, v150, v146, s[14:15]
    v_cndmask_b32 v221, v151, v147, s[16:17]
    v_cndmask_b32 v145, v145, v141, s[12:13]
    s_waitcnt lgkmcnt(2)
    v_mfma_f32_32x32x16_bf16 v[152:167], v[16:19], v[28:31], v[152:167]
    ds_read_b128 v[12:15], v3 offset:416
    v_cndmask_b32 v146, v146, v142, s[14:15]
    v_cndmask_b32 v147, v147, v143, s[16:17]
    v_cndmask_b32 v141, v141, v137, s[12:13]
    v_cndmask_b32 v142, v142, v138, s[14:15]
    v_mfma_f32_32x32x16_bf16 v[168:183], v[16:19], v[44:47], v[168:183]
    v_cndmask_b32 v143, v143, v139, s[16:17]
    v_cndmask_b32 v137, v137, v133, s[12:13]
    v_cndmask_b32 v138, v138, v134, s[14:15]
    v_cndmask_b32 v139, v139, v135, s[16:17]
    v_mfma_f32_32x32x16_bf16 v[184:199], v[16:19], v[60:63], v[184:199]
    v_add_f32_dpp v220, v221, v220 wave_ror:1 row_mask:0xf bank_mask:0xf
    v_add_f32_dpp v146, v147, v146 wave_ror:1 row_mask:0xf bank_mask:0xf
    v_add_f32_dpp v142, v143, v142 wave_ror:1 row_mask:0xf bank_mask:0xf
    v_add_f32_dpp v138, v139, v138 wave_ror:1 row_mask:0xf bank_mask:0xf
    v_mfma_f32_32x32x16_bf16 v[200:215], v[16:19], v[76:79], v[200:215]
    v_add_f32_dpp v219, v220, v219 wave_ror:1 row_mask:0xf bank_mask:0xf
    v_add_f32_dpp v145, v146, v145 wave_ror:1 row_mask:0xf bank_mask:0xf
    v_add_f32_dpp v141, v142, v141 wave_ror:1 row_mask:0xf bank_mask:0xf
    v_add_f32_dpp v137, v138, v137 wave_ror:1 row_mask:0xf bank_mask:0xf
    s_waitcnt lgkmcnt(2)
    v_mfma_f32_32x32x16_bf16 v[152:167], v[20:23], v[24:27], v[152:167]
    ds_read_b128 v[16:19], v3 offset:448
    v_add_f32_dpp v148, v219, v148 wave_ror:1 row_mask:0xf bank_mask:0xf
    v_add_f32_dpp v144, v145, v144 wave_ror:1 row_mask:0xf bank_mask:0xf
    v_add_f32_dpp v140, v141, v140 wave_ror:1 row_mask:0xf bank_mask:0xf
    v_add_f32_dpp v136, v137, v136 wave_ror:1 row_mask:0xf bank_mask:0xf
    v_mfma_f32_32x32x16_bf16 v[168:183], v[20:23], v[40:43], v[168:183]
    s_mov_b32 vcc_lo, 0xaaaaaaaa
    s_mov_b32 vcc_hi, 0xaaaaaaaa
    v_cndmask_b32_dpp v122, v120, v124, vcc quad_perm:[1,0,3,2] row_mask:0xf bank_mask:0xf
    v_cndmask_b32_dpp v125, v128, v132, vcc quad_perm:[1,0,3,2] row_mask:0xf bank_mask:0xf
    v_mfma_f32_32x32x16_bf16 v[184:199], v[20:23], v[56:59], v[184:199]
    v_cndmask_b32_dpp v127, v136, v140, vcc quad_perm:[1,0,3,2] row_mask:0xf bank_mask:0xf
    v_cndmask_b32_dpp v130, v144, v148, vcc quad_perm:[1,0,3,2] row_mask:0xf bank_mask:0xf
    s_not_b64 vcc, vcc
    v_cndmask_b32_dpp v121, v124, v120, vcc quad_perm:[1,0,3,2] row_mask:0xf bank_mask:0xf
    v_mfma_f32_32x32x16_bf16 v[200:215], v[20:23], v[72:75], v[200:215]
    v_cndmask_b32_dpp v123, v132, v128, vcc quad_perm:[1,0,3,2] row_mask:0xf bank_mask:0xf
    v_cndmask_b32_dpp v126, v140, v136, vcc quad_perm:[1,0,3,2] row_mask:0xf bank_mask:0xf
    v_cndmask_b32_dpp v129, v148, v144, vcc quad_perm:[1,0,3,2] row_mask:0xf bank_mask:0xf
    v_cvt_pk_bf16_f32 v131, v121, v122
    s_waitcnt lgkmcnt(2)
    v_mfma_f32_32x32x16_bf16 v[168:183], v[8:11], v[36:39], v[168:183]
    ds_read_b128 v[20:23], v3 offset:480
    v_cvt_pk_bf16_f32 v137, v123, v125
    v_cvt_pk_bf16_f32 v138, v126, v127
    v_cvt_pk_bf16_f32 v139, v129, v130
    s_mov_b32 vcc_lo, 0xcccccccc
    v_mfma_f32_32x32x16_bf16 v[184:199], v[8:11], v[52:55], v[184:199]
    s_mov_b32 vcc_hi, 0xcccccccc
    v_cndmask_b32_dpp v142, v131, v137, vcc quad_perm:[2,3,0,1] row_mask:0xf bank_mask:0xf
    v_cndmask_b32_dpp v145, v138, v139, vcc quad_perm:[2,3,0,1] row_mask:0xf bank_mask:0xf
    s_not_b64 vcc, vcc
    v_mfma_f32_32x32x16_bf16 v[200:215], v[8:11], v[68:71], v[200:215]
    v_cndmask_b32_dpp v141, v137, v131, vcc quad_perm:[2,3,0,1] row_mask:0xf bank_mask:0xf
    v_cndmask_b32_dpp v143, v139, v138, vcc quad_perm:[2,3,0,1] row_mask:0xf bank_mask:0xf
    s_mov_b32 vcc_lo, 0xf0f0f0f0
    s_mov_b32 vcc_hi, 0xf0f0f0f0
    s_waitcnt lgkmcnt(2)
    v_mfma_f32_32x32x16_bf16 v[168:183], v[12:15], v[32:35], v[168:183]
    ds_read_b128 v[8:11], v3 offset:512
    v_cndmask_b32_dpp v122, v141, v143, vcc row_ror:12 row_mask:0xf bank_mask:0xf
    v_cndmask_b32_dpp v123, v142, v145, vcc row_ror:12 row_mask:0xf bank_mask:0xf
    s_not_b64 vcc, vcc
    v_cndmask_b32_dpp v120, v143, v141, vcc row_ror:4 row_mask:0xf bank_mask:0xf
    v_mfma_f32_32x32x16_bf16 v[184:199], v[12:15], v[48:51], v[184:199]
    v_cndmask_b32_dpp v121, v145, v142, vcc row_ror:4 row_mask:0xf bank_mask:0xf
    buffer_store_dwordx4 v[120:123], v5, s[56:59], s18 offen offset:0 sc1
    v_cndmask_b32 v222, v165, v161, s[12:13]
    v_cndmask_b32 v223, v166, v162, s[14:15]
    v_mfma_f32_32x32x16_bf16 v[200:215], v[12:15], v[64:67], v[200:215]
    v_cndmask_b32 v224, v167, v163, s[16:17]
    v_cndmask_b32 v161, v161, v157, s[12:13]
    v_cndmask_b32 v162, v162, v158, s[14:15]
    v_cndmask_b32 v163, v163, v159, s[16:17]
    s_waitcnt lgkmcnt(2)
    v_mfma_f32_32x32x16_bf16 v[168:183], v[16:19], v[28:31], v[168:183]
    ds_read_b128 v[12:15], v3 offset:544
    v_cndmask_b32 v157, v157, v153, s[12:13]
    v_cndmask_b32 v158, v158, v154, s[14:15]
    v_cndmask_b32 v159, v159, v155, s[16:17]
    v_cndmask_b32 v153, v153, v149, s[12:13]
    v_mfma_f32_32x32x16_bf16 v[184:199], v[16:19], v[44:47], v[184:199]
    v_cndmask_b32 v154, v154, v150, s[14:15]
    v_cndmask_b32 v155, v155, v151, s[16:17]
    v_add_f32_dpp v223, v224, v223 wave_ror:1 row_mask:0xf bank_mask:0xf
    v_add_f32_dpp v162, v163, v162 wave_ror:1 row_mask:0xf bank_mask:0xf
    v_mfma_f32_32x32x16_bf16 v[200:215], v[16:19], v[60:63], v[200:215]
    v_add_f32_dpp v158, v159, v158 wave_ror:1 row_mask:0xf bank_mask:0xf
    v_add_f32_dpp v154, v155, v154 wave_ror:1 row_mask:0xf bank_mask:0xf
    v_add_f32_dpp v222, v223, v222 wave_ror:1 row_mask:0xf bank_mask:0xf
    v_add_f32_dpp v161, v162, v161 wave_ror:1 row_mask:0xf bank_mask:0xf
    s_waitcnt lgkmcnt(2)
    v_mfma_f32_32x32x16_bf16 v[168:183], v[20:23], v[24:27], v[168:183]
    ds_read_b128 v[16:19], v3 offset:576
    v_add_f32_dpp v157, v158, v157 wave_ror:1 row_mask:0xf bank_mask:0xf
    v_add_f32_dpp v153, v154, v153 wave_ror:1 row_mask:0xf bank_mask:0xf
    v_add_f32_dpp v164, v222, v164 wave_ror:1 row_mask:0xf bank_mask:0xf
    v_add_f32_dpp v160, v161, v160 wave_ror:1 row_mask:0xf bank_mask:0xf
    v_mfma_f32_32x32x16_bf16 v[184:199], v[20:23], v[40:43], v[184:199]
    v_add_f32_dpp v156, v157, v156 wave_ror:1 row_mask:0xf bank_mask:0xf
    v_add_f32_dpp v152, v153, v152 wave_ror:1 row_mask:0xf bank_mask:0xf
    v_mfma_f32_32x32x16_bf16 v[200:215], v[20:23], v[56:59], v[200:215]
    s_waitcnt lgkmcnt(2)
    v_mfma_f32_32x32x16_bf16 v[184:199], v[8:11], v[36:39], v[184:199]
    ds_read_b128 v[20:23], v3 offset:608
    v_mfma_f32_32x32x16_bf16 v[200:215], v[8:11], v[52:55], v[200:215]
    s_waitcnt lgkmcnt(2)
    v_mfma_f32_32x32x16_bf16 v[184:199], v[12:15], v[32:35], v[184:199]
    ds_read_b128 v[8:11], v3 offset:640
    v_mfma_f32_32x32x16_bf16 v[200:215], v[12:15], v[48:51], v[200:215]
    v_cndmask_b32 v225, v181, v177, s[12:13]
    v_cndmask_b32 v226, v182, v178, s[14:15]
    v_cndmask_b32 v227, v183, v179, s[16:17]
    v_cndmask_b32 v177, v177, v173, s[12:13]
    s_waitcnt lgkmcnt(2)
    v_mfma_f32_32x32x16_bf16 v[184:199], v[16:19], v[28:31], v[184:199]
    ds_read_b128 v[12:15], v3 offset:672
    v_cndmask_b32 v178, v178, v174, s[14:15]
    v_cndmask_b32 v179, v179, v175, s[16:17]
    v_cndmask_b32 v173, v173, v169, s[12:13]
    v_cndmask_b32 v174, v174, v170, s[14:15]
    v_mfma_f32_32x32x16_bf16 v[200:215], v[16:19], v[44:47], v[200:215]
    v_cndmask_b32 v175, v175, v171, s[16:17]
    v_cndmask_b32 v169, v169, v165, s[12:13]
    v_cndmask_b32 v170, v170, v166, s[14:15]
    v_cndmask_b32 v171, v171, v167, s[16:17]
    s_waitcnt lgkmcnt(2)
    v_mfma_f32_32x32x16_bf16 v[184:199], v[20:23], v[24:27], v[184:199]
    ds_read_b128 v[16:19], v3 offset:704
    v_add_f32_dpp v226, v227, v226 wave_ror:1 row_mask:0xf bank_mask:0xf
    v_add_f32_dpp v178, v179, v178 wave_ror:1 row_mask:0xf bank_mask:0xf
    v_add_f32_dpp v174, v175, v174 wave_ror:1 row_mask:0xf bank_mask:0xf
    v_add_f32_dpp v170, v171, v170 wave_ror:1 row_mask:0xf bank_mask:0xf
    v_mfma_f32_32x32x16_bf16 v[200:215], v[20:23], v[40:43], v[200:215]
    v_add_f32_dpp v225, v226, v225 wave_ror:1 row_mask:0xf bank_mask:0xf
    v_add_f32_dpp v177, v178, v177 wave_ror:1 row_mask:0xf bank_mask:0xf
    v_add_f32_dpp v173, v174, v173 wave_ror:1 row_mask:0xf bank_mask:0xf
    v_add_f32_dpp v169, v170, v169 wave_ror:1 row_mask:0xf bank_mask:0xf
    s_waitcnt lgkmcnt(2)
    v_mfma_f32_32x32x16_bf16 v[200:215], v[8:11], v[36:39], v[200:215]
    ds_read_b128 v[20:23], v3 offset:736
    v_add_f32_dpp v180, v225, v180 wave_ror:1 row_mask:0xf bank_mask:0xf
    v_add_f32_dpp v176, v177, v176 wave_ror:1 row_mask:0xf bank_mask:0xf
    v_add_f32_dpp v172, v173, v172 wave_ror:1 row_mask:0xf bank_mask:0xf
    v_add_f32_dpp v168, v169, v168 wave_ror:1 row_mask:0xf bank_mask:0xf
    s_waitcnt lgkmcnt(2)
    v_mfma_f32_32x32x16_bf16 v[200:215], v[12:15], v[32:35], v[200:215]
    s_mov_b32 vcc_lo, 0xaaaaaaaa
    s_mov_b32 vcc_hi, 0xaaaaaaaa
    v_cndmask_b32_dpp v154, v152, v156, vcc quad_perm:[1,0,3,2] row_mask:0xf bank_mask:0xf
    v_cndmask_b32_dpp v157, v160, v164, vcc quad_perm:[1,0,3,2] row_mask:0xf bank_mask:0xf
    s_waitcnt lgkmcnt(1)
    v_mfma_f32_32x32x16_bf16 v[200:215], v[16:19], v[28:31], v[200:215]
    v_cndmask_b32_dpp v159, v168, v172, vcc quad_perm:[1,0,3,2] row_mask:0xf bank_mask:0xf
    v_cndmask_b32_dpp v162, v176, v180, vcc quad_perm:[1,0,3,2] row_mask:0xf bank_mask:0xf
    s_not_b64 vcc, vcc
    v_cndmask_b32_dpp v153, v156, v152, vcc quad_perm:[1,0,3,2] row_mask:0xf bank_mask:0xf
    s_waitcnt lgkmcnt(0)
    v_mfma_f32_32x32x16_bf16 v[200:215], v[20:23], v[24:27], v[200:215]
    v_cndmask_b32_dpp v155, v164, v160, vcc quad_perm:[1,0,3,2] row_mask:0xf bank_mask:0xf
    v_cndmask_b32_dpp v158, v172, v168, vcc quad_perm:[1,0,3,2] row_mask:0xf bank_mask:0xf
    v_cndmask_b32_dpp v161, v180, v176, vcc quad_perm:[1,0,3,2] row_mask:0xf bank_mask:0xf
    v_cvt_pk_bf16_f32 v163, v153, v154
    v_cvt_pk_bf16_f32 v169, v155, v157
    v_cvt_pk_bf16_f32 v170, v158, v159
    v_cvt_pk_bf16_f32 v171, v161, v162
    s_mov_b32 vcc_lo, 0xcccccccc
    s_mov_b32 vcc_hi, 0xcccccccc
    v_cndmask_b32_dpp v174, v163, v169, vcc quad_perm:[2,3,0,1] row_mask:0xf bank_mask:0xf
    v_cndmask_b32_dpp v177, v170, v171, vcc quad_perm:[2,3,0,1] row_mask:0xf bank_mask:0xf
    s_not_b64 vcc, vcc
    v_cndmask_b32_dpp v173, v169, v163, vcc quad_perm:[2,3,0,1] row_mask:0xf bank_mask:0xf
    v_cndmask_b32_dpp v175, v171, v170, vcc quad_perm:[2,3,0,1] row_mask:0xf bank_mask:0xf
    s_mov_b32 vcc_lo, 0xf0f0f0f0
    s_mov_b32 vcc_hi, 0xf0f0f0f0
    v_cndmask_b32_dpp v154, v173, v175, vcc row_ror:12 row_mask:0xf bank_mask:0xf
    v_cndmask_b32_dpp v155, v174, v177, vcc row_ror:12 row_mask:0xf bank_mask:0xf
    s_not_b64 vcc, vcc
    v_cndmask_b32_dpp v152, v175, v173, vcc row_ror:4 row_mask:0xf bank_mask:0xf
    v_cndmask_b32_dpp v153, v177, v174, vcc row_ror:4 row_mask:0xf bank_mask:0xf
    buffer_store_dwordx4 v[152:155], v5, s[56:59], s18 offen offset:1024 sc1
    v_cndmask_b32 v228, v197, v193, s[12:13]
    v_cndmask_b32 v229, v198, v194, s[14:15]
    v_cndmask_b32 v230, v199, v195, s[16:17]
    v_cndmask_b32 v193, v193, v189, s[12:13]
    v_cndmask_b32 v194, v194, v190, s[14:15]
    v_cndmask_b32 v195, v195, v191, s[16:17]
    v_cndmask_b32 v189, v189, v185, s[12:13]
    v_cndmask_b32 v190, v190, v186, s[14:15]
    v_cndmask_b32 v191, v191, v187, s[16:17]
    v_cndmask_b32 v185, v185, v181, s[12:13]
    v_cndmask_b32 v186, v186, v182, s[14:15]
    v_cndmask_b32 v187, v187, v183, s[16:17]
    v_add_f32_dpp v229, v230, v229 wave_ror:1 row_mask:0xf bank_mask:0xf
    v_add_f32_dpp v194, v195, v194 wave_ror:1 row_mask:0xf bank_mask:0xf
    v_add_f32_dpp v190, v191, v190 wave_ror:1 row_mask:0xf bank_mask:0xf
    v_add_f32_dpp v186, v187, v186 wave_ror:1 row_mask:0xf bank_mask:0xf
    v_add_f32_dpp v228, v229, v228 wave_ror:1 row_mask:0xf bank_mask:0xf
    v_add_f32_dpp v193, v194, v193 wave_ror:1 row_mask:0xf bank_mask:0xf
    v_add_f32_dpp v189, v190, v189 wave_ror:1 row_mask:0xf bank_mask:0xf
    v_add_f32_dpp v185, v186, v185 wave_ror:1 row_mask:0xf bank_mask:0xf
    v_add_f32_dpp v196, v228, v196 wave_ror:1 row_mask:0xf bank_mask:0xf
    v_add_f32_dpp v192, v193, v192 wave_ror:1 row_mask:0xf bank_mask:0xf
    v_add_f32_dpp v188, v189, v188 wave_ror:1 row_mask:0xf bank_mask:0xf
    v_add_f32_dpp v184, v185, v184 wave_ror:1 row_mask:0xf bank_mask:0xf
    s_nop 7
    s_nop 3
    v_cndmask_b32 v231, v213, v209, s[12:13]
    v_cndmask_b32 v232, v214, v210, s[14:15]
    v_cndmask_b32 v233, v215, v211, s[16:17]
    v_cndmask_b32 v209, v209, v205, s[12:13]
    v_cndmask_b32 v210, v210, v206, s[14:15]
    v_cndmask_b32 v211, v211, v207, s[16:17]
    v_cndmask_b32 v205, v205, v201, s[12:13]
    v_cndmask_b32 v206, v206, v202, s[14:15]
    v_cndmask_b32 v207, v207, v203, s[16:17]
    v_cndmask_b32 v201, v201, v197, s[12:13]
    v_cndmask_b32 v202, v202, v198, s[14:15]
    v_cndmask_b32 v203, v203, v199, s[16:17]
    v_add_f32_dpp v232, v233, v232 wave_ror:1 row_mask:0xf bank_mask:0xf
    v_add_f32_dpp v210, v211, v210 wave_ror:1 row_mask:0xf bank_mask:0xf
    v_add_f32_dpp v206, v207, v206 wave_ror:1 row_mask:0xf bank_mask:0xf
    v_add_f32_dpp v202, v203, v202 wave_ror:1 row_mask:0xf bank_mask:0xf
    v_add_f32_dpp v231, v232, v231 wave_ror:1 row_mask:0xf bank_mask:0xf
    v_add_f32_dpp v209, v210, v209 wave_ror:1 row_mask:0xf bank_mask:0xf
    v_add_f32_dpp v205, v206, v205 wave_ror:1 row_mask:0xf bank_mask:0xf
    v_add_f32_dpp v201, v202, v201 wave_ror:1 row_mask:0xf bank_mask:0xf
    v_add_f32_dpp v212, v231, v212 wave_ror:1 row_mask:0xf bank_mask:0xf
    v_add_f32_dpp v208, v209, v208 wave_ror:1 row_mask:0xf bank_mask:0xf
    v_add_f32_dpp v204, v205, v204 wave_ror:1 row_mask:0xf bank_mask:0xf
    v_add_f32_dpp v200, v201, v200 wave_ror:1 row_mask:0xf bank_mask:0xf
    s_mov_b32 vcc_lo, 0xaaaaaaaa
    s_mov_b32 vcc_hi, 0xaaaaaaaa
    v_cndmask_b32_dpp v186, v184, v188, vcc quad_perm:[1,0,3,2] row_mask:0xf bank_mask:0xf
    v_cndmask_b32_dpp v189, v192, v196, vcc quad_perm:[1,0,3,2] row_mask:0xf bank_mask:0xf
    v_cndmask_b32_dpp v191, v200, v204, vcc quad_perm:[1,0,3,2] row_mask:0xf bank_mask:0xf
    v_cndmask_b32_dpp v194, v208, v212, vcc quad_perm:[1,0,3,2] row_mask:0xf bank_mask:0xf
    s_not_b64 vcc, vcc
    v_cndmask_b32_dpp v185, v188, v184, vcc quad_perm:[1,0,3,2] row_mask:0xf bank_mask:0xf
    v_cndmask_b32_dpp v187, v196, v192, vcc quad_perm:[1,0,3,2] row_mask:0xf bank_mask:0xf
    v_cndmask_b32_dpp v190, v204, v200, vcc quad_perm:[1,0,3,2] row_mask:0xf bank_mask:0xf
    v_cndmask_b32_dpp v193, v212, v208, vcc quad_perm:[1,0,3,2] row_mask:0xf bank_mask:0xf
    v_cvt_pk_bf16_f32 v195, v185, v186
    v_cvt_pk_bf16_f32 v201, v187, v189
    v_cvt_pk_bf16_f32 v202, v190, v191
    v_cvt_pk_bf16_f32 v203, v193, v194
    s_mov_b32 vcc_lo, 0xcccccccc
    s_mov_b32 vcc_hi, 0xcccccccc
    v_cndmask_b32_dpp v206, v195, v201, vcc quad_perm:[2,3,0,1] row_mask:0xf bank_mask:0xf
    v_cndmask_b32_dpp v209, v202, v203, vcc quad_perm:[2,3,0,1] row_mask:0xf bank_mask:0xf
    s_not_b64 vcc, vcc
    v_cndmask_b32_dpp v205, v201, v195, vcc quad_perm:[2,3,0,1] row_mask:0xf bank_mask:0xf
    v_cndmask_b32_dpp v207, v203, v202, vcc quad_perm:[2,3,0,1] row_mask:0xf bank_mask:0xf
    s_mov_b32 vcc_lo, 0xf0f0f0f0
    s_mov_b32 vcc_hi, 0xf0f0f0f0
    v_cndmask_b32_dpp v186, v205, v207, vcc row_ror:12 row_mask:0xf bank_mask:0xf
    v_cndmask_b32_dpp v187, v206, v209, vcc row_ror:12 row_mask:0xf bank_mask:0xf
    s_not_b64 vcc, vcc
    v_cndmask_b32_dpp v184, v207, v205, vcc row_ror:4 row_mask:0xf bank_mask:0xf
    v_cndmask_b32_dpp v185, v209, v206, vcc row_ror:4 row_mask:0xf bank_mask:0xf
    buffer_store_dwordx4 v[184:187], v5, s[56:59], s18 offen offset:2048 sc1
    s_waitcnt vmcnt(0)
    s_mov_b64 exec, 1
    buffer_store_dword v7, v6, s[56:59], s19 offen sc1
    s_mov_b64 exec, -1
    s_endpgm
CVA_SLOW:
    s_waitcnt lgkmcnt(0)
    s_mov_b32 s77, 0x100000
    s_lshr_b32 s16, s7, 7
    s_lshl_b32 s16, s16, 7
    s_lshr_b32 s17, s7, 3
    s_and_b32 s17, s17, 8
    s_add_u32 s16, s16, s17
    s_add_u32 s16, s16, 16154624
    v_and_b32 v216, 7, v0
    v_lshlrev_b32 v216, 9, v216
PUA_SPIN:
    s_sleep 8
    buffer_load_dwordx2 v[218:219], v216, s[56:59], s16 offen sc1
    s_waitcnt vmcnt(0)
    s_sub_u32 s77, s77, 1
    s_cmp_eq_u32 s77, 0
    s_cbranch_scc1 PUA_OK
PUA_CHK:
    v_cmp_eq_u32 vcc, s23, v218
    v_cmp_eq_u32 s[50:51], s23, v219
    s_nop 3
    s_and_b64 vcc, vcc, s[50:51]
    s_cmp_eq_u64 vcc, exec
    s_cbranch_scc0 PUA_SPIN
PUA_OK:
    v_lshlrev_b32 v216, 4, v0
    s_mul_i32 s52, s6, 5376
    s_mul_i32 s53, s7, 4224
    s_add_u32 s53, s53, 8388608
    s_add_u32 m0, s52, 131184
    s_nop 0
    buffer_load_dwordx4 v216, s[56:59], s53 offen sc1 lds
    s_add_u32 s53, s53, 1024
    s_add_u32 m0, s52, 132528
    s_nop 0
    buffer_load_dwordx4 v216, s[56:59], s53 offen sc1 lds
    s_add_u32 s53, s53, 1024
    s_add_u32 m0, s52, 133872
    s_nop 0
    buffer_load_dwordx4 v216, s[56:59], s53 offen sc1 lds
    s_add_u32 s53, s53, 1024
    s_add_u32 m0, s52, 135216
    s_nop 0
    buffer_load_dwordx4 v216, s[56:59], s53 offen sc1 lds
    s_add_u32 s53, s53, 1024
    s_mov_b32 s16, 0
    s_mov_b32 s17, 0xe0000000
    v_mov_b32 v4, 1
    s_waitcnt vmcnt(0)
    s_branch CVA_GO
L_CONVB:
    s_lshl_b32 s8, s6, 13
    s_add_u32 s8, s8, 151072
    s_mul_i32 s9, s6, 5376
    s_add_u32 s9, s9, 131088
    v_lshrrev_b32 v6, 2, v0
    v_and_b32 v10, 7, v6
    v_and_b32 v6, 3, v6
    v_and_b32 v7, 3, v0
    v_lshrrev_b32 v8, 4, v0
    v_and_b32 v8, 1, v8
    v_lshrrev_b32 v9, 5, v0
    v_mul_u32_u24 v3, 1344, v7
    v_sub_u32 v10, v10, v9
    v_lshl_add_u32 v3, v10, 4, v3
    v_add_u32 v3, s9, v3
    v_lshlrev_b32 v2, 5, v8
    v_lshl_add_u32 v2, v7, 3, v2
    v_lshl_add_u32 v2, v9, 6, v2
    v_lshlrev_b32 v10, 3, v6
    v_sub_u32 v2, v2, v10
    v_add_u32 v2, s8, v2
    v_and_b32 v4, 7, v0
    v_lshrrev_b32 v5, 3, v0
    v_lshlrev_b32 v5, 4, v5
    v_lshl_add_u32 v5, v4, 7, v5
    v_mov_b32 v6, 0
    v_mov_b32 v7, s23
    s_mov_b32 s12, 0
    s_mov_b32 s13, 0x80000000
    s_mov_b32 s14, 0
    s_mov_b32 s15, 0xc0000000
    s_mov_b32 s16, 0
    s_mov_b32 s17, 0xe0000000
    s_lshl_b32 s7, s2, 1
    s_add_u32 s7, s7, s6
    s_mul_i32 s18, s7, 4224
    s_add_u32 s18, s18, 11010048
    s_lshl_b32 s19, s2, 4
    s_add_u32 s19, s19, s6
    s_lshl_b32 s19, s19, 3
    s_add_u32 s19, s19, 16121860
    s_setprio 3
    s_lshl_b32 s52, s6, 2
    s_add_u32 s52, s52, 142096
    v_mov_b32 v4, s52
    s_barrier
    ds_read_b32 v4, v4
CVB_GO:
    ds_read_b128 v[8:11], v3 offset:0
    ds_read_b64_tr_b16 v[116:117], v2 offset:2976
    ds_read_b64_tr_b16 v[118:119], v2 offset:2944
    ds_read_b64_tr_b16 v[132:133], v2 offset:3488
    ds_read_b64_tr_b16 v[134:135], v2 offset:3456
    ds_read_b64_tr_b16 v[148:149], v2 offset:4000
    ds_read_b64_tr_b16 v[150:151], v2 offset:3968
    s_waitcnt lgkmcnt(7)
    v_readfirstlane_b32 s52, v4
    s_nop 3
    s_cmp_eq_u32 s52, 0
    s_cbranch_scc1 CVB_SLOW
    ds_read_b128 v[12:15], v3 offset:32
    ds_read_b64_tr_b16 v[112:113], v2 offset:2848
    ds_read_b64_tr_b16 v[114:115], v2 offset:2816
    ds_read_b64_tr_b16 v[128:129], v2 offset:3360
    ds_read_b64_tr_b16 v[130:131], v2 offset:3328
    ds_read_b64_tr_b16 v[144:145], v2 offset:3872
    ds_read_b64_tr_b16 v[146:147], v2 offset:3840
    s_waitcnt lgkmcnt(7)
    v_mfma_f32_32x32x16_bf16 v[152:167], v[8:11], v[116:119], 0
    ds_read_b128 v[16:19], v3 offset:64
    ds_read_b64_tr_b16 v[108:109], v2 offset:2720
    ds_read_b64_tr_b16 v[110:111], v2 offset:2688
    v_mfma_f32_32x32x16_bf16 v[168:183], v[8:11], v[132:135], 0
    ds_read_b64_tr_b16 v[124:125], v2 offset:3232
    ds_read_b64_tr_b16 v[126:127], v2 offset:3200
    ds_read_b64_tr_b16 v[140:141], v2 offset:3744
    v_mfma_f32_32x32x16_bf16 v[184:199], v[8:11], v[148:151], 0
    ds_read_b64_tr_b16 v[142:143], v2 offset:3712
    s_waitcnt lgkmcnt(7)
    v_mfma_f32_32x32x16_bf16 v[152:167], v[12:15], v[112:115], v[152:167]
    ds_read_b128 v[20:23], v3 offset:96
    ds_read_b64_tr_b16 v[104:105], v2 offset:2592
    ds_read_b64_tr_b16 v[106:107], v2 offset:2560
    v_mfma_f32_32x32x16_bf16 v[168:183], v[12:15], v[128:131], v[168:183]
    ds_read_b64_tr_b16 v[120:121], v2 offset:3104
    ds_read_b64_tr_b16 v[122:123], v2 offset:3072
    ds_read_b64_tr_b16 v[136:137], v2 offset:3616
    v_mfma_f32_32x32x16_bf16 v[184:199], v[12:15], v[144:147], v[184:199]
    ds_read_b64_tr_b16 v[138:139], v2 offset:3584
    s_waitcnt lgkmcnt(7)
    v_mfma_f32_32x32x16_bf16 v[152:167], v[16:19], v[108:111], v[152:167]
    ds_read_b128 v[8:11], v3 offset:128
    ds_read_b64_tr_b16 v[100:101], v2 offset:2464
    ds_read_b64_tr_b16 v[102:103], v2 offset:2432
    v_mfma_f32_32x32x16_bf16 v[168:183], v[16:19], v[124:127], v[168:183]
    ds_read_b128 v[12:15], v3 offset:160
    ds_read_b64_tr_b16 v[96:97], v2 offset:2336
    v_mfma_f32_32x32x16_bf16 v[184:199], v[16:19], v[140:143], v[184:199]
    ds_read_b64_tr_b16 v[98:99], v2 offset:2304
    s_waitcnt lgkmcnt(6)
    v_mfma_f32_32x32x16_bf16 v[152:167], v[20:23], v[104:107], v[152:167]
    ds_read_b128 v[16:19], v3 offset:192
    ds_read_b64_tr_b16 v[92:93], v2 offset:2208
    v_mfma_f32_32x32x16_bf16 v[168:183], v[20:23], v[120:123], v[168:183]
    ds_read_b64_tr_b16 v[94:95], v2 offset:2176
    v_mfma_f32_32x32x16_bf16 v[184:199], v[20:23], v[136:139], v[184:199]
    s_waitcnt lgkmcnt(6)
    v_mfma_f32_32x32x16_bf16 v[152:167], v[8:11], v[100:103], v[152:167]
    ds_read_b128 v[20:23], v3 offset:224
    ds_read_b64_tr_b16 v[88:89], v2 offset:2080
    v_mfma_f32_32x32x16_bf16 v[168:183], v[8:11], v[116:119], v[168:183]
    ds_read_b64_tr_b16 v[90:91], v2 offset:2048
    v_mfma_f32_32x32x16_bf16 v[184:199], v[8:11], v[132:135], v[184:199]
    s_waitcnt lgkmcnt(6)
    v_mfma_f32_32x32x16_bf16 v[152:167], v[12:15], v[96:99], v[152:167]
    ds_read_b128 v[8:11], v3 offset:256
    ds_read_b64_tr_b16 v[84:85], v2 offset:1952
    v_mfma_f32_32x32x16_bf16 v[168:183], v[12:15], v[112:115], v[168:183]
    ds_read_b64_tr_b16 v[86:87], v2 offset:1920
    v_mfma_f32_32x32x16_bf16 v[184:199], v[12:15], v[128:131], v[184:199]
    s_waitcnt lgkmcnt(6)
    v_mfma_f32_32x32x16_bf16 v[152:167], v[16:19], v[92:95], v[152:167]
    ds_read_b128 v[12:15], v3 offset:288
    ds_read_b64_tr_b16 v[80:81], v2 offset:1824
    v_mfma_f32_32x32x16_bf16 v[168:183], v[16:19], v[108:111], v[168:183]
    ds_read_b64_tr_b16 v[82:83], v2 offset:1792
    v_mfma_f32_32x32x16_bf16 v[184:199], v[16:19], v[124:127], v[184:199]
    s_waitcnt lgkmcnt(6)
    v_mfma_f32_32x32x16_bf16 v[152:167], v[20:23], v[88:91], v[152:167]
    ds_read_b128 v[16:19], v3 offset:320
    ds_read_b64_tr_b16 v[76:77], v2 offset:1696
    v_mfma_f32_32x32x16_bf16 v[168:183], v[20:23], v[104:107], v[168:183]
    ds_read_b64_tr_b16 v[78:79], v2 offset:1664
    v_mfma_f32_32x32x16_bf16 v[184:199], v[20:23], v[120:123], v[184:199]
    s_waitcnt lgkmcnt(6)
    v_mfma_f32_32x32x16_bf16 v[152:167], v[8:11], v[84:87], v[152:167]
    ds_read_b128 v[20:23], v3 offset:352
    ds_read_b64_tr_b16 v[72:73], v2 offset:1568
    v_mfma_f32_32x32x16_bf16 v[168:183], v[8:11], v[100:103], v[168:183]
    ds_read_b64_tr_b16 v[74:75], v2 offset:1536
    v_mfma_f32_32x32x16_bf16 v[184:199], v[8:11], v[116:119], v[184:199]
    s_waitcnt lgkmcnt(6)
    v_mfma_f32_32x32x16_bf16 v[152:167], v[12:15], v[80:83], v[152:167]
    ds_read_b128 v[8:11], v3 offset:384
    ds_read_b64_tr_b16 v[68:69], v2 offset:1440
    v_mfma_f32_32x32x16_bf16 v[168:183], v[12:15], v[96:99], v[168:183]
    ds_read_b64_tr_b16 v[70:71], v2 offset:1408
    v_mfma_f32_32x32x16_bf16 v[184:199], v[12:15], v[112:115], v[184:199]
    s_waitcnt lgkmcnt(6)
    v_mfma_f32_32x32x16_bf16 v[152:167], v[16:19], v[76:79], v[152:167]
    ds_read_b128 v[12:15], v3 offset:416
    ds_read_b64_tr_b16 v[64:65], v2 offset:1312
    v_mfma_f32_32x32x16_bf16 v[168:183], v[16:19], v[92:95], v[168:183]
    ds_read_b64_tr_b16 v[66:67], v2 offset:1280
    v_mfma_f32_32x32x16_bf16 v[184:199], v[16:19], v[108:111], v[184:199]
    s_waitcnt lgkmcnt(6)
    v_mfma_f32_32x32x16_bf16 v[152:167], v[20:23], v[72:75], v[152:167]
    ds_read_b128 v[16:19], v3 offset:448
    ds_read_b64_tr_b16 v[60:61], v2 offset:1184
    v_mfma_f32_32x32x16_bf16 v[168:183], v[20:23], v[88:91], v[168:183]
    ds_read_b64_tr_b16 v[62:63], v2 offset:1152
    v_mfma_f32_32x32x16_bf16 v[184:199], v[20:23], v[104:107], v[184:199]
    s_waitcnt lgkmcnt(6)
    v_mfma_f32_32x32x16_bf16 v[152:167], v[8:11], v[68:71], v[152:167]
    ds_read_b128 v[20:23], v3 offset:480
    ds_read_b64_tr_b16 v[56:57], v2 offset:1056
    v_mfma_f32_32x32x16_bf16 v[168:183], v[8:11], v[84:87], v[168:183]
    ds_read_b64_tr_b16 v[58:59], v2 offset:1024
    v_mfma_f32_32x32x16_bf16 v[184:199], v[8:11], v[100:103], v[184:199]
    s_waitcnt lgkmcnt(6)
    v_mfma_f32_32x32x16_bf16 v[152:167], v[12:15], v[64:67], v[152:167]
    ds_read_b128 v[8:11], v3 offset:512
    ds_read_b64_tr_b16 v[52:53], v2 offset:928
    v_mfma_f32_32x32x16_bf16 v[168:183], v[12:15], v[80:83], v[168:183]
    ds_read_b64_tr_b16 v[54:55], v2 offset:896
    v_mfma_f32_32x32x16_bf16 v[184:199], v[12:15], v[96:99], v[184:199]
    s_waitcnt lgkmcnt(6)
    v_mfma_f32_32x32x16_bf16 v[152:167], v[16:19], v[60:63], v[152:167]
    ds_read_b128 v[12:15], v3 offset:544
    ds_read_b64_tr_b16 v[48:49], v2 offset:800
    v_mfma_f32_32x32x16_bf16 v[168:183], v[16:19], v[76:79], v[168:183]
    ds_read_b64_tr_b16 v[50:51], v2 offset:768
    v_mfma_f32_32x32x16_bf16 v[184:199], v[16:19], v[92:95], v[184:199]
    s_waitcnt lgkmcnt(6)
    v_mfma_f32_32x32x16_bf16 v[152:167], v[20:23], v[56:59], v[152:167]
    ds_read_b128 v[16:19], v3 offset:576
    ds_read_b64_tr_b16 v[44:45], v2 offset:672
    v_mfma_f32_32x32x16_bf16 v[168:183], v[20:23], v[72:75], v[168:183]
    ds_read_b64_tr_b16 v[46:47], v2 offset:640
    v_mfma_f32_32x32x16_bf16 v[184:199], v[20:23], v[88:91], v[184:199]
    s_waitcnt lgkmcnt(6)
    v_mfma_f32_32x32x16_bf16 v[152:167], v[8:11], v[52:55], v[152:167]
    ds_read_b128 v[20:23], v3 offset:608
    ds_read_b64_tr_b16 v[40:41], v2 offset:544
    v_mfma_f32_32x32x16_bf16 v[168:183], v[8:11], v[68:71], v[168:183]
    ds_read_b64_tr_b16 v[42:43], v2 offset:512
    v_mfma_f32_32x32x16_bf16 v[184:199], v[8:11], v[84:87], v[184:199]
    s_waitcnt lgkmcnt(6)
    v_mfma_f32_32x32x16_bf16 v[152:167], v[12:15], v[48:51], v[152:167]
    ds_read_b128 v[8:11], v3 offset:640
    ds_read_b64_tr_b16 v[36:37], v2 offset:416
    v_mfma_f32_32x32x16_bf16 v[168:183], v[12:15], v[64:67], v[168:183]
    ds_read_b64_tr_b16 v[38:39], v2 offset:384
    v_mfma_f32_32x32x16_bf16 v[184:199], v[12:15], v[80:83], v[184:199]
    s_waitcnt lgkmcnt(6)
    v_mfma_f32_32x32x16_bf16 v[152:167], v[16:19], v[44:47], v[152:167]
    ds_read_b128 v[12:15], v3 offset:672
    ds_read_b64_tr_b16 v[32:33], v2 offset:288
    v_mfma_f32_32x32x16_bf16 v[168:183], v[16:19], v[60:63], v[168:183]
    ds_read_b64_tr_b16 v[34:35], v2 offset:256
    v_mfma_f32_32x32x16_bf16 v[184:199], v[16:19], v[76:79], v[184:199]
    s_waitcnt lgkmcnt(6)
    v_mfma_f32_32x32x16_bf16 v[152:167], v[20:23], v[40:43], v[152:167]
    ds_read_b128 v[16:19], v3 offset:704
    ds_read_b64_tr_b16 v[28:29], v2 offset:160
    v_mfma_f32_32x32x16_bf16 v[168:183], v[20:23], v[56:59], v[168:183]
    ds_read_b64_tr_b16 v[30:31], v2 offset:128
    v_mfma_f32_32x32x16_bf16 v[184:199], v[20:23], v[72:75], v[184:199]
    s_waitcnt lgkmcnt(6)
    v_mfma_f32_32x32x16_bf16 v[152:167], v[8:11], v[36:39], v[152:167]
    ds_read_b128 v[20:23], v3 offset:736
    ds_read_b64_tr_b16 v[24:25], v2 offset:32
    v_mfma_f32_32x32x16_bf16 v[168:183], v[8:11], v[52:55], v[168:183]
    ds_read_b64_tr_b16 v[26:27], v2 offset:0
    v_mfma_f32_32x32x16_bf16 v[184:199], v[8:11], v[68:71], v[184:199]
    s_waitcnt lgkmcnt(6)
    v_mfma_f32_32x32x16_bf16 v[152:167], v[12:15], v[32:35], v[152:167]
    ds_read_b128 v[8:11], v3 offset:768
    v_mfma_f32_32x32x16_bf16 v[168:183], v[12:15], v[48:51], v[168:183]
    v_mfma_f32_32x32x16_bf16 v[184:199], v[12:15], v[64:67], v[184:199]
    s_waitcnt lgkmcnt(4)
    v_mfma_f32_32x32x16_bf16 v[152:167], v[16:19], v[28:31], v[152:167]
    ds_read_b128 v[12:15], v3 offset:800
    v_mfma_f32_32x32x16_bf16 v[168:183], v[16:19], v[44:47], v[168:183]
    v_mfma_f32_32x32x16_bf16 v[184:199], v[16:19], v[60:63], v[184:199]
    s_waitcnt lgkmcnt(2)
    v_mfma_f32_32x32x16_bf16 v[152:167], v[20:23], v[24:27], v[152:167]
    ds_read_b128 v[16:19], v3 offset:832
    v_mfma_f32_32x32x16_bf16 v[168:183], v[20:23], v[40:43], v[168:183]
    v_mfma_f32_32x32x16_bf16 v[184:199], v[20:23], v[56:59], v[184:199]
    s_waitcnt lgkmcnt(2)
    v_mfma_f32_32x32x16_bf16 v[168:183], v[8:11], v[36:39], v[168:183]
    ds_read_b128 v[20:23], v3 offset:864
    v_mfma_f32_32x32x16_bf16 v[184:199], v[8:11], v[52:55], v[184:199]
    s_waitcnt lgkmcnt(2)
    v_mfma_f32_32x32x16_bf16 v[168:183], v[12:15], v[32:35], v[168:183]
    ds_read_b128 v[8:11], v3 offset:896
    v_mfma_f32_32x32x16_bf16 v[184:199], v[12:15], v[48:51], v[184:199]
    s_waitcnt lgkmcnt(2)
    v_mfma_f32_32x32x16_bf16 v[168:183], v[16:19], v[28:31], v[168:183]
    ds_read_b128 v[12:15], v3 offset:928
    v_mfma_f32_32x32x16_bf16 v[184:199], v[16:19], v[44:47], v[184:199]
    s_waitcnt lgkmcnt(2)
    v_mfma_f32_32x32x16_bf16 v[168:183], v[20:23], v[24:27], v[168:183]
    ds_read_b128 v[16:19], v3 offset:960
    v_mfma_f32_32x32x16_bf16 v[184:199], v[20:23], v[40:43], v[184:199]
    s_waitcnt lgkmcnt(2)
    v_mfma_f32_32x32x16_bf16 v[184:199], v[8:11], v[36:39], v[184:199]
    ds_read_b128 v[20:23], v3 offset:992
    s_waitcnt lgkmcnt(2)
    v_mfma_f32_32x32x16_bf16 v[184:199], v[12:15], v[32:35], v[184:199]
    s_waitcnt lgkmcnt(1)
    v_mfma_f32_32x32x16_bf16 v[184:199], v[16:19], v[28:31], v[184:199]
    s_waitcnt lgkmcnt(0)
    v_mfma_f32_32x32x16_bf16 v[184:199], v[20:23], v[24:27], v[184:199]
    s_nop 7
    s_nop 3
    v_cndmask_b32 v203, v181, v177, s[12:13]
    v_cndmask_b32 v204, v182, v178, s[14:15]
    v_cndmask_b32 v205, v183, v179, s[16:17]
    v_cndmask_b32 v177, v177, v173, s[12:13]
    v_cndmask_b32 v178, v178, v174, s[14:15]
    v_cndmask_b32 v179, v179, v175, s[16:17]
    v_cndmask_b32 v173, v173, v169, s[12:13]
    v_cndmask_b32 v174, v174, v170, s[14:15]
    v_cndmask_b32 v175, v175, v171, s[16:17]
    v_cndmask_b32 v169, v169, v165, s[12:13]
    v_cndmask_b32 v170, v170, v166, s[14:15]
    v_cndmask_b32 v171, v171, v167, s[16:17]
    v_add_f32_dpp v204, v205, v204 wave_ror:1 row_mask:0xf bank_mask:0xf
    v_add_f32_dpp v178, v179, v178 wave_ror:1 row_mask:0xf bank_mask:0xf
    v_add_f32_dpp v174, v175, v174 wave_ror:1 row_mask:0xf bank_mask:0xf
    v_add_f32_dpp v170, v171, v170 wave_ror:1 row_mask:0xf bank_mask:0xf
    v_add_f32_dpp v203, v204, v203 wave_ror:1 row_mask:0xf bank_mask:0xf
    v_add_f32_dpp v177, v178, v177 wave_ror:1 row_mask:0xf bank_mask:0xf
    v_add_f32_dpp v173, v174, v173 wave_ror:1 row_mask:0xf bank_mask:0xf
    v_add_f32_dpp v169, v170, v169 wave_ror:1 row_mask:0xf bank_mask:0xf
    v_add_f32_dpp v180, v203, v180 wave_ror:1 row_mask:0xf bank_mask:0xf
    v_add_f32_dpp v176, v177, v176 wave_ror:1 row_mask:0xf bank_mask:0xf
    v_add_f32_dpp v172, v173, v172 wave_ror:1 row_mask:0xf bank_mask:0xf
    v_add_f32_dpp v168, v169, v168 wave_ror:1 row_mask:0xf bank_mask:0xf
    v_cndmask_b32 v206, v197, v193, s[12:13]
    v_cndmask_b32 v207, v198, v194, s[14:15]
    v_cndmask_b32 v208, v199, v195, s[16:17]
    v_cndmask_b32 v193, v193, v189, s[12:13]
    v_cndmask_b32 v194, v194, v190, s[14:15]
    v_cndmask_b32 v195, v195, v191, s[16:17]
    v_cndmask_b32 v189, v189, v185, s[12:13]
    v_cndmask_b32 v190, v190, v186, s[14:15]
    v_cndmask_b32 v191, v191, v187, s[16:17]
    v_cndmask_b32 v185, v185, v181, s[12:13]
    v_cndmask_b32 v186, v186, v182, s[14:15]
    v_cndmask_b32 v187, v187, v183, s[16:17]
    v_add_f32_dpp v207, v208, v207 wave_ror:1 row_mask:0xf bank_mask:0xf
    v_add_f32_dpp v194, v195, v194 wave_ror:1 row_mask:0xf bank_mask:0xf
    v_add_f32_dpp v190, v191, v190 wave_ror:1 row_mask:0xf bank_mask:0xf
    v_add_f32_dpp v186, v187, v186 wave_ror:1 row_mask:0xf bank_mask:0xf
    v_add_f32_dpp v206, v207, v206 wave_ror:1 row_mask:0xf bank_mask:0xf
    v_add_f32_dpp v193, v194, v193 wave_ror:1 row_mask:0xf bank_mask:0xf
    v_add_f32_dpp v189, v190, v189 wave_ror:1 row_mask:0xf bank_mask:0xf
    v_add_f32_dpp v185, v186, v185 wave_ror:1 row_mask:0xf bank_mask:0xf
    v_add_f32_dpp v196, v206, v196 wave_ror:1 row_mask:0xf bank_mask:0xf
    v_add_f32_dpp v192, v193, v192 wave_ror:1 row_mask:0xf bank_mask:0xf
    v_add_f32_dpp v188, v189, v188 wave_ror:1 row_mask:0xf bank_mask:0xf
    v_add_f32_dpp v184, v185, v184 wave_ror:1 row_mask:0xf bank_mask:0xf
    s_mov_b32 vcc_lo, 0xaaaaaaaa
    s_mov_b32 vcc_hi, 0xaaaaaaaa
    v_cndmask_b32_dpp v170, v168, v172, vcc quad_perm:[1,0,3,2] row_mask:0xf bank_mask:0xf
    v_cndmask_b32_dpp v173, v176, v180, vcc quad_perm:[1,0,3,2] row_mask:0xf bank_mask:0xf
    v_cndmask_b32_dpp v175, v184, v188, vcc quad_perm:[1,0,3,2] row_mask:0xf bank_mask:0xf
    v_cndmask_b32_dpp v178, v192, v196, vcc quad_perm:[1,0,3,2] row_mask:0xf bank_mask:0xf
    s_not_b64 vcc, vcc
    v_cndmask_b32_dpp v169, v172, v168, vcc quad_perm:[1,0,3,2] row_mask:0xf bank_mask:0xf
    v_cndmask_b32_dpp v171, v180, v176, vcc quad_perm:[1,0,3,2] row_mask:0xf bank_mask:0xf
    v_cndmask_b32_dpp v174, v188, v184, vcc quad_perm:[1,0,3,2] row_mask:0xf bank_mask:0xf
    v_cndmask_b32_dpp v177, v196, v192, vcc quad_perm:[1,0,3,2] row_mask:0xf bank_mask:0xf
    v_cvt_pk_bf16_f32 v179, v169, v170
    v_cvt_pk_bf16_f32 v185, v171, v173
    v_cvt_pk_bf16_f32 v186, v174, v175
    v_cvt_pk_bf16_f32 v187, v177, v178
    s_mov_b32 vcc_lo, 0xcccccccc
    s_mov_b32 vcc_hi, 0xcccccccc
    v_cndmask_b32_dpp v190, v179, v185, vcc quad_perm:[2,3,0,1] row_mask:0xf bank_mask:0xf
    v_cndmask_b32_dpp v193, v186, v187, vcc quad_perm:[2,3,0,1] row_mask:0xf bank_mask:0xf
    s_not_b64 vcc, vcc
    v_cndmask_b32_dpp v189, v185, v179, vcc quad_perm:[2,3,0,1] row_mask:0xf bank_mask:0xf
    v_cndmask_b32_dpp v191, v187, v186, vcc quad_perm:[2,3,0,1] row_mask:0xf bank_mask:0xf
    s_mov_b32 vcc_lo, 0xf0f0f0f0
    s_mov_b32 vcc_hi, 0xf0f0f0f0
    v_cndmask_b32_dpp v170, v189, v191, vcc row_ror:12 row_mask:0xf bank_mask:0xf
    v_cndmask_b32_dpp v171, v190, v193, vcc row_ror:12 row_mask:0xf bank_mask:0xf
    s_not_b64 vcc, vcc
    v_cndmask_b32_dpp v168, v191, v189, vcc row_ror:4 row_mask:0xf bank_mask:0xf
    v_cndmask_b32_dpp v169, v193, v190, vcc row_ror:4 row_mask:0xf bank_mask:0xf
    buffer_store_dwordx4 v[168:171], v5, s[56:59], s18 offen offset:3072 sc1
    s_waitcnt vmcnt(0)
    s_mov_b64 exec, 1
    buffer_store_dword v7, v6, s[56:59], s19 offen sc1
    s_mov_b64 exec, -1
    s_cmp_lg_u32 s6, 0
    s_cbranch_scc1 CV_NOGATE
    s_lshl_b32 s16, s39, 9
    s_add_u32 s16, s16, 16162816
    v_lshrrev_b32 v2, 2, v0
    v_and_b32 v3, 3, v0
    v_and_b32 v4, 3, v2
    v_lshlrev_b32 v4, 7, v4
    v_lshl_add_u32 v4, v3, 2, v4
    v_lshlrev_b32 v2, 2, v2
    v_lshl_add_u32 v2, v3, 11, v2
    s_mov_b32 s77, 0x100000
    s_lshl_b32 s17, s39, 2
    s_and_b32 s22, s40, 3
    s_add_u32 s17, s17, s22
    s_lshl_b32 s17, s17, 6
    s_add_u32 s17, s17, 15728640
PG_SPIN:
    s_sleep 1
    buffer_load_dword v5, v4, s[56:59], s16 offen sc1
    s_waitcnt vmcnt(0)
    s_sub_u32 s77, s77, 1
    s_cmp_eq_u32 s77, 0
    s_cbranch_scc1 PG_OK
PG_CHK:
    v_cmp_eq_u32 vcc, s23, v5
    s_nop 3
    s_cmp_eq_u64 vcc, exec
    s_cbranch_scc0 PG_SPIN
PG_OK:
    buffer_load_dword v8, v2, s[56:59], s17 offen sc1
    s_add_u32 s17, s17, 8192
    buffer_load_dword v9, v2, s[56:59], s17 offen sc1
    s_add_u32 s17, s17, 8192
    buffer_load_dword v10, v2, s[56:59], s17 offen sc1
    s_add_u32 s17, s17, 8192
    buffer_load_dword v11, v2, s[56:59], s17 offen sc1
    s_add_u32 s17, s17, 8192
    buffer_load_dword v12, v2, s[56:59], s17 offen sc1
    s_add_u32 s17, s17, 8192
    buffer_load_dword v13, v2, s[56:59], s17 offen sc1
    s_add_u32 s17, s17, 8192
    buffer_load_dword v14, v2, s[56:59], s17 offen sc1
    s_add_u32 s17, s17, 8192
    buffer_load_dword v15, v2, s[56:59], s17 offen sc1
    s_waitcnt vmcnt(0)
    v_add_f32 v8, v8, v9
    v_add_f32 v10, v10, v11
    v_add_f32 v12, v12, v13
    v_add_f32 v14, v14, v15
    v_add_f32 v8, v8, v10
    v_add_f32 v12, v12, v14
    v_add_f32 v8, v8, v12
    v_cvt_pk_bf16_f32 v8, v8, v8
    v_lshlrev_b32 v8, 16, v8
    v_mul_f32 v8, 0xbfb8aa3b, v8
    v_exp_f32 v8, v8
    v_lshlrev_b32 v2, 2, v0
    v_add_f32 v8, 1.0, v8
    v_rcp_f32 v8, v8
    v_add_u32 v2, 141824, v2
    v_cvt_pk_bf16_f32 v8, v8, v8
    v_lshlrev_b32 v8, 16, v8
    ds_write_b32 v2, v8
    s_waitcnt lgkmcnt(0)
CV_NOGATE:
    s_endpgm
CVB_SLOW:
    s_waitcnt lgkmcnt(0)
    s_mov_b32 s77, 0x100000
    s_lshr_b32 s16, s7, 7
    s_lshl_b32 s16, s16, 7
    s_lshr_b32 s17, s7, 3
    s_and_b32 s17, s17, 8
    s_add_u32 s16, s16, s17
    s_add_u32 s16, s16, 16154624
    v_and_b32 v200, 7, v0
    v_lshlrev_b32 v200, 9, v200
PUB_SPIN:
    s_sleep 8
    buffer_load_dwordx2 v[202:203], v200, s[56:59], s16 offen sc1
    s_waitcnt vmcnt(0)
    s_sub_u32 s77, s77, 1
    s_cmp_eq_u32 s77, 0
    s_cbranch_scc1 PUB_OK
PUB_CHK:
    v_cmp_eq_u32 vcc, s23, v202
    v_cmp_eq_u32 s[50:51], s23, v203
    s_nop 3
    s_and_b64 vcc, vcc, s[50:51]
    s_cmp_eq_u64 vcc, exec
    s_cbranch_scc0 PUB_SPIN
PUB_OK:
    v_lshlrev_b32 v200, 4, v0
    s_mul_i32 s52, s6, 5376
    s_mul_i32 s53, s7, 4224
    s_add_u32 s53, s53, 8388608
    s_add_u32 m0, s52, 131184
    s_nop 0
    buffer_load_dwordx4 v200, s[56:59], s53 offen sc1 lds
    s_add_u32 s53, s53, 1024
    s_add_u32 m0, s52, 132528
    s_nop 0
    buffer_load_dwordx4 v200, s[56:59], s53 offen sc1 lds
    s_add_u32 s53, s53, 1024
    s_add_u32 m0, s52, 133872
    s_nop 0
    buffer_load_dwordx4 v200, s[56:59], s53 offen sc1 lds
    s_add_u32 s53, s53, 1024
    s_add_u32 m0, s52, 135216
    s_nop 0
    buffer_load_dwordx4 v200, s[56:59], s53 offen sc1 lds
    s_add_u32 s53, s53, 1024
    s_mov_b32 s16, 0
    s_mov_b32 s17, 0xe0000000
    v_mov_b32 v4, 1
    s_waitcnt vmcnt(0)
    s_branch CVB_GO
L_END:
    s_endpgm

.section .rodata,"a"
.p2align 6
.amdhsa_kernel gated_mix__ssm_conv_s4__swiglu_ffn__prompt_kernel
  .amdhsa_next_free_vgpr 256
  .amdhsa_next_free_sgpr 102
  .amdhsa_accum_offset 256
  .amdhsa_group_segment_fixed_size 0
  .amdhsa_kernarg_size 136
  .amdhsa_user_sgpr_count 2
  .amdhsa_user_sgpr_kernarg_segment_ptr 1
  .amdhsa_system_sgpr_workgroup_id_x 1
.end_amdhsa_kernel
```
